```python
import torch

def _softmax(x, axis=-1):
    return torch.softmax(x, dim=axis)
def _gelu(x):
    return torch.nn.functional.gelu(x, approximate="tanh")
def _silu(x):
    return torch.nn.functional.silu(x)
def _sigmoid(x):
    return torch.sigmoid(x)
def _layernorm(x, axis=-1, eps=1e-5):
    m = x.mean(dim=axis, keepdim=True)
    v = x.var(dim=axis, keepdim=True, unbiased=False)
    return (x - m) / torch.sqrt(v + eps)
def _scatter_add(tgt, idx, src, axis=0):
    return tgt.clone().index_add_(axis, idx, src)
def _segment_sum(src, seg, n):
    out = torch.zeros((n,) + src.shape[1:], dtype=src.dtype)
    return out.index_add_(0, seg, src)
def _pad(x, pw):
    flat = tuple(v for pair in reversed(pw) for v in pair)
    return torch.nn.functional.pad(x, flat)

kernel_name = 'sequential_preLN__grouped_kv_mqa__geglu_ffn__prompt'

def setup_inputs():

    _w = (lambda a: (lambda t: t.to(torch.bfloat16) if t.is_floating_point() else t)(torch.as_tensor(a)))
    def _A_setup():
        B, S, D, H = 1, 2048, 512, 32
        Dh = D // H
        return {
            "x": _w((lambda *s: torch.randn(*s, dtype=torch.bfloat16) * 0.05)(B, S, D)),
            "wq": _w((lambda *s: torch.randn(*s, dtype=torch.bfloat16) * 0.05)(D, H * Dh)),
            "wk": _w((lambda *s: torch.randn(*s, dtype=torch.bfloat16) * 0.05)(D, Dh)),
            "wv": _w((lambda *s: torch.randn(*s, dtype=torch.bfloat16) * 0.05)(D, Dh)),
            "wo": _w((lambda *s: torch.randn(*s, dtype=torch.bfloat16) * 0.05)(H * Dh, D)),
        }
    _A_in = _A_setup()

    def _B_setup():
        B, S, D, F = 1, 2048, 512, 1376
        return {
            "x": _w((lambda *s: torch.randn(*s, dtype=torch.bfloat16) * 0.05)(B, S, D)),
            "w_gate": _w((lambda *s: torch.randn(*s, dtype=torch.bfloat16) * 0.05)(D, F)),
            "w_up": _w((lambda *s: torch.randn(*s, dtype=torch.bfloat16) * 0.05)(D, F)),
            "w_down": _w((lambda *s: torch.randn(*s, dtype=torch.bfloat16) * 0.05)(F, D)),
        }
    _B_in = _B_setup()

    return {
        "A_x": _A_in["x"],
        "A_wq": _A_in["wq"],
        "A_wk": _A_in["wk"],
        "A_wv": _A_in["wv"],
        "A_wo": _A_in["wo"],
        "B_x": _B_in["x"],
        "B_w_gate": _B_in["w_gate"],
        "B_w_up": _B_in["w_up"],
        "B_w_down": _B_in["w_down"],
    }

def reference(A_x, A_wq, A_wk, A_wv, A_wo, B_x, B_w_gate, B_w_up, B_w_down):
    def _A_ref(x, wq, wk, wv, wo):
        B, S, D = x.shape
        H = 32
        Dh = D // H
        q = (lambda x, *d: x.permute(*d))((x @ wq).reshape(B, S, H, Dh), 0, 2, 1, 3)
        k = x @ wk
        v = x @ wv
        scores = torch.einsum("bhqd,bkd->bhqk", q, k) * (Dh ** -0.5)
        p = _softmax(scores, axis=-1)
        o = torch.einsum("bhqk,bkd->bhqd", p, v)
        return (lambda x, *d: x.permute(*d))(o, 0, 2, 1, 3).reshape(B, S, H * Dh) @ wo

    def _B_ref(x, w_gate, w_up, w_down):
        return (_gelu(x @ w_gate) * (x @ w_up)) @ w_down

    x = A_x
    h = x + _A_ref(_layernorm(x, axis=-1), A_wq, A_wk, A_wv, A_wo)
    h2 = h + _B_ref(_layernorm(h, axis=-1), B_w_gate, B_w_up, B_w_down)
    return h2
```

```asm
; @launch grid=(256,1,1) block=(256,1,1) lds=163840
.amdgcn_target "amdgcn-amd-amdhsa--gfx950"
.text
.globl sequential_preLN__grouped_kv_mqa__geglu_ffn__prompt_kernel
.p2align 8
.type sequential_preLN__grouped_kv_mqa__geglu_ffn__prompt_kernel,@function
sequential_preLN__grouped_kv_mqa__geglu_ffn__prompt_kernel:
    s_cmp_ge_u32 s2, 256
    s_cbranch_scc1 END_K
    s_load_dwordx4 s[32:35], s[0:1], 0
    s_load_dwordx4 s[36:39], s[0:1], 16
    s_load_dwordx2 s[40:41], s[0:1], 32
    s_load_dwordx4 s[44:47], s[0:1], 48
    s_load_dwordx4 s[48:51], s[0:1], 64
    s_load_dwordx2 s[52:53], s[0:1], 88
    s_load_dwordx2 s[54:55], s[0:1], 80
    v_lshrrev_b32 v1, 6, v0
    v_and_b32 v0, 63, v0
    v_readfirstlane_b32 s6, v1
    s_and_b32 s3, s2, 7
    s_lshr_b32 s7, s2, 3
    s_lshr_b32 s4, s7, 3
    s_lshl_b32 s3, s3, 2
    s_add_u32 s4, s4, s3
    s_and_b32 s5, s7, 7
    v_lshlrev_b32 v9, 4, v0
    s_getpc_b64 s[60:61]
PF_HERE:
    s_lshl_b32 s3, s7, 2
    s_add_u32 s3, s3, s6
    s_lshl_b32 s3, s3, 9
    v_and_b32 v231, 7, v0
    v_lshlrev_b32 v231, 6, v231
    v_add_u32 v231, s3, v231
    v_min_u32 v230, END_K-PF_HERE-4, v231
    s_mov_b64 exec, 0xff
    global_load_dword v232, v230, s[60:61]
    s_mov_b64 exec, -1
    s_waitcnt lgkmcnt(0)
    s_mov_b32 s8, s52
    s_mov_b32 s9, s53
    s_mov_b32 s10, 0x01a00000
    s_mov_b32 s11, 0x20000
    s_mov_b32 s56, s54
    s_mov_b32 s57, s55
    s_mov_b32 s58, 0x00000100
    s_mov_b32 s59, 0x20000
    s_mov_b32 s28, 0x3f803f80
    s_mov_b32 s12, s32
    s_mov_b32 s13, s33
    s_mov_b32 s14, 0x00200000
    s_mov_b32 s15, 0x20000
    s_and_b32 s3, s5, 1
    s_lshl_b32 s60, s4, 1
    s_add_u32 s60, s60, s3
    v_lshrrev_b32 v1, 3, v0
    v_and_b32 v10, 7, v0
    s_lshl_b32 s3, s60, 5
    s_lshl_b32 s7, s6, 3
    s_add_u32 s3, s3, s7
    v_add_u32 v2, s3, v1
    v_lshlrev_b32 v2, 10, v2
    v_lshl_add_u32 v2, v10, 4, v2
    v_xor_b32 v3, 0x8000, v2
    buffer_load_dwordx4 v[16:19], v2, s[12:15], 0 offen offset:0
    buffer_load_dwordx4 v[20:23], v2, s[12:15], 0 offen offset:128
    buffer_load_dwordx4 v[24:27], v2, s[12:15], 0 offen offset:256
    buffer_load_dwordx4 v[28:31], v2, s[12:15], 0 offen offset:384
    buffer_load_dwordx4 v[32:35], v2, s[12:15], 0 offen offset:512
    buffer_load_dwordx4 v[36:39], v2, s[12:15], 0 offen offset:640
    buffer_load_dwordx4 v[40:43], v2, s[12:15], 0 offen offset:768
    buffer_load_dwordx4 v[44:47], v2, s[12:15], 0 offen offset:896
    s_mov_b32 s16, s34
    s_mov_b32 s17, s35
    s_mov_b32 s18, 0x00080000
    s_mov_b32 s19, 0x20000
    v_lshrrev_b32 v11, 4, v0
    v_and_b32 v11, 1, v11
    v_lshlrev_b32 v11, 2, v11
    v_xor_b32 v11, v11, v10
    v_lshlrev_b32 v11, 4, v11
    v_lshl_add_u32 v4, v1, 10, v11
    s_lshl_b32 s3, s5, 7
    v_add_u32 v4, s3, v4
    v_lshrrev_b32 v11, 1, v10
    v_mul_u32_u24 v11, 1056, v11
    v_and_b32 v12, 1, v10
    v_mul_u32_u24 v12, 528, v12
    v_add_u32 v5, v11, v12
    s_lshl_b32 s3, s6, 3
    v_add_u32 v11, s3, v1
    v_lshl_add_u32 v5, v11, 4, v5
    v_lshrrev_b32 v11, 5, v0
    v_mul_u32_u24 v11, 528, v11
    v_and_b32 v12, 31, v0
    v_lshl_add_u32 v6, v12, 4, v11
    v_lshrrev_b32 v11, 4, v0
    v_bfe_u32 v12, v0, 2, 2
    v_and_b32 v13, 3, v0
    v_lshrrev_b32 v14, 1, v11
    v_lshl_add_u32 v14, v14, 3, v12
    v_and_b32 v15, 1, v11
    v_and_b32 v96, 1, v13
    v_lshlrev_b32 v96, 4, v96
    v_lshrrev_b32 v97, 1, v13
    v_lshl_add_u32 v96, v97, 3, v96
    v_mul_u32_u24 v97, 16512, v15
    v_lshl_add_u32 v97, v14, 5, v97
    v_add_u32 v97, v97, v96
    v_add_u32 v8, 33792, v97
    s_and_b32 s3, s6, 1
    s_lshl_b32 s3, s3, 2
    v_and_b32 v97, 1, v13
    v_lshl_add_u32 v97, v15, 1, v97
    v_add_u32 v97, s3, v97
    v_lshrrev_b32 v98, 1, v12
    v_lshlrev_b32 v98, 2, v98
    v_xor_b32 v97, v97, v98
    v_lshlrev_b32 v97, 4, v97
    v_lshrrev_b32 v98, 1, v13
    v_lshl_add_u32 v97, v98, 3, v97
    v_lshl_add_u32 v97, v14, 7, v97
    v_add_u32 v7, 67584, v97
    s_cmp_ge_u32 s5, 2
    s_cselect_b32 s77, 4, 8
    s_sub_u32 s3, s6, 2
    s_lshl_b32 s3, s3, 1
    s_cmp_ge_u32 s5, 2
    s_cselect_b32 s3, s6, s3
    s_lshl_b32 s75, s3, 17
    s_lshl_b32 s76, s3, 14
    s_add_u32 s76, s76, 67584
    s_lshl_b32 s74, s6, 14
    s_cmp_ge_u32 s5, 2
    s_cbranch_scc1 A_nokvdma
    s_cmp_lg_u32 s6, 2
    s_cbranch_scc1 A_noclr
    s_mul_i32 s3, s60, 208
    s_add_u32 s3, s3, 2326528
    v_lshlrev_b32 v11, 2, v0
    v_mov_b32 v12, 0
    s_mov_b32 exec_hi, 0x000fffff
    buffer_store_dword v12, v11, s[8:11], s3 offen sc1
    s_mov_b64 exec, -1
A_noclr:
    s_cmp_lt_u32 s6, 2
    s_cselect_b32 s20, s36, s38
    s_cselect_b32 s21, s37, s39
    s_mov_b32 s22, 16384
    s_mov_b32 s23, 0x20000
    s_mov_b32 s30, 50304
    s_cmov_b32 s30, 33792
    s_and_b32 s3, s6, 1
    s_lshl_b32 s3, s3, 13
    s_add_u32 s30, s30, s3
    s_add_u32 m0, s30, 0
    s_add_u32 s31, s3, 0
    buffer_load_dwordx4 v9, s[20:23], s31 offen offset:0 lds
    buffer_load_dwordx4 v9, s[20:23], s31 offen offset:1024 lds
    buffer_load_dwordx4 v9, s[20:23], s31 offen offset:2048 lds
    buffer_load_dwordx4 v9, s[20:23], s31 offen offset:3072 lds
    s_add_u32 m0, s30, 4096
    s_add_u32 s31, s3, 4096
    buffer_load_dwordx4 v9, s[20:23], s31 offen offset:0 lds
    buffer_load_dwordx4 v9, s[20:23], s31 offen offset:1024 lds
    buffer_load_dwordx4 v9, s[20:23], s31 offen offset:2048 lds
    buffer_load_dwordx4 v9, s[20:23], s31 offen offset:3072 lds
    v_mov_b32 v88, 0x3f803f80
    v_mov_b32 v92, 0x3afe3f80
    v_and_b32 v89, 59, v0
    v_cmp_eq_u32 vcc, 16, v89
    s_nop 1
    v_cndmask_b32 v92, 0, v92, vcc
    v_mov_b32 v89, 0
    v_mov_b32 v90, 0
    v_mov_b32 v91, 0
    v_mov_b32 v93, 0
    v_mov_b32 v94, 0
    v_mov_b32 v95, 0
    s_nop 1
    v_mfma_f32_32x32x16_bf16 a[64:79], v[88:91], v[92:95], 0
    v_mfma_f32_32x32x16_bf16 a[80:95], v[88:91], v[92:95], 0
    v_mfma_f32_32x32x16_bf16 a[96:111], v[88:91], v[92:95], 0
    v_mfma_f32_32x32x16_bf16 a[112:127], v[88:91], v[92:95], 0
    v_mfma_f32_32x32x16_bf16 a[128:143], v[88:91], v[92:95], 0
    v_mfma_f32_32x32x16_bf16 a[144:159], v[88:91], v[92:95], 0
    v_mfma_f32_32x32x16_bf16 a[160:175], v[88:91], v[92:95], 0
    v_mfma_f32_32x32x16_bf16 a[176:191], v[88:91], v[92:95], 0
    s_waitcnt vmcnt(8)
    s_branch A_xw
A_nokvdma:
    s_and_b32 s3, s4, 3
    s_mul_i32 s3, s3, 6
    s_add_u32 s3, s3, s5
    s_sub_u32 s3, s3, 2
    s_lshl_b32 s3, s3, 2
    s_add_u32 s3, s3, s6
    s_mul_i32 s3, s3, 22
    v_add_u32 v247, s3, v0
    v_lshrrev_b32 v246, 2, v247
    v_and_b32 v247, 3, v247
    v_lshlrev_b32 v247, 6, v247
    v_lshl_add_u32 v247, v246, 10, v247
    s_mov_b64 exec, 0x3fffff
    buffer_load_dword v246, v247, s[16:19], 0 offen
    s_mov_b64 exec, -1
    v_mov_b32 v88, 0x3f803f80
    v_mov_b32 v92, 0x3afe3f80
    v_and_b32 v89, 59, v0
    v_cmp_eq_u32 vcc, 16, v89
    s_nop 1
    v_cndmask_b32 v92, 0, v92, vcc
    v_mov_b32 v89, 0
    v_mov_b32 v90, 0
    v_mov_b32 v91, 0
    v_mov_b32 v93, 0
    v_mov_b32 v94, 0
    v_mov_b32 v95, 0
    s_nop 1
    v_mfma_f32_32x32x16_bf16 a[64:79], v[88:91], v[92:95], 0
    v_mfma_f32_32x32x16_bf16 a[80:95], v[88:91], v[92:95], 0
    v_mfma_f32_32x32x16_bf16 a[96:111], v[88:91], v[92:95], 0
    v_mfma_f32_32x32x16_bf16 a[112:127], v[88:91], v[92:95], 0
    v_mfma_f32_32x32x16_bf16 a[128:143], v[88:91], v[92:95], 0
    v_mfma_f32_32x32x16_bf16 a[144:159], v[88:91], v[92:95], 0
    v_mfma_f32_32x32x16_bf16 a[160:175], v[88:91], v[92:95], 0
    v_mfma_f32_32x32x16_bf16 a[176:191], v[88:91], v[92:95], 0
    s_waitcnt vmcnt(1)
A_xw:
    v_lshlrev_b32 v176, 16, v16
    v_and_b32 v177, 0xffff0000, v16
    v_lshlrev_b32 v178, 16, v17
    v_and_b32 v179, 0xffff0000, v17
    v_pk_mul_f32 v[84:85], v[176:177], v[176:177]
    v_lshlrev_b32 v180, 16, v18
    v_and_b32 v181, 0xffff0000, v18
    v_pk_mul_f32 v[86:87], v[178:179], v[178:179]
    v_lshlrev_b32 v182, 16, v19
    v_and_b32 v183, 0xffff0000, v19
    v_pk_fma_f32 v[84:85], v[180:181], v[180:181], v[84:85]
    v_pk_add_f32 v[80:81], v[176:177], v[180:181]
    v_lshlrev_b32 v184, 16, v20
    v_and_b32 v185, 0xffff0000, v20
    v_pk_fma_f32 v[86:87], v[182:183], v[182:183], v[86:87]
    v_pk_add_f32 v[82:83], v[178:179], v[182:183]
    v_lshlrev_b32 v186, 16, v21
    v_and_b32 v187, 0xffff0000, v21
    v_pk_fma_f32 v[84:85], v[184:185], v[184:185], v[84:85]
    v_pk_add_f32 v[80:81], v[80:81], v[184:185]
    v_lshlrev_b32 v188, 16, v22
    v_and_b32 v189, 0xffff0000, v22
    v_pk_fma_f32 v[86:87], v[186:187], v[186:187], v[86:87]
    v_pk_add_f32 v[82:83], v[82:83], v[186:187]
    v_lshlrev_b32 v190, 16, v23
    v_and_b32 v191, 0xffff0000, v23
    buffer_load_dwordx4 v[48:51], v3, s[12:15], 0 offen offset:0
    v_pk_fma_f32 v[84:85], v[188:189], v[188:189], v[84:85]
    v_pk_add_f32 v[80:81], v[80:81], v[188:189]
    v_lshlrev_b32 v192, 16, v24
    v_and_b32 v193, 0xffff0000, v24
    v_pk_fma_f32 v[86:87], v[190:191], v[190:191], v[86:87]
    v_pk_add_f32 v[82:83], v[82:83], v[190:191]
    v_lshlrev_b32 v194, 16, v25
    v_and_b32 v195, 0xffff0000, v25
    v_pk_fma_f32 v[84:85], v[192:193], v[192:193], v[84:85]
    v_pk_add_f32 v[80:81], v[80:81], v[192:193]
    v_lshlrev_b32 v196, 16, v26
    v_and_b32 v197, 0xffff0000, v26
    v_pk_fma_f32 v[86:87], v[194:195], v[194:195], v[86:87]
    v_pk_add_f32 v[82:83], v[82:83], v[194:195]
    v_lshlrev_b32 v198, 16, v27
    v_and_b32 v199, 0xffff0000, v27
    v_pk_fma_f32 v[84:85], v[196:197], v[196:197], v[84:85]
    v_pk_add_f32 v[80:81], v[80:81], v[196:197]
    v_lshlrev_b32 v200, 16, v28
    v_and_b32 v201, 0xffff0000, v28
    v_pk_fma_f32 v[86:87], v[198:199], v[198:199], v[86:87]
    v_pk_add_f32 v[82:83], v[82:83], v[198:199]
    v_lshlrev_b32 v202, 16, v29
    v_and_b32 v203, 0xffff0000, v29
    v_pk_fma_f32 v[84:85], v[200:201], v[200:201], v[84:85]
    v_pk_add_f32 v[80:81], v[80:81], v[200:201]
    buffer_load_dwordx4 v[52:55], v3, s[12:15], 0 offen offset:128
    v_lshlrev_b32 v204, 16, v30
    v_and_b32 v205, 0xffff0000, v30
    v_pk_fma_f32 v[86:87], v[202:203], v[202:203], v[86:87]
    v_pk_add_f32 v[82:83], v[82:83], v[202:203]
    v_lshlrev_b32 v206, 16, v31
    v_and_b32 v207, 0xffff0000, v31
    v_pk_fma_f32 v[84:85], v[204:205], v[204:205], v[84:85]
    v_pk_add_f32 v[80:81], v[80:81], v[204:205]
    v_lshlrev_b32 v208, 16, v32
    v_and_b32 v209, 0xffff0000, v32
    v_pk_fma_f32 v[86:87], v[206:207], v[206:207], v[86:87]
    v_pk_add_f32 v[82:83], v[82:83], v[206:207]
    v_lshlrev_b32 v210, 16, v33
    v_and_b32 v211, 0xffff0000, v33
    v_pk_fma_f32 v[84:85], v[208:209], v[208:209], v[84:85]
    v_pk_add_f32 v[80:81], v[80:81], v[208:209]
    v_lshlrev_b32 v212, 16, v34
    v_and_b32 v213, 0xffff0000, v34
    v_pk_fma_f32 v[86:87], v[210:211], v[210:211], v[86:87]
    v_pk_add_f32 v[82:83], v[82:83], v[210:211]
    v_lshlrev_b32 v214, 16, v35
    v_and_b32 v215, 0xffff0000, v35
    v_pk_fma_f32 v[84:85], v[212:213], v[212:213], v[84:85]
    v_pk_add_f32 v[80:81], v[80:81], v[212:213]
    v_lshlrev_b32 v216, 16, v36
    v_and_b32 v217, 0xffff0000, v36
    buffer_load_dwordx4 v[56:59], v3, s[12:15], 0 offen offset:256
    v_pk_fma_f32 v[86:87], v[214:215], v[214:215], v[86:87]
    v_pk_add_f32 v[82:83], v[82:83], v[214:215]
    v_lshlrev_b32 v218, 16, v37
    v_and_b32 v219, 0xffff0000, v37
    v_pk_fma_f32 v[84:85], v[216:217], v[216:217], v[84:85]
    v_pk_add_f32 v[80:81], v[80:81], v[216:217]
    v_lshlrev_b32 v220, 16, v38
    v_and_b32 v221, 0xffff0000, v38
    v_pk_fma_f32 v[86:87], v[218:219], v[218:219], v[86:87]
    v_pk_add_f32 v[82:83], v[82:83], v[218:219]
    v_lshlrev_b32 v222, 16, v39
    v_and_b32 v223, 0xffff0000, v39
    v_pk_fma_f32 v[84:85], v[220:221], v[220:221], v[84:85]
    v_pk_add_f32 v[80:81], v[80:81], v[220:221]
    v_lshlrev_b32 v224, 16, v40
    v_and_b32 v225, 0xffff0000, v40
    v_pk_fma_f32 v[86:87], v[222:223], v[222:223], v[86:87]
    v_pk_add_f32 v[82:83], v[82:83], v[222:223]
    v_lshlrev_b32 v226, 16, v41
    v_and_b32 v227, 0xffff0000, v41
    v_pk_fma_f32 v[84:85], v[224:225], v[224:225], v[84:85]
    v_pk_add_f32 v[80:81], v[80:81], v[224:225]
    v_lshlrev_b32 v228, 16, v42
    v_and_b32 v229, 0xffff0000, v42
    v_pk_fma_f32 v[86:87], v[226:227], v[226:227], v[86:87]
    v_pk_add_f32 v[82:83], v[82:83], v[226:227]
    buffer_load_dwordx4 v[60:63], v3, s[12:15], 0 offen offset:384
    v_lshlrev_b32 v230, 16, v43
    v_and_b32 v231, 0xffff0000, v43
    v_pk_fma_f32 v[84:85], v[228:229], v[228:229], v[84:85]
    v_pk_add_f32 v[80:81], v[80:81], v[228:229]
    v_lshlrev_b32 v232, 16, v44
    v_and_b32 v233, 0xffff0000, v44
    v_pk_fma_f32 v[86:87], v[230:231], v[230:231], v[86:87]
    v_pk_add_f32 v[82:83], v[82:83], v[230:231]
    v_lshlrev_b32 v234, 16, v45
    v_and_b32 v235, 0xffff0000, v45
    v_pk_fma_f32 v[84:85], v[232:233], v[232:233], v[84:85]
    v_pk_add_f32 v[80:81], v[80:81], v[232:233]
    v_lshlrev_b32 v236, 16, v46
    v_and_b32 v237, 0xffff0000, v46
    v_pk_fma_f32 v[86:87], v[234:235], v[234:235], v[86:87]
    v_pk_add_f32 v[82:83], v[82:83], v[234:235]
    v_lshlrev_b32 v238, 16, v47
    v_and_b32 v239, 0xffff0000, v47
    v_pk_fma_f32 v[84:85], v[236:237], v[236:237], v[84:85]
    v_pk_add_f32 v[80:81], v[80:81], v[236:237]
    v_pk_fma_f32 v[86:87], v[238:239], v[238:239], v[86:87]
    v_pk_add_f32 v[82:83], v[82:83], v[238:239]
    v_pk_add_f32 v[80:81], v[80:81], v[82:83]
    v_pk_add_f32 v[84:85], v[84:85], v[86:87]
    v_add_f32 v80, v80, v81
    v_add_f32 v82, v84, v85
    buffer_load_dwordx4 v[64:67], v3, s[12:15], 0 offen offset:512
    v_add_f32_dpp v80, v80, v80 quad_perm:[1,0,3,2] row_mask:0xf bank_mask:0xf
    v_add_f32_dpp v82, v82, v82 quad_perm:[1,0,3,2] row_mask:0xf bank_mask:0xf
    s_nop 0
    v_add_f32_dpp v80, v80, v80 quad_perm:[2,3,0,1] row_mask:0xf bank_mask:0xf
    v_add_f32_dpp v82, v82, v82 quad_perm:[2,3,0,1] row_mask:0xf bank_mask:0xf
    s_nop 0
    v_add_f32_dpp v80, v80, v80 row_half_mirror row_mask:0xf bank_mask:0xf
    v_add_f32_dpp v82, v82, v82 row_half_mirror row_mask:0xf bank_mask:0xf
    v_mul_f32 v80, 0x3b000000, v80
    v_mul_f32 v82, 0x3b000000, v82
    v_fma_f32 v82, -v80, v80, v82
    v_max_f32 v82, 0, v82
    v_add_f32 v82, 0x3727c5ac, v82
    v_rsq_f32 v92, v82
    v_sub_f32 v94, 0, v80
    v_mov_b32 v93, v92
    v_mul_f32 v94, v94, v92
    v_mov_b32 v95, v94
    v_pk_fma_f32 v[176:177], v[176:177], v[92:93], v[94:95]
    v_pk_fma_f32 v[178:179], v[178:179], v[92:93], v[94:95]
    v_pk_fma_f32 v[180:181], v[180:181], v[92:93], v[94:95]
    v_pk_fma_f32 v[182:183], v[182:183], v[92:93], v[94:95]
    v_cvt_pk_bf16_f32 v16, v176, v177
    v_cvt_pk_bf16_f32 v17, v178, v179
    v_cvt_pk_bf16_f32 v18, v180, v181
    v_cvt_pk_bf16_f32 v19, v182, v183
    ds_write_b128 v5, v[16:19] offset:0
    v_pk_fma_f32 v[184:185], v[184:185], v[92:93], v[94:95]
    buffer_load_dwordx4 v[68:71], v3, s[12:15], 0 offen offset:640
    v_pk_fma_f32 v[186:187], v[186:187], v[92:93], v[94:95]
    v_pk_fma_f32 v[188:189], v[188:189], v[92:93], v[94:95]
    v_pk_fma_f32 v[190:191], v[190:191], v[92:93], v[94:95]
    v_cvt_pk_bf16_f32 v20, v184, v185
    v_cvt_pk_bf16_f32 v21, v186, v187
    v_cvt_pk_bf16_f32 v22, v188, v189
    v_cvt_pk_bf16_f32 v23, v190, v191
    ds_write_b128 v5, v[20:23] offset:4224
    v_pk_fma_f32 v[192:193], v[192:193], v[92:93], v[94:95]
    v_pk_fma_f32 v[194:195], v[194:195], v[92:93], v[94:95]
    v_pk_fma_f32 v[196:197], v[196:197], v[92:93], v[94:95]
    v_pk_fma_f32 v[198:199], v[198:199], v[92:93], v[94:95]
    v_cvt_pk_bf16_f32 v24, v192, v193
    v_cvt_pk_bf16_f32 v25, v194, v195
    v_cvt_pk_bf16_f32 v26, v196, v197
    v_cvt_pk_bf16_f32 v27, v198, v199
    ds_write_b128 v5, v[24:27] offset:8448
    v_pk_fma_f32 v[200:201], v[200:201], v[92:93], v[94:95]
    v_pk_fma_f32 v[202:203], v[202:203], v[92:93], v[94:95]
    v_pk_fma_f32 v[204:205], v[204:205], v[92:93], v[94:95]
    v_pk_fma_f32 v[206:207], v[206:207], v[92:93], v[94:95]
    v_cvt_pk_bf16_f32 v28, v200, v201
    v_cvt_pk_bf16_f32 v29, v202, v203
    v_cvt_pk_bf16_f32 v30, v204, v205
    v_cvt_pk_bf16_f32 v31, v206, v207
    ds_write_b128 v5, v[28:31] offset:12672
    buffer_load_dwordx4 v[72:75], v3, s[12:15], 0 offen offset:768
    v_pk_fma_f32 v[208:209], v[208:209], v[92:93], v[94:95]
    v_pk_fma_f32 v[210:211], v[210:211], v[92:93], v[94:95]
    v_pk_fma_f32 v[212:213], v[212:213], v[92:93], v[94:95]
    v_pk_fma_f32 v[214:215], v[214:215], v[92:93], v[94:95]
    v_cvt_pk_bf16_f32 v32, v208, v209
    v_cvt_pk_bf16_f32 v33, v210, v211
    v_cvt_pk_bf16_f32 v34, v212, v213
    v_cvt_pk_bf16_f32 v35, v214, v215
    ds_write_b128 v5, v[32:35] offset:16896
    v_pk_fma_f32 v[216:217], v[216:217], v[92:93], v[94:95]
    v_pk_fma_f32 v[218:219], v[218:219], v[92:93], v[94:95]
    v_pk_fma_f32 v[220:221], v[220:221], v[92:93], v[94:95]
    v_pk_fma_f32 v[222:223], v[222:223], v[92:93], v[94:95]
    v_cvt_pk_bf16_f32 v36, v216, v217
    v_cvt_pk_bf16_f32 v37, v218, v219
    v_cvt_pk_bf16_f32 v38, v220, v221
    v_cvt_pk_bf16_f32 v39, v222, v223
    ds_write_b128 v5, v[36:39] offset:21120
    v_pk_fma_f32 v[224:225], v[224:225], v[92:93], v[94:95]
    v_pk_fma_f32 v[226:227], v[226:227], v[92:93], v[94:95]
    v_pk_fma_f32 v[228:229], v[228:229], v[92:93], v[94:95]
    v_pk_fma_f32 v[230:231], v[230:231], v[92:93], v[94:95]
    v_cvt_pk_bf16_f32 v40, v224, v225
    v_cvt_pk_bf16_f32 v41, v226, v227
    v_cvt_pk_bf16_f32 v42, v228, v229
    v_cvt_pk_bf16_f32 v43, v230, v231
    buffer_load_dwordx4 v[76:79], v3, s[12:15], 0 offen offset:896
    ds_write_b128 v5, v[40:43] offset:25344
    v_pk_fma_f32 v[232:233], v[232:233], v[92:93], v[94:95]
    v_pk_fma_f32 v[234:235], v[234:235], v[92:93], v[94:95]
    v_pk_fma_f32 v[236:237], v[236:237], v[92:93], v[94:95]
    v_pk_fma_f32 v[238:239], v[238:239], v[92:93], v[94:95]
    v_cvt_pk_bf16_f32 v44, v232, v233
    v_cvt_pk_bf16_f32 v45, v234, v235
    v_cvt_pk_bf16_f32 v46, v236, v237
    v_cvt_pk_bf16_f32 v47, v238, v239
    ds_write_b128 v5, v[44:47] offset:29568
    v_add_u32 v240, 7168, v4
    v_add_u32 v241, 14336, v4
    v_add_u32 v242, 21504, v4
    s_cmp_ge_u32 s5, 2
    s_cbranch_scc1 A_wqdma
    s_waitcnt vmcnt(8) lgkmcnt(0)
    s_barrier
    s_cmp_ge_u32 s6, 2
    s_cbranch_scc1 A_wqdma
    s_cmp_eq_u32 s6, 1
    s_cbranch_scc1 A_vwave
    ds_read_b64_tr_b16 v[96:97], v8 offset:0
    ds_read_b64_tr_b16 v[98:99], v8 offset:128
    ds_read_b128 v[144:147], v6 offset:0
    ds_read_b64_tr_b16 v[100:101], v8 offset:512
    ds_read_b64_tr_b16 v[102:103], v8 offset:640
    ds_read_b128 v[148:151], v6 offset:1056
    ds_read_b64_tr_b16 v[104:105], v8 offset:1024
    ds_read_b64_tr_b16 v[106:107], v8 offset:1152
    ds_read_b128 v[152:155], v6 offset:2112
    ds_read_b64_tr_b16 v[108:109], v8 offset:1536
    ds_read_b64_tr_b16 v[110:111], v8 offset:1664
    ds_read_b128 v[156:159], v6 offset:3168
    ds_read_b64_tr_b16 v[112:113], v8 offset:2048
    ds_read_b64_tr_b16 v[114:115], v8 offset:2176
    ds_read_b128 v[160:163], v6 offset:4224
    s_waitcnt lgkmcnt(12)
    v_mfma_f32_32x32x16_bf16 v[128:143], v[96:99], v[144:147], 0
    ds_read_b64_tr_b16 v[116:117], v8 offset:2560
    ds_read_b64_tr_b16 v[118:119], v8 offset:2688
    ds_read_b128 v[164:167], v6 offset:5280
    s_waitcnt lgkmcnt(12)
    v_mfma_f32_32x32x16_bf16 v[128:143], v[100:103], v[148:151], v[128:143]
    ds_read_b64_tr_b16 v[96:97], v8 offset:3072
    ds_read_b64_tr_b16 v[98:99], v8 offset:3200
    ds_read_b128 v[144:147], v6 offset:6336
    s_waitcnt lgkmcnt(12)
    v_mfma_f32_32x32x16_bf16 v[128:143], v[104:107], v[152:155], v[128:143]
    ds_read_b64_tr_b16 v[100:101], v8 offset:3584
    ds_read_b64_tr_b16 v[102:103], v8 offset:3712
    ds_read_b128 v[148:151], v6 offset:7392
    s_waitcnt lgkmcnt(12)
    v_mfma_f32_32x32x16_bf16 v[128:143], v[108:111], v[156:159], v[128:143]
    ds_read_b64_tr_b16 v[104:105], v8 offset:4096
    ds_read_b64_tr_b16 v[106:107], v8 offset:4224
    ds_read_b128 v[152:155], v6 offset:8448
    s_waitcnt lgkmcnt(12)
    v_mfma_f32_32x32x16_bf16 v[128:143], v[112:115], v[160:163], v[128:143]
    ds_read_b64_tr_b16 v[108:109], v8 offset:4608
    ds_read_b64_tr_b16 v[110:111], v8 offset:4736
    ds_read_b128 v[156:159], v6 offset:9504
    s_waitcnt lgkmcnt(12)
    v_mfma_f32_32x32x16_bf16 v[128:143], v[116:119], v[164:167], v[128:143]
    ds_read_b64_tr_b16 v[112:113], v8 offset:5120
    ds_read_b64_tr_b16 v[114:115], v8 offset:5248
    ds_read_b128 v[160:163], v6 offset:10560
    s_waitcnt lgkmcnt(12)
    v_mfma_f32_32x32x16_bf16 v[128:143], v[96:99], v[144:147], v[128:143]
    ds_read_b64_tr_b16 v[116:117], v8 offset:5632
    ds_read_b64_tr_b16 v[118:119], v8 offset:5760
    ds_read_b128 v[164:167], v6 offset:11616
    s_waitcnt lgkmcnt(12)
    v_mfma_f32_32x32x16_bf16 v[128:143], v[100:103], v[148:151], v[128:143]
    ds_read_b64_tr_b16 v[96:97], v8 offset:6144
    ds_read_b64_tr_b16 v[98:99], v8 offset:6272
    ds_read_b128 v[144:147], v6 offset:12672
    s_waitcnt lgkmcnt(12)
    v_mfma_f32_32x32x16_bf16 v[128:143], v[104:107], v[152:155], v[128:143]
    ds_read_b64_tr_b16 v[100:101], v8 offset:6656
    ds_read_b64_tr_b16 v[102:103], v8 offset:6784
    ds_read_b128 v[148:151], v6 offset:13728
    s_waitcnt lgkmcnt(12)
    v_mfma_f32_32x32x16_bf16 v[128:143], v[108:111], v[156:159], v[128:143]
    ds_read_b64_tr_b16 v[104:105], v8 offset:7168
    ds_read_b64_tr_b16 v[106:107], v8 offset:7296
    ds_read_b128 v[152:155], v6 offset:14784
    s_waitcnt lgkmcnt(12)
    v_mfma_f32_32x32x16_bf16 v[128:143], v[112:115], v[160:163], v[128:143]
    ds_read_b64_tr_b16 v[108:109], v8 offset:7680
    ds_read_b64_tr_b16 v[110:111], v8 offset:7808
    ds_read_b128 v[156:159], v6 offset:15840
    s_waitcnt lgkmcnt(12)
    v_mfma_f32_32x32x16_bf16 v[128:143], v[116:119], v[164:167], v[128:143]
    ds_read_b64_tr_b16 v[112:113], v8 offset:8192
    ds_read_b64_tr_b16 v[114:115], v8 offset:8320
    ds_read_b128 v[160:163], v6 offset:16896
    s_waitcnt lgkmcnt(12)
    v_mfma_f32_32x32x16_bf16 v[128:143], v[96:99], v[144:147], v[128:143]
    ds_read_b64_tr_b16 v[116:117], v8 offset:8704
    ds_read_b64_tr_b16 v[118:119], v8 offset:8832
    ds_read_b128 v[164:167], v6 offset:17952
    s_waitcnt lgkmcnt(12)
    v_mfma_f32_32x32x16_bf16 v[128:143], v[100:103], v[148:151], v[128:143]
    ds_read_b64_tr_b16 v[96:97], v8 offset:9216
    ds_read_b64_tr_b16 v[98:99], v8 offset:9344
    ds_read_b128 v[144:147], v6 offset:19008
    s_waitcnt lgkmcnt(12)
    v_mfma_f32_32x32x16_bf16 v[128:143], v[104:107], v[152:155], v[128:143]
    ds_read_b64_tr_b16 v[100:101], v8 offset:9728
    ds_read_b64_tr_b16 v[102:103], v8 offset:9856
    ds_read_b128 v[148:151], v6 offset:20064
    s_waitcnt lgkmcnt(12)
    v_mfma_f32_32x32x16_bf16 v[128:143], v[108:111], v[156:159], v[128:143]
    ds_read_b64_tr_b16 v[104:105], v8 offset:10240
    ds_read_b64_tr_b16 v[106:107], v8 offset:10368
    ds_read_b128 v[152:155], v6 offset:21120
    s_waitcnt lgkmcnt(12)
    v_mfma_f32_32x32x16_bf16 v[128:143], v[112:115], v[160:163], v[128:143]
    ds_read_b64_tr_b16 v[108:109], v8 offset:10752
    ds_read_b64_tr_b16 v[110:111], v8 offset:10880
    ds_read_b128 v[156:159], v6 offset:22176
    s_waitcnt lgkmcnt(12)
    v_mfma_f32_32x32x16_bf16 v[128:143], v[116:119], v[164:167], v[128:143]
    ds_read_b64_tr_b16 v[112:113], v8 offset:11264
    ds_read_b64_tr_b16 v[114:115], v8 offset:11392
    ds_read_b128 v[160:163], v6 offset:23232
    s_waitcnt lgkmcnt(12)
    v_mfma_f32_32x32x16_bf16 v[128:143], v[96:99], v[144:147], v[128:143]
    ds_read_b64_tr_b16 v[116:117], v8 offset:11776
    ds_read_b64_tr_b16 v[118:119], v8 offset:11904
    ds_read_b128 v[164:167], v6 offset:24288
    s_waitcnt lgkmcnt(12)
    v_mfma_f32_32x32x16_bf16 v[128:143], v[100:103], v[148:151], v[128:143]
    ds_read_b64_tr_b16 v[96:97], v8 offset:12288
    ds_read_b64_tr_b16 v[98:99], v8 offset:12416
    ds_read_b128 v[144:147], v6 offset:25344
    s_waitcnt lgkmcnt(12)
    v_mfma_f32_32x32x16_bf16 v[128:143], v[104:107], v[152:155], v[128:143]
    ds_read_b64_tr_b16 v[100:101], v8 offset:12800
    ds_read_b64_tr_b16 v[102:103], v8 offset:12928
    ds_read_b128 v[148:151], v6 offset:26400
    s_waitcnt lgkmcnt(12)
    v_mfma_f32_32x32x16_bf16 v[128:143], v[108:111], v[156:159], v[128:143]
    ds_read_b64_tr_b16 v[104:105], v8 offset:13312
    ds_read_b64_tr_b16 v[106:107], v8 offset:13440
    ds_read_b128 v[152:155], v6 offset:27456
    s_waitcnt lgkmcnt(12)
    v_mfma_f32_32x32x16_bf16 v[128:143], v[112:115], v[160:163], v[128:143]
    ds_read_b64_tr_b16 v[108:109], v8 offset:13824
    ds_read_b64_tr_b16 v[110:111], v8 offset:13952
    ds_read_b128 v[156:159], v6 offset:28512
    s_waitcnt lgkmcnt(12)
    v_mfma_f32_32x32x16_bf16 v[128:143], v[116:119], v[164:167], v[128:143]
    ds_read_b64_tr_b16 v[112:113], v8 offset:14336
    ds_read_b64_tr_b16 v[114:115], v8 offset:14464
    ds_read_b128 v[160:163], v6 offset:29568
    s_waitcnt lgkmcnt(12)
    v_mfma_f32_32x32x16_bf16 v[128:143], v[96:99], v[144:147], v[128:143]
    ds_read_b64_tr_b16 v[116:117], v8 offset:14848
    ds_read_b64_tr_b16 v[118:119], v8 offset:14976
    ds_read_b128 v[164:167], v6 offset:30624
    s_waitcnt lgkmcnt(12)
    v_mfma_f32_32x32x16_bf16 v[128:143], v[100:103], v[148:151], v[128:143]
    ds_read_b64_tr_b16 v[96:97], v8 offset:15360
    ds_read_b64_tr_b16 v[98:99], v8 offset:15488
    ds_read_b128 v[144:147], v6 offset:31680
    s_waitcnt lgkmcnt(12)
    v_mfma_f32_32x32x16_bf16 v[128:143], v[104:107], v[152:155], v[128:143]
    ds_read_b64_tr_b16 v[100:101], v8 offset:15872
    ds_read_b64_tr_b16 v[102:103], v8 offset:16000
    ds_read_b128 v[148:151], v6 offset:32736
    s_waitcnt lgkmcnt(12)
    v_mfma_f32_32x32x16_bf16 v[128:143], v[108:111], v[156:159], v[128:143]
    s_waitcnt lgkmcnt(9)
    v_mfma_f32_32x32x16_bf16 v[128:143], v[112:115], v[160:163], v[128:143]
    s_waitcnt lgkmcnt(6)
    v_mfma_f32_32x32x16_bf16 v[128:143], v[116:119], v[164:167], v[128:143]
    s_waitcnt lgkmcnt(3)
    v_mfma_f32_32x32x16_bf16 v[128:143], v[96:99], v[144:147], v[128:143]
    s_waitcnt lgkmcnt(0)
    v_mfma_f32_32x32x16_bf16 v[128:143], v[100:103], v[148:151], v[128:143]
    s_nop 11
    v_cvt_pk_bf16_f32 v88, v128, v129
    v_cvt_pk_bf16_f32 v89, v130, v131
    v_cvt_pk_bf16_f32 v90, v132, v133
    v_cvt_pk_bf16_f32 v91, v134, v135
    s_lshl_b32 s3, s60, 10
    s_add_u32 s3, s3, 2097152
    buffer_store_dwordx4 v[88:91], v9, s[8:11], s3 offen sc1
    v_mul_f32 v84, v128, v128
    v_fmac_f32 v84, v129, v129
    v_fmac_f32 v84, v130, v130
    v_fmac_f32 v84, v131, v131
    v_fmac_f32 v84, v132, v132
    v_fmac_f32 v84, v133, v133
    v_fmac_f32 v84, v134, v134
    v_fmac_f32 v84, v135, v135
    v_mov_b32 v85, v84
    s_nop 1
    v_permlane32_swap_b32 v84, v85
    v_add_f32 v84, v84, v85
    s_nop 1
    v_max_f32_dpp v84, v84, v84 row_ror:8 row_mask:0xf bank_mask:0xf
    s_nop 1
    v_max_f32_dpp v84, v84, v84 row_ror:4 row_mask:0xf bank_mask:0xf
    s_nop 1
    v_max_f32_dpp v84, v84, v84 row_ror:2 row_mask:0xf bank_mask:0xf
    s_nop 1
    v_max_f32_dpp v84, v84, v84 row_ror:1 row_mask:0xf bank_mask:0xf
    s_nop 0
    v_readlane_b32 s3, v84, 0
    v_readlane_b32 s7, v84, 16
    s_nop 0
    s_max_u32 s3, s3, s7
    v_mov_b32 v84, s3
    s_lshl_b32 s7, s60, 7
    s_add_u32 s7, s7, 2293760
    v_lshlrev_b32 v85, 2, v0
    s_mov_b32 exec_hi, 0
    buffer_store_dword v84, v85, s[8:11], s7 offen sc1
    s_mov_b64 exec, -1
    s_waitcnt vmcnt(2)
    s_lshl_b32 s3, s60, 12
    s_add_u32 s3, s3, 7340032
    v_mov_b32 v120, -1
    v_mov_b32 v121, -1
    v_mov_b32 v122, -1
    v_mov_b32 v123, -1
    buffer_store_dwordx4 v[120:123], v9, s[8:11], s3 offen sc1
    buffer_store_dwordx4 v[120:123], v9, s[8:11], s3 offen offset:1024 sc1
    s_branch A_kvdone
A_vwave:
    v_and_b32 v84, 3, v0
    v_bfe_u32 v85, v0, 2, 1
    v_lshl_add_u32 v84, v85, 3, v84
    v_bfe_u32 v85, v0, 3, 1
    v_lshl_add_u32 v84, v85, 2, v84
    v_and_b32 v85, 16, v0
    v_add_u32 v84, v84, v85
    v_lshrrev_b32 v85, 5, v0
    v_mul_u32_u24 v85, 528, v85
    v_lshl_add_u32 v86, v84, 4, v85
    ds_read_b64_tr_b16 v[96:97], v8 offset:0
    ds_read_b64_tr_b16 v[98:99], v8 offset:128
    ds_read_b128 v[144:147], v86 offset:0
    ds_read_b64_tr_b16 v[100:101], v8 offset:512
    ds_read_b64_tr_b16 v[102:103], v8 offset:640
    ds_read_b128 v[148:151], v86 offset:1056
    ds_read_b64_tr_b16 v[104:105], v8 offset:1024
    ds_read_b64_tr_b16 v[106:107], v8 offset:1152
    ds_read_b128 v[152:155], v86 offset:2112
    ds_read_b64_tr_b16 v[108:109], v8 offset:1536
    ds_read_b64_tr_b16 v[110:111], v8 offset:1664
    ds_read_b128 v[156:159], v86 offset:3168
    ds_read_b64_tr_b16 v[112:113], v8 offset:2048
    ds_read_b64_tr_b16 v[114:115], v8 offset:2176
    ds_read_b128 v[160:163], v86 offset:4224
    s_waitcnt lgkmcnt(12)
    v_mfma_f32_32x32x16_bf16 v[128:143], v[144:147], v[96:99], 0
    ds_read_b64_tr_b16 v[116:117], v8 offset:2560
    ds_read_b64_tr_b16 v[118:119], v8 offset:2688
    ds_read_b128 v[164:167], v86 offset:5280
    s_waitcnt lgkmcnt(12)
    v_mfma_f32_32x32x16_bf16 v[128:143], v[148:151], v[100:103], v[128:143]
    ds_read_b64_tr_b16 v[96:97], v8 offset:3072
    ds_read_b64_tr_b16 v[98:99], v8 offset:3200
    ds_read_b128 v[144:147], v86 offset:6336
    s_waitcnt lgkmcnt(12)
    v_mfma_f32_32x32x16_bf16 v[128:143], v[152:155], v[104:107], v[128:143]
    ds_read_b64_tr_b16 v[100:101], v8 offset:3584
    ds_read_b64_tr_b16 v[102:103], v8 offset:3712
    ds_read_b128 v[148:151], v86 offset:7392
    s_waitcnt lgkmcnt(12)
    v_mfma_f32_32x32x16_bf16 v[128:143], v[156:159], v[108:111], v[128:143]
    ds_read_b64_tr_b16 v[104:105], v8 offset:4096
    ds_read_b64_tr_b16 v[106:107], v8 offset:4224
    ds_read_b128 v[152:155], v86 offset:8448
    s_waitcnt lgkmcnt(12)
    v_mfma_f32_32x32x16_bf16 v[128:143], v[160:163], v[112:115], v[128:143]
    ds_read_b64_tr_b16 v[108:109], v8 offset:4608
    ds_read_b64_tr_b16 v[110:111], v8 offset:4736
    ds_read_b128 v[156:159], v86 offset:9504
    s_waitcnt lgkmcnt(12)
    v_mfma_f32_32x32x16_bf16 v[128:143], v[164:167], v[116:119], v[128:143]
    ds_read_b64_tr_b16 v[112:113], v8 offset:5120
    ds_read_b64_tr_b16 v[114:115], v8 offset:5248
    ds_read_b128 v[160:163], v86 offset:10560
    s_waitcnt lgkmcnt(12)
    v_mfma_f32_32x32x16_bf16 v[128:143], v[144:147], v[96:99], v[128:143]
    ds_read_b64_tr_b16 v[116:117], v8 offset:5632
    ds_read_b64_tr_b16 v[118:119], v8 offset:5760
    ds_read_b128 v[164:167], v86 offset:11616
    s_waitcnt lgkmcnt(12)
    v_mfma_f32_32x32x16_bf16 v[128:143], v[148:151], v[100:103], v[128:143]
    ds_read_b64_tr_b16 v[96:97], v8 offset:6144
    ds_read_b64_tr_b16 v[98:99], v8 offset:6272
    ds_read_b128 v[144:147], v86 offset:12672
    s_waitcnt lgkmcnt(12)
    v_mfma_f32_32x32x16_bf16 v[128:143], v[152:155], v[104:107], v[128:143]
    ds_read_b64_tr_b16 v[100:101], v8 offset:6656
    ds_read_b64_tr_b16 v[102:103], v8 offset:6784
    ds_read_b128 v[148:151], v86 offset:13728
    s_waitcnt lgkmcnt(12)
    v_mfma_f32_32x32x16_bf16 v[128:143], v[156:159], v[108:111], v[128:143]
    ds_read_b64_tr_b16 v[104:105], v8 offset:7168
    ds_read_b64_tr_b16 v[106:107], v8 offset:7296
    ds_read_b128 v[152:155], v86 offset:14784
    s_waitcnt lgkmcnt(12)
    v_mfma_f32_32x32x16_bf16 v[128:143], v[160:163], v[112:115], v[128:143]
    ds_read_b64_tr_b16 v[108:109], v8 offset:7680
    ds_read_b64_tr_b16 v[110:111], v8 offset:7808
    ds_read_b128 v[156:159], v86 offset:15840
    s_waitcnt lgkmcnt(12)
    v_mfma_f32_32x32x16_bf16 v[128:143], v[164:167], v[116:119], v[128:143]
    ds_read_b64_tr_b16 v[112:113], v8 offset:8192
    ds_read_b64_tr_b16 v[114:115], v8 offset:8320
    ds_read_b128 v[160:163], v86 offset:16896
    s_waitcnt lgkmcnt(12)
    v_mfma_f32_32x32x16_bf16 v[128:143], v[144:147], v[96:99], v[128:143]
    ds_read_b64_tr_b16 v[116:117], v8 offset:8704
    ds_read_b64_tr_b16 v[118:119], v8 offset:8832
    ds_read_b128 v[164:167], v86 offset:17952
    s_waitcnt lgkmcnt(12)
    v_mfma_f32_32x32x16_bf16 v[128:143], v[148:151], v[100:103], v[128:143]
    ds_read_b64_tr_b16 v[96:97], v8 offset:9216
    ds_read_b64_tr_b16 v[98:99], v8 offset:9344
    ds_read_b128 v[144:147], v86 offset:19008
    s_waitcnt lgkmcnt(12)
    v_mfma_f32_32x32x16_bf16 v[128:143], v[152:155], v[104:107], v[128:143]
    ds_read_b64_tr_b16 v[100:101], v8 offset:9728
    ds_read_b64_tr_b16 v[102:103], v8 offset:9856
    ds_read_b128 v[148:151], v86 offset:20064
    s_waitcnt lgkmcnt(12)
    v_mfma_f32_32x32x16_bf16 v[128:143], v[156:159], v[108:111], v[128:143]
    ds_read_b64_tr_b16 v[104:105], v8 offset:10240
    ds_read_b64_tr_b16 v[106:107], v8 offset:10368
    ds_read_b128 v[152:155], v86 offset:21120
    s_waitcnt lgkmcnt(12)
    v_mfma_f32_32x32x16_bf16 v[128:143], v[160:163], v[112:115], v[128:143]
    ds_read_b64_tr_b16 v[108:109], v8 offset:10752
    ds_read_b64_tr_b16 v[110:111], v8 offset:10880
    ds_read_b128 v[156:159], v86 offset:22176
    s_waitcnt lgkmcnt(12)
    v_mfma_f32_32x32x16_bf16 v[128:143], v[164:167], v[116:119], v[128:143]
    ds_read_b64_tr_b16 v[112:113], v8 offset:11264
    ds_read_b64_tr_b16 v[114:115], v8 offset:11392
    ds_read_b128 v[160:163], v86 offset:23232
    s_waitcnt lgkmcnt(12)
    v_mfma_f32_32x32x16_bf16 v[128:143], v[144:147], v[96:99], v[128:143]
    ds_read_b64_tr_b16 v[116:117], v8 offset:11776
    ds_read_b64_tr_b16 v[118:119], v8 offset:11904
    ds_read_b128 v[164:167], v86 offset:24288
    s_waitcnt lgkmcnt(12)
    v_mfma_f32_32x32x16_bf16 v[128:143], v[148:151], v[100:103], v[128:143]
    ds_read_b64_tr_b16 v[96:97], v8 offset:12288
    ds_read_b64_tr_b16 v[98:99], v8 offset:12416
    ds_read_b128 v[144:147], v86 offset:25344
    s_waitcnt lgkmcnt(12)
    v_mfma_f32_32x32x16_bf16 v[128:143], v[152:155], v[104:107], v[128:143]
    ds_read_b64_tr_b16 v[100:101], v8 offset:12800
    ds_read_b64_tr_b16 v[102:103], v8 offset:12928
    ds_read_b128 v[148:151], v86 offset:26400
    s_waitcnt lgkmcnt(12)
    v_mfma_f32_32x32x16_bf16 v[128:143], v[156:159], v[108:111], v[128:143]
    ds_read_b64_tr_b16 v[104:105], v8 offset:13312
    ds_read_b64_tr_b16 v[106:107], v8 offset:13440
    ds_read_b128 v[152:155], v86 offset:27456
    s_waitcnt lgkmcnt(12)
    v_mfma_f32_32x32x16_bf16 v[128:143], v[160:163], v[112:115], v[128:143]
    ds_read_b64_tr_b16 v[108:109], v8 offset:13824
    ds_read_b64_tr_b16 v[110:111], v8 offset:13952
    ds_read_b128 v[156:159], v86 offset:28512
    s_waitcnt lgkmcnt(12)
    v_mfma_f32_32x32x16_bf16 v[128:143], v[164:167], v[116:119], v[128:143]
    ds_read_b64_tr_b16 v[112:113], v8 offset:14336
    ds_read_b64_tr_b16 v[114:115], v8 offset:14464
    ds_read_b128 v[160:163], v86 offset:29568
    s_waitcnt lgkmcnt(12)
    v_mfma_f32_32x32x16_bf16 v[128:143], v[144:147], v[96:99], v[128:143]
    ds_read_b64_tr_b16 v[116:117], v8 offset:14848
    ds_read_b64_tr_b16 v[118:119], v8 offset:14976
    ds_read_b128 v[164:167], v86 offset:30624
    s_waitcnt lgkmcnt(12)
    v_mfma_f32_32x32x16_bf16 v[128:143], v[148:151], v[100:103], v[128:143]
    ds_read_b64_tr_b16 v[96:97], v8 offset:15360
    ds_read_b64_tr_b16 v[98:99], v8 offset:15488
    ds_read_b128 v[144:147], v86 offset:31680
    s_waitcnt lgkmcnt(12)
    v_mfma_f32_32x32x16_bf16 v[128:143], v[152:155], v[104:107], v[128:143]
    ds_read_b64_tr_b16 v[100:101], v8 offset:15872
    ds_read_b64_tr_b16 v[102:103], v8 offset:16000
    ds_read_b128 v[148:151], v86 offset:32736
    s_waitcnt lgkmcnt(12)
    v_mfma_f32_32x32x16_bf16 v[128:143], v[156:159], v[108:111], v[128:143]
    s_waitcnt lgkmcnt(9)
    v_mfma_f32_32x32x16_bf16 v[128:143], v[160:163], v[112:115], v[128:143]
    s_waitcnt lgkmcnt(6)
    v_mfma_f32_32x32x16_bf16 v[128:143], v[164:167], v[116:119], v[128:143]
    s_waitcnt lgkmcnt(3)
    v_mfma_f32_32x32x16_bf16 v[128:143], v[144:147], v[96:99], v[128:143]
    s_waitcnt lgkmcnt(0)
    v_mfma_f32_32x32x16_bf16 v[128:143], v[148:151], v[100:103], v[128:143]
    s_nop 11
    v_cvt_pk_bf16_f32 v88, v128, v129
    v_cvt_pk_bf16_f32 v89, v130, v131
    v_cvt_pk_bf16_f32 v90, v132, v133
    v_cvt_pk_bf16_f32 v91, v134, v135
    v_cvt_pk_bf16_f32 v92, v136, v137
    v_cvt_pk_bf16_f32 v93, v138, v139
    v_cvt_pk_bf16_f32 v94, v140, v141
    v_cvt_pk_bf16_f32 v95, v142, v143
    v_xor_b32 v84, 256, v9
    s_lshl_b32 s3, s60, 11
    s_add_u32 s3, s3, 2162688
    s_mov_b32 exec_lo, 0xffff0000
    s_mov_b32 exec_hi, 0xffff0000
    buffer_store_dwordx4 v[88:91], v84, s[8:11], s3 offen sc1
    buffer_store_dwordx4 v[92:95], v84, s[8:11], s3 offen offset:1024 sc1
    s_mov_b64 exec, -1
    s_waitcnt vmcnt(2)
    s_lshl_b32 s3, s60, 12
    s_add_u32 s3, s3, 7342080
    v_mov_b32 v120, -1
    v_mov_b32 v121, -1
    v_mov_b32 v122, -1
    v_mov_b32 v123, -1
    buffer_store_dwordx4 v[120:123], v9, s[8:11], s3 offen sc1
    buffer_store_dwordx4 v[120:123], v9, s[8:11], s3 offen offset:1024 sc1
    s_branch A_kvdone
A_wqdma:
    s_waitcnt vmcnt(0)
A_wqloop:
    s_mov_b32 m0, s76
    s_nop 0
    buffer_load_dwordx4 v4, s[16:19], s75 offen offset:0 lds
    buffer_load_dwordx4 v240, s[16:19], s75 offen offset:1024 lds
    buffer_load_dwordx4 v241, s[16:19], s75 offen offset:2048 lds
    buffer_load_dwordx4 v242, s[16:19], s75 offen offset:3072 lds
    s_add_u32 s76, s76, 4096
    s_add_u32 s75, s75, 32768
    s_sub_u32 s77, s77, 1
    s_cmp_lg_u32 s77, 0
    s_cbranch_scc1 A_wqloop
A_kvdone:
    v_lshlrev_b32 v176, 16, v48
    v_and_b32 v177, 0xffff0000, v48
    v_lshlrev_b32 v178, 16, v49
    v_and_b32 v179, 0xffff0000, v49
    v_pk_mul_f32 v[84:85], v[176:177], v[176:177]
    v_lshlrev_b32 v180, 16, v50
    v_and_b32 v181, 0xffff0000, v50
    v_pk_mul_f32 v[86:87], v[178:179], v[178:179]
    v_lshlrev_b32 v182, 16, v51
    v_and_b32 v183, 0xffff0000, v51
    v_pk_fma_f32 v[84:85], v[180:181], v[180:181], v[84:85]
    v_pk_add_f32 v[80:81], v[176:177], v[180:181]
    v_lshlrev_b32 v184, 16, v52
    v_and_b32 v185, 0xffff0000, v52
    v_pk_fma_f32 v[86:87], v[182:183], v[182:183], v[86:87]
    v_pk_add_f32 v[82:83], v[178:179], v[182:183]
    v_lshlrev_b32 v186, 16, v53
    v_and_b32 v187, 0xffff0000, v53
    v_pk_fma_f32 v[84:85], v[184:185], v[184:185], v[84:85]
    v_pk_add_f32 v[80:81], v[80:81], v[184:185]
    v_lshlrev_b32 v188, 16, v54
    v_and_b32 v189, 0xffff0000, v54
    v_pk_fma_f32 v[86:87], v[186:187], v[186:187], v[86:87]
    v_pk_add_f32 v[82:83], v[82:83], v[186:187]
    v_lshlrev_b32 v190, 16, v55
    v_and_b32 v191, 0xffff0000, v55
    v_pk_fma_f32 v[84:85], v[188:189], v[188:189], v[84:85]
    v_pk_add_f32 v[80:81], v[80:81], v[188:189]
    v_lshlrev_b32 v192, 16, v56
    v_and_b32 v193, 0xffff0000, v56
    v_pk_fma_f32 v[86:87], v[190:191], v[190:191], v[86:87]
    v_pk_add_f32 v[82:83], v[82:83], v[190:191]
    v_lshlrev_b32 v194, 16, v57
    v_and_b32 v195, 0xffff0000, v57
    v_pk_fma_f32 v[84:85], v[192:193], v[192:193], v[84:85]
    v_pk_add_f32 v[80:81], v[80:81], v[192:193]
    v_lshlrev_b32 v196, 16, v58
    v_and_b32 v197, 0xffff0000, v58
    v_pk_fma_f32 v[86:87], v[194:195], v[194:195], v[86:87]
    v_pk_add_f32 v[82:83], v[82:83], v[194:195]
    v_lshlrev_b32 v198, 16, v59
    v_and_b32 v199, 0xffff0000, v59
    v_pk_fma_f32 v[84:85], v[196:197], v[196:197], v[84:85]
    v_pk_add_f32 v[80:81], v[80:81], v[196:197]
    v_lshlrev_b32 v200, 16, v60
    v_and_b32 v201, 0xffff0000, v60
    v_pk_fma_f32 v[86:87], v[198:199], v[198:199], v[86:87]
    v_pk_add_f32 v[82:83], v[82:83], v[198:199]
    v_lshlrev_b32 v202, 16, v61
    v_and_b32 v203, 0xffff0000, v61
    v_pk_fma_f32 v[84:85], v[200:201], v[200:201], v[84:85]
    v_pk_add_f32 v[80:81], v[80:81], v[200:201]
    v_lshlrev_b32 v204, 16, v62
    v_and_b32 v205, 0xffff0000, v62
    v_pk_fma_f32 v[86:87], v[202:203], v[202:203], v[86:87]
    v_pk_add_f32 v[82:83], v[82:83], v[202:203]
    v_lshlrev_b32 v206, 16, v63
    v_and_b32 v207, 0xffff0000, v63
    v_pk_fma_f32 v[84:85], v[204:205], v[204:205], v[84:85]
    v_pk_add_f32 v[80:81], v[80:81], v[204:205]
    v_lshlrev_b32 v208, 16, v64
    v_and_b32 v209, 0xffff0000, v64
    v_pk_fma_f32 v[86:87], v[206:207], v[206:207], v[86:87]
    v_pk_add_f32 v[82:83], v[82:83], v[206:207]
    v_lshlrev_b32 v210, 16, v65
    v_and_b32 v211, 0xffff0000, v65
    v_pk_fma_f32 v[84:85], v[208:209], v[208:209], v[84:85]
    v_pk_add_f32 v[80:81], v[80:81], v[208:209]
    v_lshlrev_b32 v212, 16, v66
    v_and_b32 v213, 0xffff0000, v66
    v_pk_fma_f32 v[86:87], v[210:211], v[210:211], v[86:87]
    v_pk_add_f32 v[82:83], v[82:83], v[210:211]
    v_lshlrev_b32 v214, 16, v67
    v_and_b32 v215, 0xffff0000, v67
    v_pk_fma_f32 v[84:85], v[212:213], v[212:213], v[84:85]
    v_pk_add_f32 v[80:81], v[80:81], v[212:213]
    v_lshlrev_b32 v216, 16, v68
    v_and_b32 v217, 0xffff0000, v68
    v_pk_fma_f32 v[86:87], v[214:215], v[214:215], v[86:87]
    v_pk_add_f32 v[82:83], v[82:83], v[214:215]
    v_lshlrev_b32 v218, 16, v69
    v_and_b32 v219, 0xffff0000, v69
    v_pk_fma_f32 v[84:85], v[216:217], v[216:217], v[84:85]
    v_pk_add_f32 v[80:81], v[80:81], v[216:217]
    v_lshlrev_b32 v220, 16, v70
    v_and_b32 v221, 0xffff0000, v70
    v_pk_fma_f32 v[86:87], v[218:219], v[218:219], v[86:87]
    v_pk_add_f32 v[82:83], v[82:83], v[218:219]
    v_lshlrev_b32 v222, 16, v71
    v_and_b32 v223, 0xffff0000, v71
    v_pk_fma_f32 v[84:85], v[220:221], v[220:221], v[84:85]
    v_pk_add_f32 v[80:81], v[80:81], v[220:221]
    v_lshlrev_b32 v224, 16, v72
    v_and_b32 v225, 0xffff0000, v72
    v_pk_fma_f32 v[86:87], v[222:223], v[222:223], v[86:87]
    v_pk_add_f32 v[82:83], v[82:83], v[222:223]
    v_lshlrev_b32 v226, 16, v73
    v_and_b32 v227, 0xffff0000, v73
    v_pk_fma_f32 v[84:85], v[224:225], v[224:225], v[84:85]
    v_pk_add_f32 v[80:81], v[80:81], v[224:225]
    v_lshlrev_b32 v228, 16, v74
    v_and_b32 v229, 0xffff0000, v74
    v_pk_fma_f32 v[86:87], v[226:227], v[226:227], v[86:87]
    v_pk_add_f32 v[82:83], v[82:83], v[226:227]
    v_lshlrev_b32 v230, 16, v75
    v_and_b32 v231, 0xffff0000, v75
    v_pk_fma_f32 v[84:85], v[228:229], v[228:229], v[84:85]
    v_pk_add_f32 v[80:81], v[80:81], v[228:229]
    v_lshlrev_b32 v232, 16, v76
    v_and_b32 v233, 0xffff0000, v76
    v_pk_fma_f32 v[86:87], v[230:231], v[230:231], v[86:87]
    v_pk_add_f32 v[82:83], v[82:83], v[230:231]
    v_lshlrev_b32 v234, 16, v77
    v_and_b32 v235, 0xffff0000, v77
    v_pk_fma_f32 v[84:85], v[232:233], v[232:233], v[84:85]
    v_pk_add_f32 v[80:81], v[80:81], v[232:233]
    v_lshlrev_b32 v236, 16, v78
    v_and_b32 v237, 0xffff0000, v78
    v_pk_fma_f32 v[86:87], v[234:235], v[234:235], v[86:87]
    v_pk_add_f32 v[82:83], v[82:83], v[234:235]
    v_lshlrev_b32 v238, 16, v79
    v_and_b32 v239, 0xffff0000, v79
    v_pk_fma_f32 v[84:85], v[236:237], v[236:237], v[84:85]
    v_pk_add_f32 v[80:81], v[80:81], v[236:237]
    v_pk_fma_f32 v[86:87], v[238:239], v[238:239], v[86:87]
    v_pk_add_f32 v[82:83], v[82:83], v[238:239]
    v_pk_add_f32 v[80:81], v[80:81], v[82:83]
    v_pk_add_f32 v[84:85], v[84:85], v[86:87]
    v_add_f32 v80, v80, v81
    v_add_f32 v82, v84, v85
    s_nop 0
    v_add_f32_dpp v80, v80, v80 quad_perm:[1,0,3,2] row_mask:0xf bank_mask:0xf
    v_add_f32_dpp v82, v82, v82 quad_perm:[1,0,3,2] row_mask:0xf bank_mask:0xf
    s_nop 0
    v_add_f32_dpp v80, v80, v80 quad_perm:[2,3,0,1] row_mask:0xf bank_mask:0xf
    v_add_f32_dpp v82, v82, v82 quad_perm:[2,3,0,1] row_mask:0xf bank_mask:0xf
    s_nop 0
    v_add_f32_dpp v80, v80, v80 row_half_mirror row_mask:0xf bank_mask:0xf
    v_add_f32_dpp v82, v82, v82 row_half_mirror row_mask:0xf bank_mask:0xf
    v_mul_f32 v80, 0x3b000000, v80
    v_mul_f32 v82, 0x3b000000, v82
    v_fma_f32 v82, -v80, v80, v82
    v_max_f32 v82, 0, v82
    v_add_f32 v82, 0x3727c5ac, v82
    v_rsq_f32 v92, v82
    v_sub_f32 v94, 0, v80
    v_mov_b32 v93, v92
    v_mul_f32 v94, v94, v92
    v_mov_b32 v95, v94
    v_pk_fma_f32 v[176:177], v[176:177], v[92:93], v[94:95]
    v_pk_fma_f32 v[178:179], v[178:179], v[92:93], v[94:95]
    v_pk_fma_f32 v[180:181], v[180:181], v[92:93], v[94:95]
    v_pk_fma_f32 v[182:183], v[182:183], v[92:93], v[94:95]
    v_cvt_pk_bf16_f32 v48, v176, v177
    v_cvt_pk_bf16_f32 v49, v178, v179
    v_cvt_pk_bf16_f32 v50, v180, v181
    v_cvt_pk_bf16_f32 v51, v182, v183
    v_pk_fma_f32 v[184:185], v[184:185], v[92:93], v[94:95]
    v_pk_fma_f32 v[186:187], v[186:187], v[92:93], v[94:95]
    v_pk_fma_f32 v[188:189], v[188:189], v[92:93], v[94:95]
    v_pk_fma_f32 v[190:191], v[190:191], v[92:93], v[94:95]
    v_cvt_pk_bf16_f32 v52, v184, v185
    v_cvt_pk_bf16_f32 v53, v186, v187
    v_cvt_pk_bf16_f32 v54, v188, v189
    v_cvt_pk_bf16_f32 v55, v190, v191
    v_pk_fma_f32 v[192:193], v[192:193], v[92:93], v[94:95]
    v_pk_fma_f32 v[194:195], v[194:195], v[92:93], v[94:95]
    v_pk_fma_f32 v[196:197], v[196:197], v[92:93], v[94:95]
    v_pk_fma_f32 v[198:199], v[198:199], v[92:93], v[94:95]
    v_cvt_pk_bf16_f32 v56, v192, v193
    v_cvt_pk_bf16_f32 v57, v194, v195
    v_cvt_pk_bf16_f32 v58, v196, v197
    v_cvt_pk_bf16_f32 v59, v198, v199
    v_pk_fma_f32 v[200:201], v[200:201], v[92:93], v[94:95]
    v_pk_fma_f32 v[202:203], v[202:203], v[92:93], v[94:95]
    v_pk_fma_f32 v[204:205], v[204:205], v[92:93], v[94:95]
    v_pk_fma_f32 v[206:207], v[206:207], v[92:93], v[94:95]
    v_cvt_pk_bf16_f32 v60, v200, v201
    v_cvt_pk_bf16_f32 v61, v202, v203
    v_cvt_pk_bf16_f32 v62, v204, v205
    v_cvt_pk_bf16_f32 v63, v206, v207
    v_pk_fma_f32 v[208:209], v[208:209], v[92:93], v[94:95]
    v_pk_fma_f32 v[210:211], v[210:211], v[92:93], v[94:95]
    v_pk_fma_f32 v[212:213], v[212:213], v[92:93], v[94:95]
    v_pk_fma_f32 v[214:215], v[214:215], v[92:93], v[94:95]
    v_cvt_pk_bf16_f32 v64, v208, v209
    v_cvt_pk_bf16_f32 v65, v210, v211
    v_cvt_pk_bf16_f32 v66, v212, v213
    v_cvt_pk_bf16_f32 v67, v214, v215
    v_pk_fma_f32 v[216:217], v[216:217], v[92:93], v[94:95]
    v_pk_fma_f32 v[218:219], v[218:219], v[92:93], v[94:95]
    v_pk_fma_f32 v[220:221], v[220:221], v[92:93], v[94:95]
    v_pk_fma_f32 v[222:223], v[222:223], v[92:93], v[94:95]
    v_cvt_pk_bf16_f32 v68, v216, v217
    v_cvt_pk_bf16_f32 v69, v218, v219
    v_cvt_pk_bf16_f32 v70, v220, v221
    v_cvt_pk_bf16_f32 v71, v222, v223
    v_pk_fma_f32 v[224:225], v[224:225], v[92:93], v[94:95]
    v_pk_fma_f32 v[226:227], v[226:227], v[92:93], v[94:95]
    v_pk_fma_f32 v[228:229], v[228:229], v[92:93], v[94:95]
    v_pk_fma_f32 v[230:231], v[230:231], v[92:93], v[94:95]
    v_cvt_pk_bf16_f32 v72, v224, v225
    v_cvt_pk_bf16_f32 v73, v226, v227
    v_cvt_pk_bf16_f32 v74, v228, v229
    v_cvt_pk_bf16_f32 v75, v230, v231
    v_pk_fma_f32 v[232:233], v[232:233], v[92:93], v[94:95]
    v_pk_fma_f32 v[234:235], v[234:235], v[92:93], v[94:95]
    v_pk_fma_f32 v[236:237], v[236:237], v[92:93], v[94:95]
    v_pk_fma_f32 v[238:239], v[238:239], v[92:93], v[94:95]
    v_cvt_pk_bf16_f32 v76, v232, v233
    v_cvt_pk_bf16_f32 v77, v234, v235
    v_cvt_pk_bf16_f32 v78, v236, v237
    v_cvt_pk_bf16_f32 v79, v238, v239
    s_cmp_ge_u32 s5, 2
    s_cbranch_scc1 A_nosig
    s_cmp_ge_u32 s6, 2
    s_cbranch_scc1 A_nosig2
    s_waitcnt vmcnt(0)
    s_barrier
    s_cmp_lg_u32 s6, 0
    s_cbranch_scc1 A_nosig3
    s_lshr_b32 s3, s60, 5
    s_lshl_b32 s3, s3, 6
    v_mov_b32 v85, s3
    v_mov_b32 v243, 1
    s_mov_b64 exec, 1
    buffer_atomic_add v243, v85, s[56:59], 0 offen sc0 sc1
    s_mov_b64 exec, -1
A_nosig3:
    ds_write_b128 v5, v[48:51] offset:33792
    ds_write_b128 v5, v[52:55] offset:38016
    ds_write_b128 v5, v[56:59] offset:42240
    ds_write_b128 v5, v[60:63] offset:46464
    ds_write_b128 v5, v[64:67] offset:50688
    ds_write_b128 v5, v[68:71] offset:54912
    ds_write_b128 v5, v[72:75] offset:59136
    ds_write_b128 v5, v[76:79] offset:63360
    s_branch A_lnbw
A_nosig2:
    s_barrier
A_nosig:
    ds_write_b128 v5, v[48:51] offset:33792
    ds_write_b128 v5, v[52:55] offset:38016
    ds_write_b128 v5, v[56:59] offset:42240
    ds_write_b128 v5, v[60:63] offset:46464
    ds_write_b128 v5, v[64:67] offset:50688
    ds_write_b128 v5, v[68:71] offset:54912
    ds_write_b128 v5, v[72:75] offset:59136
    ds_write_b128 v5, v[76:79] offset:63360
    s_waitcnt vmcnt(0)
A_lnbw:
    s_waitcnt lgkmcnt(0)
    s_barrier
    s_lshr_b32 s3, s6, 1
    s_mul_i32 s7, s3, 33792
    v_add_u32 v6, s7, v6
    ds_read_b64_tr_b16 v[96:97], v7 offset:0
    ds_read_b64_tr_b16 v[98:99], v7 offset:512
    ds_read_b128 v[144:147], v6 offset:0
    ds_read_b64_tr_b16 v[100:101], v7 offset:2048
    ds_read_b64_tr_b16 v[102:103], v7 offset:2560
    ds_read_b128 v[148:151], v6 offset:1056
    ds_read_b64_tr_b16 v[104:105], v7 offset:4096
    ds_read_b64_tr_b16 v[106:107], v7 offset:4608
    ds_read_b128 v[152:155], v6 offset:2112
    ds_read_b64_tr_b16 v[108:109], v7 offset:6144
    ds_read_b64_tr_b16 v[110:111], v7 offset:6656
    ds_read_b128 v[156:159], v6 offset:3168
    ds_read_b64_tr_b16 v[112:113], v7 offset:8192
    ds_read_b64_tr_b16 v[114:115], v7 offset:8704
    ds_read_b128 v[160:163], v6 offset:4224
    s_waitcnt lgkmcnt(12)
    v_mfma_f32_32x32x16_bf16 v[128:143], v[96:99], v[144:147], 0
    v_mov_b32 v64, 0
    v_mov_b32 v80, 0
    ds_read_b64_tr_b16 v[116:117], v7 offset:10240
    ds_read_b64_tr_b16 v[118:119], v7 offset:10752
    ds_read_b128 v[164:167], v6 offset:5280
    s_waitcnt lgkmcnt(12)
    v_mfma_f32_32x32x16_bf16 v[128:143], v[100:103], v[148:151], v[128:143]
    v_mov_b32 v65, 0
    v_mov_b32 v81, 0
    ds_read_b64_tr_b16 v[96:97], v7 offset:12288
    ds_read_b64_tr_b16 v[98:99], v7 offset:12800
    ds_read_b128 v[144:147], v6 offset:6336
    s_waitcnt lgkmcnt(12)
    v_mfma_f32_32x32x16_bf16 v[128:143], v[104:107], v[152:155], v[128:143]
    v_mov_b32 v66, 0
    v_mov_b32 v82, 0
    ds_read_b64_tr_b16 v[100:101], v7 offset:14336
    ds_read_b64_tr_b16 v[102:103], v7 offset:14848
    ds_read_b128 v[148:151], v6 offset:7392
    s_waitcnt lgkmcnt(12)
    v_mfma_f32_32x32x16_bf16 v[128:143], v[108:111], v[156:159], v[128:143]
    v_mov_b32 v67, 0
    v_mov_b32 v83, 0
    ds_read_b64_tr_b16 v[104:105], v7 offset:16384
    ds_read_b64_tr_b16 v[106:107], v7 offset:16896
    ds_read_b128 v[152:155], v6 offset:8448
    s_waitcnt lgkmcnt(12)
    v_mfma_f32_32x32x16_bf16 v[128:143], v[112:115], v[160:163], v[128:143]
    v_mov_b32 v68, 0
    v_mov_b32 v84, 0
    ds_read_b64_tr_b16 v[108:109], v7 offset:18432
    ds_read_b64_tr_b16 v[110:111], v7 offset:18944
    ds_read_b128 v[156:159], v6 offset:9504
    s_waitcnt lgkmcnt(12)
    v_mfma_f32_32x32x16_bf16 v[128:143], v[116:119], v[164:167], v[128:143]
    v_mov_b32 v69, 0
    v_mov_b32 v85, 0
    ds_read_b64_tr_b16 v[112:113], v7 offset:20480
    ds_read_b64_tr_b16 v[114:115], v7 offset:20992
    ds_read_b128 v[160:163], v6 offset:10560
    s_waitcnt lgkmcnt(12)
    v_mfma_f32_32x32x16_bf16 v[128:143], v[96:99], v[144:147], v[128:143]
    v_mov_b32 v70, 0
    v_mov_b32 v86, 0
    ds_read_b64_tr_b16 v[116:117], v7 offset:22528
    ds_read_b64_tr_b16 v[118:119], v7 offset:23040
    ds_read_b128 v[164:167], v6 offset:11616
    s_waitcnt lgkmcnt(12)
    v_mfma_f32_32x32x16_bf16 v[128:143], v[100:103], v[148:151], v[128:143]
    s_cmp_ge_u32 s5, 2
    s_cbranch_scc1 A_nogo
    s_cmp_lg_u32 s6, 0
    s_cbranch_scc1 A_nogo
    s_waitcnt vmcnt(0)
    v_readfirstlane_b32 s3, v243
    s_nop 0
    s_and_b32 s3, s3, 31
    s_cmp_lg_u32 s3, 31
    s_cbranch_scc1 A_nogo
    v_mov_b32 v243, 1
    s_lshr_b32 s3, s60, 5
    s_lshl_b32 s3, s3, 6
    s_add_u32 s3, s3, 128
    v_mov_b32 v244, s3
    s_mov_b64 exec, 1
    buffer_store_dword v243, v244, s[56:59], 0 offen sc1
    s_mov_b64 exec, -1
A_nogo:
    v_mov_b32 v71, 0
    v_mov_b32 v87, 0
    ds_read_b64_tr_b16 v[96:97], v7 offset:24576
    ds_read_b64_tr_b16 v[98:99], v7 offset:25088
    ds_read_b128 v[144:147], v6 offset:12672
    s_waitcnt lgkmcnt(12)
    v_mfma_f32_32x32x16_bf16 v[128:143], v[104:107], v[152:155], v[128:143]
    v_mov_b32 v72, 0
    v_mov_b32 v88, 0
    ds_read_b64_tr_b16 v[100:101], v7 offset:26624
    ds_read_b64_tr_b16 v[102:103], v7 offset:27136
    ds_read_b128 v[148:151], v6 offset:13728
    s_waitcnt lgkmcnt(12)
    v_mfma_f32_32x32x16_bf16 v[128:143], v[108:111], v[156:159], v[128:143]
    v_mov_b32 v73, 0
    v_mov_b32 v89, 0
    ds_read_b64_tr_b16 v[104:105], v7 offset:28672
    ds_read_b64_tr_b16 v[106:107], v7 offset:29184
    ds_read_b128 v[152:155], v6 offset:14784
    s_waitcnt lgkmcnt(12)
    v_mfma_f32_32x32x16_bf16 v[128:143], v[112:115], v[160:163], v[128:143]
    v_mov_b32 v74, 0
    v_mov_b32 v90, 0
    ds_read_b64_tr_b16 v[108:109], v7 offset:30720
    ds_read_b64_tr_b16 v[110:111], v7 offset:31232
    ds_read_b128 v[156:159], v6 offset:15840
    s_waitcnt lgkmcnt(12)
    v_mfma_f32_32x32x16_bf16 v[128:143], v[116:119], v[164:167], v[128:143]
    v_mov_b32 v75, 0
    v_mov_b32 v91, 0
    ds_read_b64_tr_b16 v[112:113], v7 offset:32768
    ds_read_b64_tr_b16 v[114:115], v7 offset:33280
    ds_read_b128 v[160:163], v6 offset:16896
    s_waitcnt lgkmcnt(12)
    v_mfma_f32_32x32x16_bf16 v[128:143], v[96:99], v[144:147], v[128:143]
    v_mov_b32 v76, 0
    v_mov_b32 v92, 0
    ds_read_b64_tr_b16 v[116:117], v7 offset:34816
    ds_read_b64_tr_b16 v[118:119], v7 offset:35328
    ds_read_b128 v[164:167], v6 offset:17952
    s_waitcnt lgkmcnt(12)
    v_mfma_f32_32x32x16_bf16 v[128:143], v[100:103], v[148:151], v[128:143]
    v_mov_b32 v77, 0
    v_mov_b32 v93, 0
    ds_read_b64_tr_b16 v[96:97], v7 offset:36864
    ds_read_b64_tr_b16 v[98:99], v7 offset:37376
    ds_read_b128 v[144:147], v6 offset:19008
    s_waitcnt lgkmcnt(12)
    v_mfma_f32_32x32x16_bf16 v[128:143], v[104:107], v[152:155], v[128:143]
    v_mov_b32 v78, 0
    v_mov_b32 v94, 0
    ds_read_b64_tr_b16 v[100:101], v7 offset:38912
    ds_read_b64_tr_b16 v[102:103], v7 offset:39424
    ds_read_b128 v[148:151], v6 offset:20064
    s_waitcnt lgkmcnt(12)
    v_mfma_f32_32x32x16_bf16 v[128:143], v[108:111], v[156:159], v[128:143]
    v_mov_b32 v79, 0
    v_mov_b32 v95, 0
    ds_read_b64_tr_b16 v[104:105], v7 offset:40960
    ds_read_b64_tr_b16 v[106:107], v7 offset:41472
    ds_read_b128 v[152:155], v6 offset:21120
    s_waitcnt lgkmcnt(12)
    v_mfma_f32_32x32x16_bf16 v[128:143], v[112:115], v[160:163], v[128:143]
    v_mov_b32 v52, 0
    v_mov_b32 v53, 0
    ds_read_b64_tr_b16 v[108:109], v7 offset:43008
    ds_read_b64_tr_b16 v[110:111], v7 offset:43520
    ds_read_b128 v[156:159], v6 offset:22176
    s_waitcnt lgkmcnt(12)
    v_mfma_f32_32x32x16_bf16 v[128:143], v[116:119], v[164:167], v[128:143]
    v_mov_b32 v54, 0
    v_mov_b32 v55, 0
    ds_read_b64_tr_b16 v[112:113], v7 offset:45056
    ds_read_b64_tr_b16 v[114:115], v7 offset:45568
    ds_read_b128 v[160:163], v6 offset:23232
    s_waitcnt lgkmcnt(12)
    v_mfma_f32_32x32x16_bf16 v[128:143], v[96:99], v[144:147], v[128:143]
    v_mov_b32 v48, 0xdddddddd
    s_mov_b32 s80, 0xffff
    ds_read_b64_tr_b16 v[116:117], v7 offset:47104
    ds_read_b64_tr_b16 v[118:119], v7 offset:47616
    ds_read_b128 v[164:167], v6 offset:24288
    s_waitcnt lgkmcnt(12)
    v_mfma_f32_32x32x16_bf16 v[128:143], v[100:103], v[148:151], v[128:143]
    s_mov_b32 s81, 0xffff
    s_mul_i32 s77, s6, 2304
    ds_read_b64_tr_b16 v[96:97], v7 offset:49152
    ds_read_b64_tr_b16 v[98:99], v7 offset:49664
    ds_read_b128 v[144:147], v6 offset:25344
    s_waitcnt lgkmcnt(12)
    v_mfma_f32_32x32x16_bf16 v[128:143], v[104:107], v[152:155], v[128:143]
    s_add_u32 s77, s77, 73728
    v_add_u32 v56, s77, v9
    ds_read_b64_tr_b16 v[100:101], v7 offset:51200
    ds_read_b64_tr_b16 v[102:103], v7 offset:51712
    ds_read_b128 v[148:151], v6 offset:26400
    s_waitcnt lgkmcnt(12)
    v_mfma_f32_32x32x16_bf16 v[128:143], v[108:111], v[156:159], v[128:143]
    s_add_u32 s77, s77, 2048
    v_lshl_add_u32 v57, v0, 2, s77
    ds_read_b64_tr_b16 v[104:105], v7 offset:53248
    ds_read_b64_tr_b16 v[106:107], v7 offset:53760
    ds_read_b128 v[152:155], v6 offset:27456
    s_waitcnt lgkmcnt(12)
    v_mfma_f32_32x32x16_bf16 v[128:143], v[112:115], v[160:163], v[128:143]
    v_add_u32 v58, 148480, v9
    v_add_u32 v59, 147456, v9
    ds_read_b64_tr_b16 v[108:109], v7 offset:55296
    ds_read_b64_tr_b16 v[110:111], v7 offset:55808
    ds_read_b128 v[156:159], v6 offset:28512
    s_waitcnt lgkmcnt(12)
    v_mfma_f32_32x32x16_bf16 v[128:143], v[116:119], v[164:167], v[128:143]
    v_mov_b32 v60, 161792
    s_lshl_b32 s42, s6, 14
    ds_read_b64_tr_b16 v[112:113], v7 offset:57344
    ds_read_b64_tr_b16 v[114:115], v7 offset:57856
    ds_read_b128 v[160:163], v6 offset:29568
    s_waitcnt lgkmcnt(12)
    v_mfma_f32_32x32x16_bf16 v[128:143], v[96:99], v[144:147], v[128:143]
    s_lshr_b32 s61, s6, 1
    s_lshl_b32 s77, s4, 1
    ds_read_b64_tr_b16 v[116:117], v7 offset:59392
    ds_read_b64_tr_b16 v[118:119], v7 offset:59904
    ds_read_b128 v[164:167], v6 offset:30624
    s_waitcnt lgkmcnt(12)
    v_mfma_f32_32x32x16_bf16 v[128:143], v[100:103], v[148:151], v[128:143]
    s_add_u32 s61, s61, s77
    s_and_b32 s62, s6, 1
    ds_read_b64_tr_b16 v[96:97], v7 offset:61440
    ds_read_b64_tr_b16 v[98:99], v7 offset:61952
    ds_read_b128 v[144:147], v6 offset:31680
    s_waitcnt lgkmcnt(12)
    v_mfma_f32_32x32x16_bf16 v[128:143], v[104:107], v[152:155], v[128:143]
    s_lshl_b32 s77, s5, 1
    s_add_u32 s62, s62, s77
    ds_read_b64_tr_b16 v[100:101], v7 offset:63488
    ds_read_b64_tr_b16 v[102:103], v7 offset:64000
    ds_read_b128 v[148:151], v6 offset:32736
    s_waitcnt lgkmcnt(12)
    v_mfma_f32_32x32x16_bf16 v[128:143], v[108:111], v[156:159], v[128:143]
    v_and_b32 v2, 31, v0
    s_lshl_b32 s77, s61, 5
    s_waitcnt lgkmcnt(9)
    v_mfma_f32_32x32x16_bf16 v[128:143], v[112:115], v[160:163], v[128:143]
    v_add_u32 v2, s77, v2
    v_lshlrev_b32 v2, 10, v2
    s_waitcnt lgkmcnt(6)
    v_mfma_f32_32x32x16_bf16 v[128:143], v[116:119], v[164:167], v[128:143]
    v_lshrrev_b32 v3, 5, v0
    v_lshl_add_u32 v8, v3, 4, v2
    s_waitcnt lgkmcnt(3)
    v_mfma_f32_32x32x16_bf16 v[128:143], v[96:99], v[144:147], v[128:143]
    s_waitcnt lgkmcnt(0)
    v_mfma_f32_32x32x16_bf16 v[128:143], v[100:103], v[148:151], v[128:143]
    s_mov_b32 s30, 0x3eb8aa3b
    s_mov_b32 s31, s30
    v_add_u32 v5, 7168, v4
    v_add_u32 v6, 14336, v4
    v_add_u32 v7, 21504, v4
    s_nop 6
    v_pk_mul_f32 v[128:129], v[128:129], s[30:31]
    v_pk_mul_f32 v[130:131], v[130:131], s[30:31]
    v_pk_mul_f32 v[132:133], v[132:133], s[30:31]
    v_pk_mul_f32 v[134:135], v[134:135], s[30:31]
    v_pk_mul_f32 v[136:137], v[136:137], s[30:31]
    v_pk_mul_f32 v[138:139], v[138:139], s[30:31]
    v_pk_mul_f32 v[140:141], v[140:141], s[30:31]
    v_pk_mul_f32 v[142:143], v[142:143], s[30:31]
    v_cvt_pk_bf16_f32 v96, v128, v129
    v_cvt_pk_bf16_f32 v97, v130, v131
    v_cvt_pk_bf16_f32 v98, v132, v133
    v_cvt_pk_bf16_f32 v99, v134, v135
    v_cvt_pk_bf16_f32 v100, v136, v137
    v_cvt_pk_bf16_f32 v101, v138, v139
    v_cvt_pk_bf16_f32 v102, v140, v141
    v_cvt_pk_bf16_f32 v103, v142, v143
    s_lshr_b32 s3, s6, 1
    s_xor_b32 s3, s5, s3
    s_and_b32 s3, s3, 1
    s_lshl_b32 s3, s3, 2
    s_and_b32 s7, s6, 1
    s_lshl_b32 s7, s7, 1
    s_add_u32 s3, s3, s7
    s_lshl_b32 s3, s3, 10
    s_add_u32 s3, s3, 147456
    v_add_u32 v104, s3, v9
    ds_write_b128 v104, v[96:99]
    ds_write_b128 v104, v[100:103] offset:1024
    v_mul_f32 v104, v128, v128
    v_mul_f32 v105, v136, v136
    v_fmac_f32 v104, v129, v129
    v_fmac_f32 v105, v137, v137
    v_fmac_f32 v104, v130, v130
    v_fmac_f32 v105, v138, v138
    v_fmac_f32 v104, v131, v131
    v_fmac_f32 v105, v139, v139
    v_fmac_f32 v104, v132, v132
    v_fmac_f32 v105, v140, v140
    v_fmac_f32 v104, v133, v133
    v_fmac_f32 v105, v141, v141
    v_fmac_f32 v104, v134, v134
    v_fmac_f32 v105, v142, v142
    v_fmac_f32 v104, v135, v135
    v_fmac_f32 v105, v143, v143
    v_mov_b32 v106, v104
    v_mov_b32 v107, v105
    s_nop 0
    v_permlane32_swap_b32 v104, v106
    v_permlane32_swap_b32 v105, v107
    v_add_f32 v104, v104, v106
    v_add_f32 v105, v105, v107
    v_max_u32 v104, v104, v105
    s_nop 1
    v_max_u32_dpp v104, v104, v104 row_ror:8 row_mask:0xf bank_mask:0xf
    s_nop 1
    v_max_u32_dpp v104, v104, v104 row_ror:4 row_mask:0xf bank_mask:0xf
    s_nop 1
    v_max_u32_dpp v104, v104, v104 row_ror:2 row_mask:0xf bank_mask:0xf
    s_nop 1
    v_max_u32_dpp v104, v104, v104 row_ror:1 row_mask:0xf bank_mask:0xf
    s_nop 0
    v_readlane_b32 s3, v104, 0
    v_readlane_b32 s7, v104, 16
    s_nop 0
    s_max_u32 s3, s3, s7
    v_mov_b32 v104, s3
    s_lshl_b32 s7, s6, 2
    s_add_u32 s7, s7, 161792
    v_mov_b32 v105, s7
    ds_write_b32 v105, v104
    s_mov_b32 s24, s40
    s_mov_b32 s25, s41
    s_mov_b32 s26, 0x00080000
    s_mov_b32 s27, 0x20000
    s_lshl_b32 s75, s6, 17
    s_mov_b32 s16, s44
    s_mov_b32 s17, s45
    s_mov_b32 s18, 0x00158000
    s_mov_b32 s19, 0x20000
    s_mov_b32 s20, s46
    s_mov_b32 s21, s47
    s_mov_b32 s22, 0x00158000
    s_mov_b32 s23, 0x20000
    s_lshr_b32 s78, s2, 3
    s_lshl_b32 s78, s78, 2
    s_add_u32 s78, s78, s6
    s_mul_i32 s78, s78, 6880
    s_add_u32 s78, s78, 528384
    v_lshlrev_b32 v50, 6, v0
    v_and_b32 v51, 15, v0
    v_lshlrev_b32 v51, 7, v51
    s_lshr_b32 s3, s6, 1
    s_lshl_b32 s7, s4, 1
    s_add_u32 s3, s3, s7
    s_lshl_b32 s3, s3, 5
    s_lshl_b32 s7, s5, 2
    s_add_u32 s3, s3, s7
    s_and_b32 s7, s6, 1
    s_lshl_b32 s7, s7, 1
    s_add_u32 s3, s3, s7
    s_lshl_b32 s3, s3, 10
    s_add_u32 s82, s3, 3145728
    s_lshl_b32 s3, s61, 5
    s_lshl_b32 s7, s62, 1
    s_add_u32 s3, s3, s7
    s_lshl_b32 s3, s3, 10
    s_add_u32 s83, s3, 5242880
    s_lshl_b32 s3, s61, 12
    s_lshl_b32 s7, s62, 8
    s_add_u32 s3, s3, s7
    s_add_u32 s84, s3, 7340032
    s_lshl_b32 s31, s42, 1
    s_add_u32 s31, s31, 2162688
    s_add_u32 s30, s42, 2097152
    v_lshrrev_b32 v11, 4, v0
    v_bfe_u32 v12, v0, 2, 2
    v_and_b32 v13, 3, v0
    v_lshrrev_b32 v14, 1, v11
    v_lshl_add_u32 v14, v14, 3, v12
    v_and_b32 v15, 1, v11
    v_and_b32 v96, 1, v13
    v_lshlrev_b32 v96, 4, v96
    v_lshrrev_b32 v97, 1, v13
    v_lshl_add_u32 v96, v97, 3, v96
    s_and_b32 s3, s6, 1
    s_lshl_b32 s3, s3, 2
    v_and_b32 v97, 1, v13
    v_lshl_add_u32 v97, v15, 1, v97
    v_add_u32 v97, s3, v97
    v_lshrrev_b32 v98, 1, v12
    v_lshlrev_b32 v98, 2, v98
    v_xor_b32 v97, v97, v98
    v_lshlrev_b32 v97, 4, v97
    v_lshrrev_b32 v98, 1, v13
    v_lshl_add_u32 v97, v98, 3, v97
    v_lshl_add_u32 v97, v14, 7, v97
    v_add_u32 v10, 0, v97
    s_and_b32 s3, s6, 1
    s_lshl_b32 s3, s3, 15
    v_add_u32 v10, s3, v10
    v_xor_b32 v1, 64, v10
    v_lshlrev_b32 v11, 7, v0
    s_cmp_lg_u32 s6, 0
    s_cbranch_scc1 B_s1skip
    v_and_b32 v62, 1, v0
    v_lshlrev_b32 v62, 6, v62
    v_add_u32 v62, 128, v62
    s_mov_b32 s29, 131072
POLL_s1:
    buffer_load_dword v61, v62, s[56:59], 0 offen sc1
    s_waitcnt vmcnt(0)
    v_cmp_ne_u32 vcc, 1, v61
    s_nop 0
    s_cmp_eq_u64 vcc, 0
    s_cbranch_scc1 POLLD_s1
    s_sleep 1
    s_sub_u32 s29, s29, 1
    s_cmp_lg_u32 s29, 0
    s_cbranch_scc1 POLL_s1
POLLD_s1:
B_s1skip:
    s_waitcnt lgkmcnt(0)
    s_barrier
    s_mov_b32 s3, 2293760
    buffer_load_dword v61, v11, s[8:11], s3 offen sc1
    s_add_u32 s3, s30, 0
    buffer_load_dwordx4 a[0:3], v9, s[8:11], s3 offen sc1
    ds_read_b128 v[96:99], v59
    ds_read_b128 v[104:107], v60
    s_add_u32 s3, s30, 1024
    buffer_load_dwordx4 a[4:7], v9, s[8:11], s3 offen sc1
    s_add_u32 s3, s31, 0
    s_mov_b64 exec, s[80:81]
    buffer_load_dwordx4 a[64:67], v9, s[8:11], s3 offen sc1
    buffer_load_dwordx4 a[68:71], v9, s[8:11], s3 offen offset:1024 sc1
    s_mov_b64 exec, -1
    s_add_u32 s3, s30, 2048
    buffer_load_dwordx4 a[8:11], v9, s[8:11], s3 offen sc1
    s_add_u32 s3, s31, 2048
    s_mov_b64 exec, s[80:81]
    buffer_load_dwordx4 a[72:75], v9, s[8:11], s3 offen sc1
    buffer_load_dwordx4 a[76:79], v9, s[8:11], s3 offen offset:1024 sc1
    s_mov_b64 exec, -1
    s_add_u32 s3, s30, 3072
    buffer_load_dwordx4 a[12:15], v9, s[8:11], s3 offen sc1
    s_add_u32 s3, s31, 4096
    s_mov_b64 exec, s[80:81]
    buffer_load_dwordx4 a[80:83], v9, s[8:11], s3 offen sc1
    buffer_load_dwordx4 a[84:87], v9, s[8:11], s3 offen offset:1024 sc1
    s_mov_b64 exec, -1
    s_waitcnt lgkmcnt(0)
    v_max_u32 v60, v104, v105
    v_max3_u32 v60, v60, v106, v107
    s_waitcnt vmcnt(9)
    v_mfma_f32_32x32x16_bf16 v[16:31], a[0:3], v[96:99], 0
    s_waitcnt vmcnt(10)
    v_max_u32_dpp v61, v61, v61 row_ror:8 row_mask:0xf bank_mask:0xf
    s_nop 1
    v_max_u32_dpp v61, v61, v61 row_ror:4 row_mask:0xf bank_mask:0xf
    s_nop 1
    v_max_u32_dpp v61, v61, v61 row_ror:2 row_mask:0xf bank_mask:0xf
    s_nop 1
    v_max_u32_dpp v61, v61, v61 row_ror:1 row_mask:0xf bank_mask:0xf
    s_nop 0
    v_readlane_b32 s3, v61, 0
    v_readlane_b32 s7, v61, 16
    s_nop 0
    s_max_u32 s3, s3, s7
    v_readlane_b32 s7, v61, 32
    s_nop 0
    s_max_u32 s3, s3, s7
    v_readlane_b32 s7, v61, 48
    s_nop 0
    s_max_u32 s65, s3, s7
    v_mul_f32 v60, s65, v60
    v_cmp_nge_f32 vcc, 0x44c03bd7, v60
    s_nop 0
    s_cmp_lg_u64 vcc, 0
    s_cbranch_scc1 L_slow
    s_waitcnt vmcnt(7)
    v_exp_f32 v16, v16
    v_exp_f32 v17, v17
    v_exp_f32 v18, v18
    s_add_u32 s3, s30, 4096
    buffer_load_dwordx4 a[16:19], v9, s[8:11], s3 offen sc1
    v_exp_f32 v19, v19
    v_exp_f32 v20, v20
    v_mfma_f32_32x32x16_bf16 v[32:47], a[4:7], v[96:99], 0
    v_exp_f32 v21, v21
    v_exp_f32 v22, v22
    s_add_u32 s3, s31, 6144
    s_mov_b64 exec, s[80:81]
    buffer_load_dwordx4 a[88:91], v9, s[8:11], s3 offen sc1
    buffer_load_dwordx4 a[92:95], v9, s[8:11], s3 offen offset:1024 sc1
    s_mov_b64 exec, -1
    v_exp_f32 v23, v23
    v_exp_f32 v24, v24
    v_exp_f32 v25, v25
    v_smfmac_f32_32x32x32_bf16 v[64:79], a[64:67], v[16:23], v48
    v_exp_f32 v26, v26
    v_exp_f32 v27, v27
    v_exp_f32 v28, v28
    v_exp_f32 v29, v29
    v_exp_f32 v30, v30
    v_exp_f32 v31, v31
    s_waitcnt vmcnt(7)
    v_exp_f32 v32, v32
    v_exp_f32 v33, v33
    v_smfmac_f32_32x32x32_bf16 v[64:79], a[68:71], v[24:31], v48
    v_exp_f32 v34, v34
    s_add_u32 s3, s30, 5120
    buffer_load_dwordx4 a[20:23], v9, s[8:11], s3 offen sc1
    v_exp_f32 v35, v35
    v_exp_f32 v36, v36
    v_mfma_f32_32x32x16_bf16 v[16:31], a[8:11], v[96:99], 0
    v_exp_f32 v37, v37
    v_exp_f32 v38, v38
    s_add_u32 s3, s31, 8192
    s_mov_b64 exec, s[80:81]
    buffer_load_dwordx4 a[96:99], v9, s[8:11], s3 offen sc1
    buffer_load_dwordx4 a[100:103], v9, s[8:11], s3 offen offset:1024 sc1
    s_mov_b64 exec, -1
    v_exp_f32 v39, v39
    v_exp_f32 v40, v40
    v_exp_f32 v41, v41
    v_smfmac_f32_32x32x32_bf16 v[64:79], a[72:75], v[32:39], v48
    v_exp_f32 v42, v42
    v_exp_f32 v43, v43
    v_exp_f32 v44, v44
    v_exp_f32 v45, v45
    v_exp_f32 v46, v46
    v_exp_f32 v47, v47
    s_waitcnt vmcnt(7)
    v_exp_f32 v16, v16
    v_exp_f32 v17, v17
    v_smfmac_f32_32x32x32_bf16 v[64:79], a[76:79], v[40:47], v48
    v_exp_f32 v18, v18
    s_add_u32 s3, s30, 6144
    buffer_load_dwordx4 a[24:27], v9, s[8:11], s3 offen sc1
    v_exp_f32 v19, v19
    v_exp_f32 v20, v20
    v_mfma_f32_32x32x16_bf16 v[32:47], a[12:15], v[96:99], 0
    v_exp_f32 v21, v21
    v_exp_f32 v22, v22
    s_add_u32 s3, s31, 10240
    s_mov_b64 exec, s[80:81]
    buffer_load_dwordx4 a[104:107], v9, s[8:11], s3 offen sc1
    buffer_load_dwordx4 a[108:111], v9, s[8:11], s3 offen offset:1024 sc1
    s_mov_b64 exec, -1
    v_exp_f32 v23, v23
    v_exp_f32 v24, v24
    v_exp_f32 v25, v25
    v_smfmac_f32_32x32x32_bf16 v[64:79], a[80:83], v[16:23], v48
    v_exp_f32 v26, v26
    v_exp_f32 v27, v27
    v_exp_f32 v28, v28
    v_exp_f32 v29, v29
    v_exp_f32 v30, v30
    v_exp_f32 v31, v31
    s_waitcnt vmcnt(7)
    v_exp_f32 v32, v32
    v_exp_f32 v33, v33
    v_smfmac_f32_32x32x32_bf16 v[64:79], a[84:87], v[24:31], v48
    v_exp_f32 v34, v34
    s_add_u32 s3, s30, 7168
    buffer_load_dwordx4 a[28:31], v9, s[8:11], s3 offen sc1
    v_exp_f32 v35, v35
    v_exp_f32 v36, v36
    v_mfma_f32_32x32x16_bf16 v[16:31], a[16:19], v[96:99], 0
    v_exp_f32 v37, v37
    v_exp_f32 v38, v38
    s_add_u32 s3, s31, 12288
    s_mov_b64 exec, s[80:81]
    buffer_load_dwordx4 a[112:115], v9, s[8:11], s3 offen sc1
    buffer_load_dwordx4 a[116:119], v9, s[8:11], s3 offen offset:1024 sc1
    s_mov_b64 exec, -1
    v_exp_f32 v39, v39
    v_exp_f32 v40, v40
    v_exp_f32 v41, v41
    v_smfmac_f32_32x32x32_bf16 v[64:79], a[88:91], v[32:39], v48
    v_exp_f32 v42, v42
    v_exp_f32 v43, v43
    v_exp_f32 v44, v44
    v_exp_f32 v45, v45
    v_exp_f32 v46, v46
    v_exp_f32 v47, v47
    s_waitcnt vmcnt(7)
    v_exp_f32 v16, v16
    v_exp_f32 v17, v17
    v_smfmac_f32_32x32x32_bf16 v[64:79], a[92:95], v[40:47], v48
    v_exp_f32 v18, v18
    ds_read_b128 v[100:103], v58
    s_add_u32 s3, s30, 8192
    buffer_load_dwordx4 a[32:35], v9, s[8:11], s3 offen sc1
    v_exp_f32 v19, v19
    v_exp_f32 v20, v20
    v_mfma_f32_32x32x16_bf16 v[32:47], a[20:23], v[96:99], 0
    v_exp_f32 v21, v21
    v_exp_f32 v22, v22
    s_add_u32 s3, s31, 14336
    s_mov_b64 exec, s[80:81]
    buffer_load_dwordx4 a[120:123], v9, s[8:11], s3 offen sc1
    buffer_load_dwordx4 a[124:127], v9, s[8:11], s3 offen offset:1024 sc1
    s_mov_b64 exec, -1
    v_exp_f32 v23, v23
    v_exp_f32 v24, v24
    v_exp_f32 v25, v25
    v_smfmac_f32_32x32x32_bf16 v[64:79], a[96:99], v[16:23], v48
    v_exp_f32 v26, v26
    v_exp_f32 v27, v27
    v_exp_f32 v28, v28
    v_exp_f32 v29, v29
    v_exp_f32 v30, v30
    v_exp_f32 v31, v31
    s_waitcnt vmcnt(7)
    v_exp_f32 v32, v32
    v_exp_f32 v33, v33
    v_smfmac_f32_32x32x32_bf16 v[64:79], a[100:103], v[24:31], v48
    v_exp_f32 v34, v34
    v_add_u32 v58, 1024, v58
    s_add_u32 s3, s30, 9216
    buffer_load_dwordx4 a[36:39], v9, s[8:11], s3 offen sc1
    v_exp_f32 v35, v35
    v_exp_f32 v36, v36
    v_mfma_f32_32x32x16_bf16 v[16:31], a[24:27], v[96:99], 0
    v_exp_f32 v37, v37
    v_exp_f32 v38, v38
    s_add_u32 s3, s31, 16384
    s_mov_b64 exec, s[80:81]
    buffer_load_dwordx4 a[128:131], v9, s[8:11], s3 offen sc1
    buffer_load_dwordx4 a[132:135], v9, s[8:11], s3 offen offset:1024 sc1
    s_mov_b64 exec, -1
    v_exp_f32 v39, v39
    v_exp_f32 v40, v40
    v_exp_f32 v41, v41
    v_smfmac_f32_32x32x32_bf16 v[64:79], a[104:107], v[32:39], v48
    v_exp_f32 v42, v42
    v_exp_f32 v43, v43
    v_exp_f32 v44, v44
    v_exp_f32 v45, v45
    v_exp_f32 v46, v46
    v_exp_f32 v47, v47
    s_waitcnt vmcnt(7)
    v_exp_f32 v16, v16
    v_exp_f32 v17, v17
    v_smfmac_f32_32x32x32_bf16 v[64:79], a[108:111], v[40:47], v48
    v_exp_f32 v18, v18
    s_add_u32 s3, s30, 10240
    buffer_load_dwordx4 a[40:43], v9, s[8:11], s3 offen sc1
    v_exp_f32 v19, v19
    v_exp_f32 v20, v20
    v_mfma_f32_32x32x16_bf16 v[32:47], a[28:31], v[96:99], 0
    v_exp_f32 v21, v21
    v_exp_f32 v22, v22
    s_add_u32 s3, s31, 18432
    s_mov_b64 exec, s[80:81]
    buffer_load_dwordx4 a[136:139], v9, s[8:11], s3 offen sc1
    buffer_load_dwordx4 a[140:143], v9, s[8:11], s3 offen offset:1024 sc1
    s_mov_b64 exec, -1
    v_exp_f32 v23, v23
    v_exp_f32 v24, v24
    v_exp_f32 v25, v25
    v_smfmac_f32_32x32x32_bf16 v[64:79], a[112:115], v[16:23], v48
    v_exp_f32 v26, v26
    v_exp_f32 v27, v27
    v_exp_f32 v28, v28
    v_exp_f32 v29, v29
    v_exp_f32 v30, v30
    v_exp_f32 v31, v31
    s_waitcnt vmcnt(7)
    v_exp_f32 v32, v32
    v_exp_f32 v33, v33
    v_smfmac_f32_32x32x32_bf16 v[64:79], a[116:119], v[24:31], v48
    v_exp_f32 v34, v34
    s_add_u32 s3, s30, 11264
    buffer_load_dwordx4 a[44:47], v9, s[8:11], s3 offen sc1
    v_exp_f32 v35, v35
    v_exp_f32 v36, v36
    v_mfma_f32_32x32x16_bf16 v[16:31], a[32:35], v[96:99], 0
    v_exp_f32 v37, v37
    v_exp_f32 v38, v38
    s_add_u32 s3, s31, 20480
    s_mov_b64 exec, s[80:81]
    buffer_load_dwordx4 a[144:147], v9, s[8:11], s3 offen sc1
    buffer_load_dwordx4 a[148:151], v9, s[8:11], s3 offen offset:1024 sc1
    s_mov_b64 exec, -1
    v_exp_f32 v39, v39
    v_exp_f32 v40, v40
    v_exp_f32 v41, v41
    v_smfmac_f32_32x32x32_bf16 v[64:79], a[120:123], v[32:39], v48
    v_exp_f32 v42, v42
    v_exp_f32 v43, v43
    v_exp_f32 v44, v44
    v_exp_f32 v45, v45
    v_exp_f32 v46, v46
    v_exp_f32 v47, v47
    s_waitcnt vmcnt(7)
    v_exp_f32 v16, v16
    v_exp_f32 v17, v17
    v_smfmac_f32_32x32x32_bf16 v[64:79], a[124:127], v[40:47], v48
    v_exp_f32 v18, v18
    s_add_u32 s3, s30, 12288
    buffer_load_dwordx4 a[48:51], v9, s[8:11], s3 offen sc1
    v_exp_f32 v19, v19
    v_exp_f32 v20, v20
    v_mfma_f32_32x32x16_bf16 v[32:47], a[36:39], v[96:99], 0
    v_exp_f32 v21, v21
    v_exp_f32 v22, v22
    s_add_u32 s3, s31, 22528
    s_mov_b64 exec, s[80:81]
    buffer_load_dwordx4 a[152:155], v9, s[8:11], s3 offen sc1
    buffer_load_dwordx4 a[156:159], v9, s[8:11], s3 offen offset:1024 sc1
    s_mov_b64 exec, -1
    v_exp_f32 v23, v23
    v_exp_f32 v24, v24
    v_exp_f32 v25, v25
    v_smfmac_f32_32x32x32_bf16 v[64:79], a[128:131], v[16:23], v48
    v_exp_f32 v26, v26
    v_exp_f32 v27, v27
    v_exp_f32 v28, v28
    v_exp_f32 v29, v29
    v_exp_f32 v30, v30
    v_exp_f32 v31, v31
    s_waitcnt vmcnt(7)
    v_exp_f32 v32, v32
    v_exp_f32 v33, v33
    v_smfmac_f32_32x32x32_bf16 v[64:79], a[132:135], v[24:31], v48
    v_exp_f32 v34, v34
    s_add_u32 s3, s30, 13312
    buffer_load_dwordx4 a[52:55], v9, s[8:11], s3 offen sc1
    v_exp_f32 v35, v35
    v_exp_f32 v36, v36
    v_mfma_f32_32x32x16_bf16 v[16:31], a[40:43], v[96:99], 0
    v_exp_f32 v37, v37
    v_exp_f32 v38, v38
    s_add_u32 s3, s31, 24576
    s_mov_b64 exec, s[80:81]
    buffer_load_dwordx4 a[160:163], v9, s[8:11], s3 offen sc1
    buffer_load_dwordx4 a[164:167], v9, s[8:11], s3 offen offset:1024 sc1
    s_mov_b64 exec, -1
    v_exp_f32 v39, v39
    v_exp_f32 v40, v40
    v_exp_f32 v41, v41
    v_smfmac_f32_32x32x32_bf16 v[64:79], a[136:139], v[32:39], v48
    v_exp_f32 v42, v42
    v_exp_f32 v43, v43
    v_exp_f32 v44, v44
    v_exp_f32 v45, v45
    v_exp_f32 v46, v46
    v_exp_f32 v47, v47
    s_waitcnt vmcnt(7)
    v_exp_f32 v16, v16
    v_exp_f32 v17, v17
    v_smfmac_f32_32x32x32_bf16 v[64:79], a[140:143], v[40:47], v48
    v_exp_f32 v18, v18
    s_add_u32 s3, s30, 14336
    buffer_load_dwordx4 a[56:59], v9, s[8:11], s3 offen sc1
    v_exp_f32 v19, v19
    v_exp_f32 v20, v20
    v_mfma_f32_32x32x16_bf16 v[32:47], a[44:47], v[96:99], 0
    v_exp_f32 v21, v21
    v_exp_f32 v22, v22
    s_add_u32 s3, s31, 26624
    s_mov_b64 exec, s[80:81]
    buffer_load_dwordx4 a[168:171], v9, s[8:11], s3 offen sc1
    buffer_load_dwordx4 a[172:175], v9, s[8:11], s3 offen offset:1024 sc1
    s_mov_b64 exec, -1
    v_exp_f32 v23, v23
    v_exp_f32 v24, v24
    v_exp_f32 v25, v25
    v_smfmac_f32_32x32x32_bf16 v[64:79], a[144:147], v[16:23], v48
    v_exp_f32 v26, v26
    v_exp_f32 v27, v27
    v_exp_f32 v28, v28
    v_exp_f32 v29, v29
    v_exp_f32 v30, v30
    v_exp_f32 v31, v31
    s_waitcnt vmcnt(7)
    v_exp_f32 v32, v32
    v_exp_f32 v33, v33
    v_smfmac_f32_32x32x32_bf16 v[64:79], a[148:151], v[24:31], v48
    v_exp_f32 v34, v34
    s_add_u32 s3, s30, 15360
    buffer_load_dwordx4 a[60:63], v9, s[8:11], s3 offen sc1
    v_exp_f32 v35, v35
    v_exp_f32 v36, v36
    v_mfma_f32_32x32x16_bf16 v[16:31], a[48:51], v[96:99], 0
    v_exp_f32 v37, v37
    v_exp_f32 v38, v38
    s_add_u32 s3, s31, 28672
    s_mov_b64 exec, s[80:81]
    buffer_load_dwordx4 a[176:179], v9, s[8:11], s3 offen sc1
    buffer_load_dwordx4 a[180:183], v9, s[8:11], s3 offen offset:1024 sc1
    s_mov_b64 exec, -1
    v_exp_f32 v39, v39
    v_exp_f32 v40, v40
    v_exp_f32 v41, v41
    v_smfmac_f32_32x32x32_bf16 v[64:79], a[152:155], v[32:39], v48
    v_exp_f32 v42, v42
    v_exp_f32 v43, v43
    v_exp_f32 v44, v44
    v_exp_f32 v45, v45
    v_exp_f32 v46, v46
    v_exp_f32 v47, v47
    s_waitcnt vmcnt(7)
    v_exp_f32 v16, v16
    v_exp_f32 v17, v17
    v_smfmac_f32_32x32x32_bf16 v[64:79], a[156:159], v[40:47], v48
    v_exp_f32 v18, v18
    v_exp_f32 v19, v19
    v_exp_f32 v20, v20
    v_mfma_f32_32x32x16_bf16 v[32:47], a[52:55], v[96:99], 0
    v_exp_f32 v21, v21
    v_exp_f32 v22, v22
    s_add_u32 s3, s31, 30720
    s_mov_b64 exec, s[80:81]
    buffer_load_dwordx4 a[184:187], v9, s[8:11], s3 offen sc1
    buffer_load_dwordx4 a[188:191], v9, s[8:11], s3 offen offset:1024 sc1
    s_mov_b64 exec, -1
    v_exp_f32 v23, v23
    v_exp_f32 v24, v24
    v_exp_f32 v25, v25
    v_smfmac_f32_32x32x32_bf16 v[64:79], a[160:163], v[16:23], v48
    v_exp_f32 v26, v26
    v_exp_f32 v27, v27
    v_exp_f32 v28, v28
    v_exp_f32 v29, v29
    v_exp_f32 v30, v30
    v_exp_f32 v31, v31
    s_waitcnt vmcnt(6)
    v_exp_f32 v32, v32
    v_exp_f32 v33, v33
    v_smfmac_f32_32x32x32_bf16 v[64:79], a[164:167], v[24:31], v48
    v_exp_f32 v34, v34
    v_exp_f32 v35, v35
    v_exp_f32 v36, v36
    v_mfma_f32_32x32x16_bf16 v[16:31], a[56:59], v[96:99], 0
    v_exp_f32 v37, v37
    v_exp_f32 v38, v38
    v_exp_f32 v39, v39
    v_exp_f32 v40, v40
    v_exp_f32 v41, v41
    v_smfmac_f32_32x32x32_bf16 v[64:79], a[168:171], v[32:39], v48
    v_exp_f32 v42, v42
    v_exp_f32 v43, v43
    v_exp_f32 v44, v44
    v_exp_f32 v45, v45
    v_exp_f32 v46, v46
    v_exp_f32 v47, v47
    s_waitcnt vmcnt(3)
    s_waitcnt lgkmcnt(0)
    v_exp_f32 v16, v16
    v_exp_f32 v17, v17
    v_smfmac_f32_32x32x32_bf16 v[64:79], a[172:175], v[40:47], v48
    v_exp_f32 v18, v18
    v_exp_f32 v19, v19
    v_exp_f32 v20, v20
    v_mfma_f32_32x32x16_bf16 v[32:47], a[60:63], v[96:99], 0
    v_exp_f32 v21, v21
    v_exp_f32 v22, v22
    v_exp_f32 v23, v23
    v_exp_f32 v24, v24
    v_exp_f32 v25, v25
    v_smfmac_f32_32x32x32_bf16 v[64:79], a[176:179], v[16:23], v48
    v_exp_f32 v26, v26
    v_exp_f32 v27, v27
    v_exp_f32 v28, v28
    v_exp_f32 v29, v29
    v_exp_f32 v30, v30
    v_exp_f32 v31, v31
    s_waitcnt vmcnt(1)
    v_exp_f32 v32, v32
    v_exp_f32 v33, v33
    v_smfmac_f32_32x32x32_bf16 v[64:79], a[180:183], v[24:31], v48
    v_exp_f32 v34, v34
    v_exp_f32 v35, v35
    v_exp_f32 v36, v36
    v_mfma_f32_32x32x16_bf16 v[16:31], a[0:3], v[100:103], 0
    v_exp_f32 v37, v37
    v_exp_f32 v38, v38
    v_exp_f32 v39, v39
    v_exp_f32 v40, v40
    v_exp_f32 v41, v41
    v_smfmac_f32_32x32x32_bf16 v[64:79], a[184:187], v[32:39], v48
    v_exp_f32 v42, v42
    v_exp_f32 v43, v43
    v_exp_f32 v44, v44
    v_exp_f32 v45, v45
    v_exp_f32 v46, v46
    v_exp_f32 v47, v47
    s_waitcnt vmcnt(0)
    v_exp_f32 v16, v16
    v_exp_f32 v17, v17
    v_exp_f32 v18, v18
    v_smfmac_f32_32x32x32_bf16 v[64:79], a[188:191], v[40:47], v48
    s_getreg_b32 s43, hwreg(HW_REG_XCC_ID, 0, 4)
    s_add_u32 s43, s43, 1
    s_lshr_b32 s86, s4, 1
    s_lshl_b32 s86, s86, 6
    s_add_u32 s86, s86, 2338816
    s_cmp_lg_u32 s6, 0
    s_cbranch_scc1 XP_1983
    s_and_b32 s3, s4, 1
    s_lshl_b32 s3, s3, 3
    s_add_u32 s3, s3, s5
    s_lshl_b32 s3, s3, 2
    v_mov_b32 v12, s43
    v_mov_b32 v14, s3
    s_mov_b64 exec, 1
    buffer_store_dword v12, v14, s[8:11], s86 offen sc1
    s_mov_b64 exec, -1
XP_1983:
    v_exp_f32 v19, v19
    v_exp_f32 v20, v20
    v_mfma_f32_32x32x16_bf16 v[32:47], a[4:7], v[100:103], 0
    v_exp_f32 v21, v21
    v_exp_f32 v22, v22
    v_exp_f32 v23, v23
    v_exp_f32 v24, v24
    s_lshr_b32 s85, s2, 3
    s_lshl_b32 s85, s85, 2
    s_add_u32 s85, s85, s6
    s_lshl_b32 s85, s85, 12
    buffer_load_dword v49, v50, s[24:27], s85 offen
    v_exp_f32 v25, v25
    v_exp_f32 v26, v26
    v_smfmac_f32_32x32x32_bf16 v[80:95], a[64:67], v[16:23], v48
    v_exp_f32 v27, v27
    v_exp_f32 v28, v28
    v_exp_f32 v29, v29
    v_exp_f32 v30, v30
    v_exp_f32 v31, v31
    v_exp_f32 v32, v32
    v_exp_f32 v33, v33
    v_exp_f32 v34, v34
    v_smfmac_f32_32x32x32_bf16 v[80:95], a[68:71], v[24:31], v48
    v_exp_f32 v35, v35
    v_exp_f32 v36, v36
    v_mfma_f32_32x32x16_bf16 v[16:31], a[8:11], v[100:103], 0
    v_exp_f32 v37, v37
    v_exp_f32 v38, v38
    v_exp_f32 v39, v39
    v_exp_f32 v40, v40
    v_exp_f32 v41, v41
    v_exp_f32 v42, v42
    v_smfmac_f32_32x32x32_bf16 v[80:95], a[72:75], v[32:39], v48
    v_exp_f32 v43, v43
    v_exp_f32 v44, v44
    v_exp_f32 v45, v45
    v_exp_f32 v46, v46
    v_exp_f32 v47, v47
    v_exp_f32 v16, v16
    v_exp_f32 v17, v17
    v_exp_f32 v18, v18
    v_smfmac_f32_32x32x32_bf16 v[80:95], a[76:79], v[40:47], v48
    ds_write_b128 v56, v[64:67]
    v_exp_f32 v19, v19
    v_exp_f32 v20, v20
    v_mfma_f32_32x32x16_bf16 v[32:47], a[12:15], v[100:103], 0
    v_exp_f32 v21, v21
    ds_write_b128 v56, v[68:71] offset:1024
    v_exp_f32 v22, v22
    v_exp_f32 v23, v23
    ds_write_b32 v57, v72
    v_exp_f32 v24, v24
    v_exp_f32 v25, v25
    v_exp_f32 v26, v26
    v_smfmac_f32_32x32x32_bf16 v[80:95], a[80:83], v[16:23], v48
    v_exp_f32 v27, v27
    v_exp_f32 v28, v28
    v_exp_f32 v29, v29
    v_exp_f32 v30, v30
    v_exp_f32 v31, v31
    v_exp_f32 v32, v32
    v_exp_f32 v33, v33
    v_exp_f32 v34, v34
    v_smfmac_f32_32x32x32_bf16 v[80:95], a[84:87], v[24:31], v48
    v_add_u32 v56, 9216, v56
    v_exp_f32 v35, v35
    v_exp_f32 v36, v36
    v_mfma_f32_32x32x16_bf16 v[16:31], a[16:19], v[100:103], 0
    v_exp_f32 v37, v37
    v_add_u32 v57, 9216, v57
    v_exp_f32 v38, v38
    v_exp_f32 v39, v39
    v_exp_f32 v40, v40
    v_exp_f32 v41, v41
    v_exp_f32 v42, v42
    v_smfmac_f32_32x32x32_bf16 v[80:95], a[88:91], v[32:39], v48
    v_exp_f32 v43, v43
    v_exp_f32 v44, v44
    v_exp_f32 v45, v45
    v_exp_f32 v46, v46
    v_exp_f32 v47, v47
    v_exp_f32 v16, v16
    v_exp_f32 v17, v17
    v_exp_f32 v18, v18
    v_smfmac_f32_32x32x32_bf16 v[80:95], a[92:95], v[40:47], v48
    ds_read_b128 v[96:99], v58
    v_exp_f32 v19, v19
    v_exp_f32 v20, v20
    v_mfma_f32_32x32x16_bf16 v[32:47], a[20:23], v[100:103], 0
    v_exp_f32 v21, v21
    v_exp_f32 v22, v22
    v_exp_f32 v23, v23
    v_exp_f32 v24, v24
    v_exp_f32 v25, v25
    v_exp_f32 v26, v26
    v_smfmac_f32_32x32x32_bf16 v[80:95], a[96:99], v[16:23], v48
    v_exp_f32 v27, v27
    v_exp_f32 v28, v28
    v_exp_f32 v29, v29
    v_exp_f32 v30, v30
    v_exp_f32 v31, v31
    v_exp_f32 v32, v32
    v_exp_f32 v33, v33
    v_exp_f32 v34, v34
    v_smfmac_f32_32x32x32_bf16 v[80:95], a[100:103], v[24:31], v48
    v_add_u32 v58, 1024, v58
    v_exp_f32 v35, v35
    v_exp_f32 v36, v36
    v_mfma_f32_32x32x16_bf16 v[16:31], a[24:27], v[100:103], 0
    v_exp_f32 v37, v37
    v_exp_f32 v38, v38
    v_exp_f32 v39, v39
    v_exp_f32 v40, v40
    v_exp_f32 v41, v41
    v_exp_f32 v42, v42
    v_smfmac_f32_32x32x32_bf16 v[80:95], a[104:107], v[32:39], v48
    v_exp_f32 v43, v43
    v_exp_f32 v44, v44
    v_exp_f32 v45, v45
    v_exp_f32 v46, v46
    v_exp_f32 v47, v47
    v_exp_f32 v16, v16
    v_exp_f32 v17, v17
    v_exp_f32 v18, v18
    v_smfmac_f32_32x32x32_bf16 v[80:95], a[108:111], v[40:47], v48
    v_exp_f32 v19, v19
    v_exp_f32 v20, v20
    v_mfma_f32_32x32x16_bf16 v[32:47], a[28:31], v[100:103], 0
    v_exp_f32 v21, v21
    v_exp_f32 v22, v22
    v_exp_f32 v23, v23
    v_exp_f32 v24, v24
    v_exp_f32 v25, v25
    v_exp_f32 v26, v26
    v_smfmac_f32_32x32x32_bf16 v[80:95], a[112:115], v[16:23], v48
    v_exp_f32 v27, v27
    v_exp_f32 v28, v28
    v_exp_f32 v29, v29
    v_exp_f32 v30, v30
    v_exp_f32 v31, v31
    v_exp_f32 v32, v32
    v_exp_f32 v33, v33
    v_exp_f32 v34, v34
    v_smfmac_f32_32x32x32_bf16 v[80:95], a[116:119], v[24:31], v48
    v_exp_f32 v35, v35
    v_exp_f32 v36, v36
    v_mfma_f32_32x32x16_bf16 v[16:31], a[32:35], v[100:103], 0
    v_exp_f32 v37, v37
    v_exp_f32 v38, v38
    v_exp_f32 v39, v39
    v_exp_f32 v40, v40
    v_exp_f32 v41, v41
    v_exp_f32 v42, v42
    s_add_u32 m0, s74, 0
    s_add_u32 s76, s75, 0
    buffer_load_dwordx4 v4, s[24:27], s76 offen offset:0 lds
    buffer_load_dwordx4 v5, s[24:27], s76 offen offset:1024 lds
    v_smfmac_f32_32x32x32_bf16 v[80:95], a[120:123], v[32:39], v48
    v_exp_f32 v43, v43
    v_exp_f32 v44, v44
    v_exp_f32 v45, v45
    v_exp_f32 v46, v46
    v_exp_f32 v47, v47
    v_exp_f32 v16, v16
    v_exp_f32 v17, v17
    v_exp_f32 v18, v18
    v_smfmac_f32_32x32x32_bf16 v[80:95], a[124:127], v[40:47], v48
    v_exp_f32 v19, v19
    v_exp_f32 v20, v20
    v_mfma_f32_32x32x16_bf16 v[32:47], a[36:39], v[100:103], 0
    v_exp_f32 v21, v21
    v_exp_f32 v22, v22
    v_exp_f32 v23, v23
    v_exp_f32 v24, v24
    v_exp_f32 v25, v25
    v_exp_f32 v26, v26
    buffer_load_dwordx4 v6, s[24:27], s76 offen offset:2048 lds
    buffer_load_dwordx4 v7, s[24:27], s76 offen offset:3072 lds
    v_smfmac_f32_32x32x32_bf16 v[80:95], a[128:131], v[16:23], v48
    v_exp_f32 v27, v27
    v_exp_f32 v28, v28
    v_mfma_f32_32x32x16_bf16 v[64:79], v[52:55], v[52:55], 0
    v_exp_f32 v29, v29
    v_exp_f32 v30, v30
    v_exp_f32 v31, v31
    v_exp_f32 v32, v32
    v_exp_f32 v33, v33
    v_exp_f32 v34, v34
    v_smfmac_f32_32x32x32_bf16 v[80:95], a[132:135], v[24:31], v48
    v_exp_f32 v35, v35
    v_exp_f32 v36, v36
    v_mfma_f32_32x32x16_bf16 v[16:31], a[40:43], v[100:103], 0
    v_exp_f32 v37, v37
    v_exp_f32 v38, v38
    v_exp_f32 v39, v39
    v_exp_f32 v40, v40
    v_exp_f32 v41, v41
    v_exp_f32 v42, v42
    s_add_u32 m0, s74, 4096
    s_add_u32 s76, s75, 32768
    buffer_load_dwordx4 v4, s[24:27], s76 offen offset:0 lds
    buffer_load_dwordx4 v5, s[24:27], s76 offen offset:1024 lds
    v_smfmac_f32_32x32x32_bf16 v[80:95], a[136:139], v[32:39], v48
    v_exp_f32 v43, v43
    v_exp_f32 v44, v44
    v_exp_f32 v45, v45
    v_exp_f32 v46, v46
    v_exp_f32 v47, v47
    v_exp_f32 v16, v16
    v_exp_f32 v17, v17
    v_exp_f32 v18, v18
    v_smfmac_f32_32x32x32_bf16 v[80:95], a[140:143], v[40:47], v48
    v_exp_f32 v19, v19
    v_exp_f32 v20, v20
    v_mfma_f32_32x32x16_bf16 v[32:47], a[44:47], v[100:103], 0
    v_exp_f32 v21, v21
    v_exp_f32 v22, v22
    v_exp_f32 v23, v23
    v_exp_f32 v24, v24
    v_exp_f32 v25, v25
    v_exp_f32 v26, v26
    buffer_load_dwordx4 v6, s[24:27], s76 offen offset:2048 lds
    buffer_load_dwordx4 v7, s[24:27], s76 offen offset:3072 lds
    v_smfmac_f32_32x32x32_bf16 v[80:95], a[144:147], v[16:23], v48
    v_exp_f32 v27, v27
    v_exp_f32 v28, v28
    v_exp_f32 v29, v29
    v_exp_f32 v30, v30
    v_exp_f32 v31, v31
    v_exp_f32 v32, v32
    v_exp_f32 v33, v33
    v_exp_f32 v34, v34
    v_smfmac_f32_32x32x32_bf16 v[80:95], a[148:151], v[24:31], v48
    v_exp_f32 v35, v35
    v_exp_f32 v36, v36
    v_mfma_f32_32x32x16_bf16 v[16:31], a[48:51], v[100:103], 0
    v_exp_f32 v37, v37
    v_exp_f32 v38, v38
    v_exp_f32 v39, v39
    v_exp_f32 v40, v40
    v_exp_f32 v41, v41
    v_exp_f32 v42, v42
    s_add_u32 m0, s74, 8192
    s_add_u32 s76, s75, 65536
    buffer_load_dwordx4 v4, s[24:27], s76 offen offset:0 lds
    buffer_load_dwordx4 v5, s[24:27], s76 offen offset:1024 lds
    v_smfmac_f32_32x32x32_bf16 v[80:95], a[152:155], v[32:39], v48
    v_exp_f32 v43, v43
    v_exp_f32 v44, v44
    v_exp_f32 v45, v45
    v_exp_f32 v46, v46
    v_exp_f32 v47, v47
    v_exp_f32 v16, v16
    v_exp_f32 v17, v17
    v_exp_f32 v18, v18
    v_smfmac_f32_32x32x32_bf16 v[80:95], a[156:159], v[40:47], v48
    v_exp_f32 v19, v19
    v_exp_f32 v20, v20
    v_mfma_f32_32x32x16_bf16 v[32:47], a[52:55], v[100:103], 0
    v_exp_f32 v21, v21
    v_exp_f32 v22, v22
    v_exp_f32 v23, v23
    v_exp_f32 v24, v24
    v_exp_f32 v25, v25
    v_exp_f32 v26, v26
    buffer_load_dwordx4 v6, s[24:27], s76 offen offset:2048 lds
    buffer_load_dwordx4 v7, s[24:27], s76 offen offset:3072 lds
    v_smfmac_f32_32x32x32_bf16 v[80:95], a[160:163], v[16:23], v48
    v_exp_f32 v27, v27
    v_exp_f32 v28, v28
    v_exp_f32 v29, v29
    v_exp_f32 v30, v30
    v_exp_f32 v31, v31
    v_exp_f32 v32, v32
    v_exp_f32 v33, v33
    v_exp_f32 v34, v34
    v_smfmac_f32_32x32x32_bf16 v[80:95], a[164:167], v[24:31], v48
    v_exp_f32 v35, v35
    v_exp_f32 v36, v36
    v_mfma_f32_32x32x16_bf16 v[16:31], a[56:59], v[100:103], 0
    v_exp_f32 v37, v37
    v_exp_f32 v38, v38
    v_exp_f32 v39, v39
    v_exp_f32 v40, v40
    v_exp_f32 v41, v41
    v_exp_f32 v42, v42
    s_add_u32 m0, s74, 12288
    s_add_u32 s76, s75, 98304
    buffer_load_dwordx4 v4, s[24:27], s76 offen offset:0 lds
    buffer_load_dwordx4 v5, s[24:27], s76 offen offset:1024 lds
    v_smfmac_f32_32x32x32_bf16 v[80:95], a[168:171], v[32:39], v48
    v_exp_f32 v43, v43
    v_exp_f32 v44, v44
    v_exp_f32 v45, v45
    v_exp_f32 v46, v46
    v_exp_f32 v47, v47
    s_waitcnt lgkmcnt(0)
    v_exp_f32 v16, v16
    v_exp_f32 v17, v17
    v_exp_f32 v18, v18
    v_smfmac_f32_32x32x32_bf16 v[80:95], a[172:175], v[40:47], v48
    v_exp_f32 v19, v19
    v_exp_f32 v20, v20
    v_mfma_f32_32x32x16_bf16 v[32:47], a[60:63], v[100:103], 0
    v_exp_f32 v21, v21
    v_exp_f32 v22, v22
    v_exp_f32 v23, v23
    v_exp_f32 v24, v24
    v_exp_f32 v25, v25
    v_exp_f32 v26, v26
    buffer_load_dwordx4 v6, s[24:27], s76 offen offset:2048 lds
    buffer_load_dwordx4 v7, s[24:27], s76 offen offset:3072 lds
    v_smfmac_f32_32x32x32_bf16 v[80:95], a[176:179], v[16:23], v48
    v_exp_f32 v27, v27
    v_exp_f32 v28, v28
    v_exp_f32 v29, v29
    v_exp_f32 v30, v30
    v_exp_f32 v31, v31
    v_exp_f32 v32, v32
    v_exp_f32 v33, v33
    v_exp_f32 v34, v34
    v_smfmac_f32_32x32x32_bf16 v[80:95], a[180:183], v[24:31], v48
    v_exp_f32 v35, v35
    v_exp_f32 v36, v36
    v_mfma_f32_32x32x16_bf16 v[16:31], a[0:3], v[96:99], 0
    v_exp_f32 v37, v37
    v_exp_f32 v38, v38
    v_exp_f32 v39, v39
    v_exp_f32 v40, v40
    v_exp_f32 v41, v41
    v_exp_f32 v42, v42
    s_lshl_b32 s76, s62, 6
    buffer_load_dwordx4 a[192:195], v8, s[12:15], s76 offen
    buffer_load_dwordx4 a[196:199], v8, s[12:15], s76 offen offset:32
    v_smfmac_f32_32x32x32_bf16 v[80:95], a[184:187], v[32:39], v48
    v_exp_f32 v43, v43
    v_exp_f32 v44, v44
    v_exp_f32 v45, v45
    v_exp_f32 v46, v46
    v_exp_f32 v47, v47
    v_exp_f32 v16, v16
    v_exp_f32 v17, v17
    v_exp_f32 v18, v18
    v_smfmac_f32_32x32x32_bf16 v[80:95], a[188:191], v[40:47], v48
    v_exp_f32 v19, v19
    v_exp_f32 v20, v20
    v_mfma_f32_32x32x16_bf16 v[32:47], a[4:7], v[96:99], 0
    v_exp_f32 v21, v21
    v_exp_f32 v22, v22
    v_exp_f32 v23, v23
    v_exp_f32 v24, v24
    buffer_load_dword v49, v50, s[16:19], s78 offen
    v_exp_f32 v25, v25
    v_exp_f32 v26, v26
    v_smfmac_f32_32x32x32_bf16 v[64:79], a[64:67], v[16:23], v48
    v_exp_f32 v27, v27
    v_exp_f32 v28, v28
    v_exp_f32 v29, v29
    v_exp_f32 v30, v30
    v_exp_f32 v31, v31
    v_exp_f32 v32, v32
    v_exp_f32 v33, v33
    v_exp_f32 v34, v34
    v_smfmac_f32_32x32x32_bf16 v[64:79], a[68:71], v[24:31], v48
    v_exp_f32 v35, v35
    v_exp_f32 v36, v36
    v_mfma_f32_32x32x16_bf16 v[16:31], a[8:11], v[96:99], 0
    v_exp_f32 v37, v37
    v_exp_f32 v38, v38
    v_exp_f32 v39, v39
    v_exp_f32 v40, v40
    buffer_load_dword v49, v50, s[20:23], s78 offen
    v_exp_f32 v41, v41
    v_exp_f32 v42, v42
    v_smfmac_f32_32x32x32_bf16 v[64:79], a[72:75], v[32:39], v48
    v_exp_f32 v43, v43
    v_exp_f32 v44, v44
    v_exp_f32 v45, v45
    v_exp_f32 v46, v46
    v_exp_f32 v47, v47
    v_exp_f32 v16, v16
    v_exp_f32 v17, v17
    v_exp_f32 v18, v18
    v_smfmac_f32_32x32x32_bf16 v[64:79], a[76:79], v[40:47], v48
    ds_write_b128 v56, v[80:83]
    v_exp_f32 v19, v19
    v_exp_f32 v20, v20
    v_mfma_f32_32x32x16_bf16 v[32:47], a[12:15], v[96:99], 0
    v_exp_f32 v21, v21
    ds_write_b128 v56, v[84:87] offset:1024
    v_exp_f32 v22, v22
    v_exp_f32 v23, v23
    ds_write_b32 v57, v88
    v_exp_f32 v24, v24
    s_add_u32 s78, s78, 4096
    buffer_load_dword v49, v50, s[16:19], s78 offen
    v_exp_f32 v25, v25
    v_exp_f32 v26, v26
    v_smfmac_f32_32x32x32_bf16 v[64:79], a[80:83], v[16:23], v48
    v_exp_f32 v27, v27
    v_exp_f32 v28, v28
    v_exp_f32 v29, v29
    v_exp_f32 v30, v30
    v_exp_f32 v31, v31
    v_exp_f32 v32, v32
    v_exp_f32 v33, v33
    v_exp_f32 v34, v34
    v_smfmac_f32_32x32x32_bf16 v[64:79], a[84:87], v[24:31], v48
    v_add_u32 v56, 9216, v56
    v_exp_f32 v35, v35
    v_exp_f32 v36, v36
    v_mfma_f32_32x32x16_bf16 v[16:31], a[16:19], v[96:99], 0
    v_exp_f32 v37, v37
    v_add_u32 v57, 9216, v57
    v_exp_f32 v38, v38
    v_exp_f32 v39, v39
    v_exp_f32 v40, v40
    buffer_load_dword v49, v50, s[20:23], s78 offen
    v_exp_f32 v41, v41
    v_exp_f32 v42, v42
    v_smfmac_f32_32x32x32_bf16 v[64:79], a[88:91], v[32:39], v48
    v_exp_f32 v43, v43
    v_exp_f32 v44, v44
    v_exp_f32 v45, v45
    v_exp_f32 v46, v46
    v_exp_f32 v47, v47
    v_exp_f32 v16, v16
    s_and_b32 s3, s4, 1
    v_exp_f32 v17, v17
    v_exp_f32 v18, v18
    v_smfmac_f32_32x32x32_bf16 v[64:79], a[92:95], v[40:47], v48
    ds_read_b128 v[100:103], v58
    s_lshl_b32 s3, s3, 3
    v_exp_f32 v19, v19
    v_exp_f32 v20, v20
    v_mfma_f32_32x32x16_bf16 v[32:47], a[20:23], v[96:99], 0
    v_exp_f32 v21, v21
    s_add_u32 s3, s3, s5
    v_exp_f32 v22, v22
    v_exp_f32 v23, v23
    v_exp_f32 v24, v24
    s_min_u32 s7, s3, 11
    v_exp_f32 v25, v25
    v_exp_f32 v26, v26
    v_smfmac_f32_32x32x32_bf16 v[64:79], a[96:99], v[16:23], v48
    s_lshl_b32 s7, s7, 1
    v_exp_f32 v27, v27
    v_exp_f32 v28, v28
    v_exp_f32 v29, v29
    v_exp_f32 v30, v30
    v_exp_f32 v31, v31
    v_exp_f32 v32, v32
    s_lshl_b32 s66, s3, 2
    v_exp_f32 v33, v33
    v_exp_f32 v34, v34
    v_smfmac_f32_32x32x32_bf16 v[64:79], a[100:103], v[24:31], v48
    v_add_u32 v58, 1024, v58
    s_add_u32 s66, s66, s7
    v_exp_f32 v35, v35
    v_exp_f32 v36, v36
    v_mfma_f32_32x32x16_bf16 v[16:31], a[24:27], v[96:99], 0
    v_exp_f32 v37, v37
    s_cmp_lt_u32 s3, 11
    s_cselect_b32 s67, 6, 4
    v_exp_f32 v38, v38
    v_exp_f32 v39, v39
    v_exp_f32 v40, v40
    v_add_u32 v11, 0, v0
    v_exp_f32 v41, v41
    v_exp_f32 v42, v42
    v_smfmac_f32_32x32x32_bf16 v[64:79], a[104:107], v[32:39], v48
    v_mul_u32_u24 v12, 5462, v11
    v_exp_f32 v43, v43
    v_exp_f32 v44, v44
    v_exp_f32 v45, v45
    v_exp_f32 v46, v46
    v_exp_f32 v47, v47
    v_exp_f32 v16, v16
    v_lshrrev_b32 v12, 16, v12
    v_exp_f32 v17, v17
    v_exp_f32 v18, v18
    v_smfmac_f32_32x32x32_bf16 v[64:79], a[108:111], v[40:47], v48
    v_mul_u32_u24 v13, 12, v12
    v_exp_f32 v19, v19
    v_exp_f32 v20, v20
    v_mfma_f32_32x32x16_bf16 v[32:47], a[28:31], v[96:99], 0
    v_exp_f32 v21, v21
    v_sub_u32 v13, v11, v13
    v_exp_f32 v22, v22
    v_exp_f32 v23, v23
    v_exp_f32 v24, v24
    v_mul_u32_u24 v12, 2752, v12
    v_exp_f32 v25, v25
    v_exp_f32 v26, v26
    v_smfmac_f32_32x32x32_bf16 v[64:79], a[112:115], v[16:23], v48
    v_lshl_add_u32 v2, v13, 4, v12
    v_exp_f32 v27, v27
    v_exp_f32 v28, v28
    v_exp_f32 v29, v29
    v_exp_f32 v30, v30
    v_exp_f32 v31, v31
    v_exp_f32 v32, v32
    v_add_u32 v13, 10, v13
    v_exp_f32 v33, v33
    v_exp_f32 v34, v34
    v_smfmac_f32_32x32x32_bf16 v[64:79], a[116:119], v[24:31], v48
    v_subrev_u32 v14, 12, v13
    v_exp_f32 v35, v35
    v_exp_f32 v36, v36
    v_mfma_f32_32x32x16_bf16 v[16:31], a[32:35], v[96:99], 0
    v_exp_f32 v37, v37
    v_min_u32 v13, v13, v14
    v_exp_f32 v38, v38
    v_exp_f32 v39, v39
    v_exp_f32 v40, v40
    v_lshl_add_u32 v5, v13, 4, v12
    v_exp_f32 v41, v41
    v_exp_f32 v42, v42
    v_smfmac_f32_32x32x32_bf16 v[64:79], a[120:123], v[32:39], v48
    v_add_u32 v11, 64, v0
    v_exp_f32 v43, v43
    v_exp_f32 v44, v44
    v_exp_f32 v45, v45
    v_exp_f32 v46, v46
    v_exp_f32 v47, v47
    v_exp_f32 v16, v16
    v_mul_u32_u24 v12, 5462, v11
    v_exp_f32 v17, v17
    v_exp_f32 v18, v18
    v_smfmac_f32_32x32x32_bf16 v[64:79], a[124:127], v[40:47], v48
    v_lshrrev_b32 v12, 16, v12
    v_exp_f32 v19, v19
    v_exp_f32 v20, v20
    v_mfma_f32_32x32x16_bf16 v[32:47], a[36:39], v[96:99], 0
    v_exp_f32 v21, v21
    v_mul_u32_u24 v13, 12, v12
    v_exp_f32 v22, v22
    v_exp_f32 v23, v23
    v_exp_f32 v24, v24
    v_sub_u32 v13, v11, v13
    v_exp_f32 v25, v25
    v_exp_f32 v26, v26
    v_smfmac_f32_32x32x32_bf16 v[64:79], a[128:131], v[16:23], v48
    v_mul_u32_u24 v12, 2752, v12
    v_exp_f32 v27, v27
    v_exp_f32 v28, v28
    v_mfma_f32_32x32x16_bf16 v[80:95], v[52:55], v[52:55], 0
    v_exp_f32 v29, v29
    v_exp_f32 v30, v30
    v_exp_f32 v31, v31
    v_exp_f32 v32, v32
    v_subrev_u32 v12, 1024, v12
    v_exp_f32 v33, v33
    v_exp_f32 v34, v34
    v_smfmac_f32_32x32x32_bf16 v[64:79], a[132:135], v[24:31], v48
    v_lshl_add_u32 v3, v13, 4, v12
    v_exp_f32 v35, v35
    v_exp_f32 v36, v36
    v_mfma_f32_32x32x16_bf16 v[16:31], a[40:43], v[96:99], 0
    v_exp_f32 v37, v37
    v_add_u32 v13, 10, v13
    v_exp_f32 v38, v38
    v_exp_f32 v39, v39
    v_exp_f32 v40, v40
    v_subrev_u32 v14, 12, v13
    v_exp_f32 v41, v41
    v_exp_f32 v42, v42
    v_smfmac_f32_32x32x32_bf16 v[64:79], a[136:139], v[32:39], v48
    v_min_u32 v13, v13, v14
    v_exp_f32 v43, v43
    v_exp_f32 v44, v44
    v_exp_f32 v45, v45
    v_exp_f32 v46, v46
    v_exp_f32 v47, v47
    v_exp_f32 v16, v16
    v_lshl_add_u32 v6, v13, 4, v12
    v_exp_f32 v17, v17
    v_exp_f32 v18, v18
    v_smfmac_f32_32x32x32_bf16 v[64:79], a[140:143], v[40:47], v48
    v_add_u32 v11, 128, v0
    v_exp_f32 v19, v19
    v_exp_f32 v20, v20
    v_mfma_f32_32x32x16_bf16 v[32:47], a[44:47], v[96:99], 0
    v_exp_f32 v21, v21
    v_mul_u32_u24 v12, 5462, v11
    v_exp_f32 v22, v22
    v_exp_f32 v23, v23
    v_exp_f32 v24, v24
    v_lshrrev_b32 v12, 16, v12
    v_exp_f32 v25, v25
    v_exp_f32 v26, v26
    v_smfmac_f32_32x32x32_bf16 v[64:79], a[144:147], v[16:23], v48
    v_mul_u32_u24 v13, 12, v12
    v_exp_f32 v27, v27
    v_exp_f32 v28, v28
    v_exp_f32 v29, v29
    v_exp_f32 v30, v30
    v_exp_f32 v31, v31
    v_exp_f32 v32, v32
    v_sub_u32 v13, v11, v13
    v_exp_f32 v33, v33
    v_exp_f32 v34, v34
    v_smfmac_f32_32x32x32_bf16 v[64:79], a[148:151], v[24:31], v48
    v_mul_u32_u24 v12, 2752, v12
    v_exp_f32 v35, v35
    v_exp_f32 v36, v36
    v_mfma_f32_32x32x16_bf16 v[16:31], a[48:51], v[96:99], 0
    v_exp_f32 v37, v37
    v_subrev_u32 v12, 2048, v12
    v_exp_f32 v38, v38
    v_exp_f32 v39, v39
    v_exp_f32 v40, v40
    v_lshl_add_u32 v4, v13, 4, v12
    v_exp_f32 v41, v41
    v_exp_f32 v42, v42
    v_smfmac_f32_32x32x32_bf16 v[64:79], a[152:155], v[32:39], v48
    v_add_u32 v13, 10, v13
    v_exp_f32 v43, v43
    v_exp_f32 v44, v44
    v_exp_f32 v45, v45
    v_exp_f32 v46, v46
    v_exp_f32 v47, v47
    v_exp_f32 v16, v16
    v_subrev_u32 v14, 12, v13
    v_exp_f32 v17, v17
    v_exp_f32 v18, v18
    v_smfmac_f32_32x32x32_bf16 v[64:79], a[156:159], v[40:47], v48
    v_min_u32 v13, v13, v14
    v_exp_f32 v19, v19
    v_exp_f32 v20, v20
    v_mfma_f32_32x32x16_bf16 v[32:47], a[52:55], v[96:99], 0
    v_exp_f32 v21, v21
    v_lshl_add_u32 v7, v13, 4, v12
    v_exp_f32 v22, v22
    v_exp_f32 v23, v23
    v_exp_f32 v24, v24
    s_mul_i32 s68, s6, 44032
    v_exp_f32 v25, v25
    v_exp_f32 v26, v26
    v_smfmac_f32_32x32x32_bf16 v[64:79], a[160:163], v[16:23], v48
    s_lshl_b32 s3, s66, 5
    v_exp_f32 v27, v27
    v_exp_f32 v28, v28
    v_exp_f32 v29, v29
    v_exp_f32 v30, v30
    v_exp_f32 v31, v31
    v_exp_f32 v32, v32
    s_add_u32 s68, s68, s3
    v_exp_f32 v33, v33
    v_exp_f32 v34, v34
    v_smfmac_f32_32x32x32_bf16 v[64:79], a[164:167], v[24:31], v48
    s_mul_i32 s69, s6, 3072
    v_exp_f32 v35, v35
    v_exp_f32 v36, v36
    v_mfma_f32_32x32x16_bf16 v[16:31], a[56:59], v[96:99], 0
    v_exp_f32 v37, v37
    v_exp_f32 v38, v38
    v_exp_f32 v39, v39
    v_exp_f32 v40, v40
    v_exp_f32 v41, v41
    v_exp_f32 v42, v42
    v_smfmac_f32_32x32x32_bf16 v[64:79], a[168:171], v[32:39], v48
    v_exp_f32 v43, v43
    v_exp_f32 v44, v44
    v_exp_f32 v45, v45
    v_exp_f32 v46, v46
    v_exp_f32 v47, v47
    s_waitcnt lgkmcnt(0)
    v_exp_f32 v16, v16
    v_exp_f32 v17, v17
    v_exp_f32 v18, v18
    v_smfmac_f32_32x32x32_bf16 v[64:79], a[172:175], v[40:47], v48
    v_exp_f32 v19, v19
    v_exp_f32 v20, v20
    v_mfma_f32_32x32x16_bf16 v[32:47], a[60:63], v[96:99], 0
    v_exp_f32 v21, v21
    v_exp_f32 v22, v22
    v_exp_f32 v23, v23
    v_exp_f32 v24, v24
    v_exp_f32 v25, v25
    v_exp_f32 v26, v26
    v_smfmac_f32_32x32x32_bf16 v[64:79], a[176:179], v[16:23], v48
    v_exp_f32 v27, v27
    v_exp_f32 v28, v28
    v_exp_f32 v29, v29
    v_exp_f32 v30, v30
    v_exp_f32 v31, v31
    v_exp_f32 v32, v32
    v_exp_f32 v33, v33
    v_exp_f32 v34, v34
    v_smfmac_f32_32x32x32_bf16 v[64:79], a[180:183], v[24:31], v48
    v_exp_f32 v35, v35
    v_exp_f32 v36, v36
    v_mfma_f32_32x32x16_bf16 v[16:31], a[0:3], v[100:103], 0
    v_exp_f32 v37, v37
    v_exp_f32 v38, v38
    v_exp_f32 v39, v39
    v_exp_f32 v40, v40
    v_exp_f32 v41, v41
    v_exp_f32 v42, v42
    v_smfmac_f32_32x32x32_bf16 v[64:79], a[184:187], v[32:39], v48
    v_exp_f32 v43, v43
    v_exp_f32 v44, v44
    v_exp_f32 v45, v45
    v_exp_f32 v46, v46
    v_exp_f32 v47, v47
    s_waitcnt vmcnt(4)
    s_barrier
    v_exp_f32 v16, v16
    ds_read_b64_tr_b16 v[128:129], v10 offset:0
    v_exp_f32 v17, v17
    v_exp_f32 v18, v18
    v_smfmac_f32_32x32x32_bf16 v[64:79], a[188:191], v[40:47], v48
    ds_read_b64_tr_b16 v[130:131], v10 offset:512
    v_exp_f32 v19, v19
    v_exp_f32 v20, v20
    v_mfma_f32_32x32x16_bf16 v[32:47], a[4:7], v[100:103], 0
    v_exp_f32 v21, v21
    ds_read_b64_tr_b16 v[132:133], v1 offset:0
    v_exp_f32 v22, v22
    v_exp_f32 v23, v23
    v_exp_f32 v24, v24
    ds_read_b64_tr_b16 v[134:135], v1 offset:512
    v_exp_f32 v25, v25
    v_exp_f32 v26, v26
    v_smfmac_f32_32x32x32_bf16 v[80:95], a[64:67], v[16:23], v48
    ds_read_b64_tr_b16 v[136:137], v10 offset:2048
    v_exp_f32 v27, v27
    v_exp_f32 v28, v28
    v_exp_f32 v29, v29
    v_exp_f32 v30, v30
    v_exp_f32 v31, v31
    v_exp_f32 v32, v32
    ds_read_b64_tr_b16 v[138:139], v10 offset:2560
    v_exp_f32 v33, v33
    v_exp_f32 v34, v34
    v_smfmac_f32_32x32x32_bf16 v[80:95], a[68:71], v[24:31], v48
    ds_read_b64_tr_b16 v[140:141], v1 offset:2048
    v_exp_f32 v35, v35
    v_exp_f32 v36, v36
    v_mfma_f32_32x32x16_bf16 v[16:31], a[8:11], v[100:103], 0
    v_exp_f32 v37, v37
    ds_read_b64_tr_b16 v[142:143], v1 offset:2560
    v_exp_f32 v38, v38
    v_exp_f32 v39, v39
    v_exp_f32 v40, v40
    ds_read_b64_tr_b16 v[144:145], v10 offset:4096
    v_exp_f32 v41, v41
    v_exp_f32 v42, v42
    v_smfmac_f32_32x32x32_bf16 v[80:95], a[72:75], v[32:39], v48
    ds_read_b64_tr_b16 v[146:147], v10 offset:4608
    v_exp_f32 v43, v43
    v_exp_f32 v44, v44
    v_exp_f32 v45, v45
    v_exp_f32 v46, v46
    v_exp_f32 v47, v47
    v_exp_f32 v16, v16
    ds_read_b64_tr_b16 v[148:149], v1 offset:4096
    v_exp_f32 v17, v17
    v_exp_f32 v18, v18
    v_smfmac_f32_32x32x32_bf16 v[80:95], a[76:79], v[40:47], v48
    ds_write_b128 v56, v[64:67]
    ds_read_b64_tr_b16 v[150:151], v1 offset:4608
    v_exp_f32 v19, v19
    v_exp_f32 v20, v20
    v_mfma_f32_32x32x16_bf16 v[32:47], a[12:15], v[100:103], 0
    v_exp_f32 v21, v21
    ds_write_b128 v56, v[68:71] offset:1024
    ds_read_b64_tr_b16 v[152:153], v10 offset:6144
    v_exp_f32 v22, v22
    v_exp_f32 v23, v23
    ds_write_b32 v57, v72
    v_exp_f32 v24, v24
    ds_read_b64_tr_b16 v[154:155], v10 offset:6656
    v_exp_f32 v25, v25
    v_exp_f32 v26, v26
    v_smfmac_f32_32x32x32_bf16 v[80:95], a[80:83], v[16:23], v48
    ds_read_b64_tr_b16 v[156:157], v1 offset:6144
    v_exp_f32 v27, v27
    v_exp_f32 v28, v28
    v_exp_f32 v29, v29
    v_exp_f32 v30, v30
    v_exp_f32 v31, v31
    v_exp_f32 v32, v32
    ds_read_b64_tr_b16 v[158:159], v1 offset:6656
    v_exp_f32 v33, v33
    v_exp_f32 v34, v34
    v_smfmac_f32_32x32x32_bf16 v[80:95], a[84:87], v[24:31], v48
    v_add_u32 v56, 9216, v56
    ds_read_b64_tr_b16 v[160:161], v10 offset:8192
    v_exp_f32 v35, v35
    v_exp_f32 v36, v36
    v_mfma_f32_32x32x16_bf16 v[16:31], a[16:19], v[100:103], 0
    v_exp_f32 v37, v37
    v_add_u32 v57, 9216, v57
    ds_read_b64_tr_b16 v[162:163], v10 offset:8704
    v_exp_f32 v38, v38
    v_exp_f32 v39, v39
    v_exp_f32 v40, v40
    ds_read_b64_tr_b16 v[164:165], v1 offset:8192
    v_exp_f32 v41, v41
    v_exp_f32 v42, v42
    v_smfmac_f32_32x32x32_bf16 v[80:95], a[88:91], v[32:39], v48
    ds_read_b64_tr_b16 v[166:167], v1 offset:8704
    v_exp_f32 v43, v43
    v_exp_f32 v44, v44
    v_exp_f32 v45, v45
    v_exp_f32 v46, v46
    v_exp_f32 v47, v47
    v_exp_f32 v16, v16
    ds_read_b64_tr_b16 v[168:169], v10 offset:10240
    v_exp_f32 v17, v17
    v_exp_f32 v18, v18
    v_smfmac_f32_32x32x32_bf16 v[80:95], a[92:95], v[40:47], v48
    ds_read_b128 v[96:99], v58
    ds_read_b64_tr_b16 v[170:171], v10 offset:10752
    v_exp_f32 v19, v19
    v_exp_f32 v20, v20
    v_mfma_f32_32x32x16_bf16 v[32:47], a[20:23], v[100:103], 0
    v_exp_f32 v21, v21
    ds_read_b64_tr_b16 v[172:173], v1 offset:10240
    v_exp_f32 v22, v22
    v_exp_f32 v23, v23
    v_exp_f32 v24, v24
    ds_read_b64_tr_b16 v[174:175], v1 offset:10752
    v_exp_f32 v25, v25
    v_exp_f32 v26, v26
    v_smfmac_f32_32x32x32_bf16 v[80:95], a[96:99], v[16:23], v48
    ds_read_b64_tr_b16 v[176:177], v10 offset:12288
    v_exp_f32 v27, v27
    v_exp_f32 v28, v28
    v_exp_f32 v29, v29
    v_exp_f32 v30, v30
    v_exp_f32 v31, v31
    v_exp_f32 v32, v32
    ds_read_b64_tr_b16 v[178:179], v10 offset:12800
    v_exp_f32 v33, v33
    v_exp_f32 v34, v34
    v_smfmac_f32_32x32x32_bf16 v[80:95], a[100:103], v[24:31], v48
    v_add_u32 v58, 1024, v58
    ds_read_b64_tr_b16 v[180:181], v1 offset:12288
    v_exp_f32 v35, v35
    v_exp_f32 v36, v36
    v_mfma_f32_32x32x16_bf16 v[16:31], a[24:27], v[100:103], 0
    v_exp_f32 v37, v37
    ds_read_b64_tr_b16 v[182:183], v1 offset:12800
    v_exp_f32 v38, v38
    v_exp_f32 v39, v39
    v_exp_f32 v40, v40
    ds_read_b64_tr_b16 v[184:185], v10 offset:14336
    v_exp_f32 v41, v41
    v_exp_f32 v42, v42
    v_smfmac_f32_32x32x32_bf16 v[80:95], a[104:107], v[32:39], v48
    ds_read_b64_tr_b16 v[186:187], v10 offset:14848
    v_exp_f32 v43, v43
    v_exp_f32 v44, v44
    v_exp_f32 v45, v45
    v_exp_f32 v46, v46
    v_exp_f32 v47, v47
    v_exp_f32 v16, v16
    ds_read_b64_tr_b16 v[188:189], v1 offset:14336
    v_exp_f32 v17, v17
    v_exp_f32 v18, v18
    v_smfmac_f32_32x32x32_bf16 v[80:95], a[108:111], v[40:47], v48
    ds_read_b64_tr_b16 v[190:191], v1 offset:14848
    v_exp_f32 v19, v19
    v_exp_f32 v20, v20
    v_mfma_f32_32x32x16_bf16 v[32:47], a[28:31], v[100:103], 0
    v_exp_f32 v21, v21
    ds_read_b64_tr_b16 v[192:193], v10 offset:16384
    v_exp_f32 v22, v22
    v_exp_f32 v23, v23
    v_exp_f32 v24, v24
    ds_read_b64_tr_b16 v[194:195], v10 offset:16896
    v_exp_f32 v25, v25
    v_exp_f32 v26, v26
    v_smfmac_f32_32x32x32_bf16 v[80:95], a[112:115], v[16:23], v48
    ds_read_b64_tr_b16 v[196:197], v1 offset:16384
    v_exp_f32 v27, v27
    v_exp_f32 v28, v28
    v_exp_f32 v29, v29
    v_exp_f32 v30, v30
    v_exp_f32 v31, v31
    v_exp_f32 v32, v32
    ds_read_b64_tr_b16 v[198:199], v1 offset:16896
    v_exp_f32 v33, v33
    v_exp_f32 v34, v34
    v_smfmac_f32_32x32x32_bf16 v[80:95], a[116:119], v[24:31], v48
    ds_read_b64_tr_b16 v[200:201], v10 offset:18432
    v_exp_f32 v35, v35
    v_exp_f32 v36, v36
    v_mfma_f32_32x32x16_bf16 v[16:31], a[32:35], v[100:103], 0
    v_exp_f32 v37, v37
    ds_read_b64_tr_b16 v[202:203], v10 offset:18944
    v_exp_f32 v38, v38
    v_exp_f32 v39, v39
    v_exp_f32 v40, v40
    ds_read_b64_tr_b16 v[204:205], v1 offset:18432
    v_exp_f32 v41, v41
    v_exp_f32 v42, v42
    v_smfmac_f32_32x32x32_bf16 v[80:95], a[120:123], v[32:39], v48
    ds_read_b64_tr_b16 v[206:207], v1 offset:18944
    v_exp_f32 v43, v43
    v_exp_f32 v44, v44
    v_exp_f32 v45, v45
    v_exp_f32 v46, v46
    v_exp_f32 v47, v47
    v_exp_f32 v16, v16
    ds_read_b64_tr_b16 v[208:209], v10 offset:20480
    v_exp_f32 v17, v17
    v_exp_f32 v18, v18
    v_smfmac_f32_32x32x32_bf16 v[80:95], a[124:127], v[40:47], v48
    ds_read_b64_tr_b16 v[210:211], v10 offset:20992
    v_exp_f32 v19, v19
    v_exp_f32 v20, v20
    v_mfma_f32_32x32x16_bf16 v[32:47], a[36:39], v[100:103], 0
    v_exp_f32 v21, v21
    ds_read_b64_tr_b16 v[212:213], v1 offset:20480
    v_exp_f32 v22, v22
    v_exp_f32 v23, v23
    v_exp_f32 v24, v24
    ds_read_b64_tr_b16 v[214:215], v1 offset:20992
    v_exp_f32 v25, v25
    v_exp_f32 v26, v26
    v_smfmac_f32_32x32x32_bf16 v[80:95], a[128:131], v[16:23], v48
    ds_read_b64_tr_b16 v[216:217], v10 offset:22528
    v_exp_f32 v27, v27
    v_exp_f32 v28, v28
    v_mfma_f32_32x32x16_bf16 v[64:79], v[52:55], v[52:55], 0
    v_exp_f32 v29, v29
    v_exp_f32 v30, v30
    v_exp_f32 v31, v31
    v_exp_f32 v32, v32
    ds_read_b64_tr_b16 v[218:219], v10 offset:23040
    v_exp_f32 v33, v33
    v_exp_f32 v34, v34
    v_smfmac_f32_32x32x32_bf16 v[80:95], a[132:135], v[24:31], v48
    ds_read_b64_tr_b16 v[220:221], v1 offset:22528
    v_exp_f32 v35, v35
    v_exp_f32 v36, v36
    v_mfma_f32_32x32x16_bf16 v[16:31], a[40:43], v[100:103], 0
    v_exp_f32 v37, v37
    ds_read_b64_tr_b16 v[222:223], v1 offset:23040
    v_exp_f32 v38, v38
    v_exp_f32 v39, v39
    v_exp_f32 v40, v40
    ds_read_b64_tr_b16 v[224:225], v10 offset:24576
    v_exp_f32 v41, v41
    v_exp_f32 v42, v42
    v_smfmac_f32_32x32x32_bf16 v[80:95], a[136:139], v[32:39], v48
    ds_read_b64_tr_b16 v[226:227], v10 offset:25088
    v_exp_f32 v43, v43
    v_exp_f32 v44, v44
    v_exp_f32 v45, v45
    v_exp_f32 v46, v46
    v_exp_f32 v47, v47
    v_exp_f32 v16, v16
    ds_read_b64_tr_b16 v[228:229], v1 offset:24576
    v_exp_f32 v17, v17
    v_exp_f32 v18, v18
    v_smfmac_f32_32x32x32_bf16 v[80:95], a[140:143], v[40:47], v48
    ds_read_b64_tr_b16 v[230:231], v1 offset:25088
    v_exp_f32 v19, v19
    v_exp_f32 v20, v20
    v_mfma_f32_32x32x16_bf16 v[32:47], a[44:47], v[100:103], 0
    v_exp_f32 v21, v21
    ds_read_b64_tr_b16 v[232:233], v10 offset:26624
    v_exp_f32 v22, v22
    v_exp_f32 v23, v23
    v_exp_f32 v24, v24
    ds_read_b64_tr_b16 v[234:235], v10 offset:27136
    v_exp_f32 v25, v25
    v_exp_f32 v26, v26
    v_smfmac_f32_32x32x32_bf16 v[80:95], a[144:147], v[16:23], v48
    ds_read_b64_tr_b16 v[236:237], v1 offset:26624
    v_exp_f32 v27, v27
    v_exp_f32 v28, v28
    v_exp_f32 v29, v29
    v_exp_f32 v30, v30
    v_exp_f32 v31, v31
    v_exp_f32 v32, v32
    ds_read_b64_tr_b16 v[238:239], v1 offset:27136
    v_exp_f32 v33, v33
    v_exp_f32 v34, v34
    v_smfmac_f32_32x32x32_bf16 v[80:95], a[148:151], v[24:31], v48
    ds_read_b64_tr_b16 v[240:241], v10 offset:28672
    v_exp_f32 v35, v35
    v_exp_f32 v36, v36
    v_mfma_f32_32x32x16_bf16 v[16:31], a[48:51], v[100:103], 0
    v_exp_f32 v37, v37
    ds_read_b64_tr_b16 v[242:243], v10 offset:29184
    v_exp_f32 v38, v38
    v_exp_f32 v39, v39
    v_exp_f32 v40, v40
    ds_read_b64_tr_b16 v[244:245], v1 offset:28672
    v_exp_f32 v41, v41
    v_exp_f32 v42, v42
    v_smfmac_f32_32x32x32_bf16 v[80:95], a[152:155], v[32:39], v48
    ds_read_b64_tr_b16 v[246:247], v1 offset:29184
    v_exp_f32 v43, v43
    v_exp_f32 v44, v44
    v_exp_f32 v45, v45
    v_exp_f32 v46, v46
    v_exp_f32 v47, v47
    v_exp_f32 v16, v16
    ds_read_b64_tr_b16 v[248:249], v10 offset:30720
    v_exp_f32 v17, v17
    v_exp_f32 v18, v18
    v_smfmac_f32_32x32x32_bf16 v[80:95], a[156:159], v[40:47], v48
    ds_read_b64_tr_b16 v[250:251], v10 offset:31232
    v_exp_f32 v19, v19
    v_exp_f32 v20, v20
    v_mfma_f32_32x32x16_bf16 v[32:47], a[52:55], v[100:103], 0
    v_exp_f32 v21, v21
    ds_read_b64_tr_b16 v[252:253], v1 offset:30720
    v_exp_f32 v22, v22
    v_exp_f32 v23, v23
    v_exp_f32 v24, v24
    ds_read_b64_tr_b16 v[254:255], v1 offset:31232
    v_exp_f32 v25, v25
    v_exp_f32 v26, v26
    v_smfmac_f32_32x32x32_bf16 v[80:95], a[160:163], v[16:23], v48
    v_exp_f32 v27, v27
    v_exp_f32 v28, v28
    v_exp_f32 v29, v29
    v_exp_f32 v30, v30
    v_exp_f32 v31, v31
    v_exp_f32 v32, v32
    v_exp_f32 v33, v33
    v_exp_f32 v34, v34
    v_smfmac_f32_32x32x32_bf16 v[80:95], a[164:167], v[24:31], v48
    v_exp_f32 v35, v35
    v_exp_f32 v36, v36
    v_mfma_f32_32x32x16_bf16 v[16:31], a[56:59], v[100:103], 0
    v_exp_f32 v37, v37
    v_exp_f32 v38, v38
    v_exp_f32 v39, v39
    v_exp_f32 v40, v40
    v_exp_f32 v41, v41
    v_exp_f32 v42, v42
    v_smfmac_f32_32x32x32_bf16 v[80:95], a[168:171], v[32:39], v48
    v_exp_f32 v43, v43
    v_exp_f32 v44, v44
    v_exp_f32 v45, v45
    v_exp_f32 v46, v46
    v_exp_f32 v47, v47
    s_waitcnt lgkmcnt(0)
    v_exp_f32 v16, v16
    v_exp_f32 v17, v17
    v_exp_f32 v18, v18
    v_smfmac_f32_32x32x32_bf16 v[80:95], a[172:175], v[40:47], v48
    v_exp_f32 v19, v19
    v_exp_f32 v20, v20
    v_mfma_f32_32x32x16_bf16 v[32:47], a[60:63], v[100:103], 0
    v_exp_f32 v21, v21
    v_exp_f32 v22, v22
    v_exp_f32 v23, v23
    v_exp_f32 v24, v24
    v_exp_f32 v25, v25
    v_exp_f32 v26, v26
    v_smfmac_f32_32x32x32_bf16 v[80:95], a[176:179], v[16:23], v48
    v_exp_f32 v27, v27
    v_exp_f32 v28, v28
    v_exp_f32 v29, v29
    v_exp_f32 v30, v30
    v_exp_f32 v31, v31
    v_exp_f32 v32, v32
    v_exp_f32 v33, v33
    v_exp_f32 v34, v34
    v_smfmac_f32_32x32x32_bf16 v[80:95], a[180:183], v[24:31], v48
    v_exp_f32 v35, v35
    v_exp_f32 v36, v36
    v_mfma_f32_32x32x16_bf16 v[16:31], a[0:3], v[96:99], 0
    v_exp_f32 v37, v37
    v_exp_f32 v38, v38
    v_exp_f32 v39, v39
    v_exp_f32 v40, v40
    v_exp_f32 v41, v41
    v_exp_f32 v42, v42
    v_smfmac_f32_32x32x32_bf16 v[80:95], a[184:187], v[32:39], v48
    v_exp_f32 v43, v43
    v_exp_f32 v44, v44
    v_exp_f32 v45, v45
    v_exp_f32 v46, v46
    v_exp_f32 v47, v47
    s_barrier
    v_exp_f32 v16, v16
    v_exp_f32 v17, v17
    v_exp_f32 v18, v18
    v_smfmac_f32_32x32x32_bf16 v[80:95], a[188:191], v[40:47], v48
    v_exp_f32 v19, v19
    v_exp_f32 v20, v20
    v_mfma_f32_32x32x16_bf16 v[32:47], a[4:7], v[96:99], 0
    v_exp_f32 v21, v21
    v_exp_f32 v22, v22
    v_exp_f32 v23, v23
    v_exp_f32 v24, v24
    v_exp_f32 v25, v25
    v_exp_f32 v26, v26
    v_smfmac_f32_32x32x32_bf16 v[64:79], a[64:67], v[16:23], v48
    v_exp_f32 v27, v27
    v_exp_f32 v28, v28
    v_exp_f32 v29, v29
    v_exp_f32 v30, v30
    v_exp_f32 v31, v31
    v_exp_f32 v32, v32
    v_exp_f32 v33, v33
    v_exp_f32 v34, v34
    v_smfmac_f32_32x32x32_bf16 v[64:79], a[68:71], v[24:31], v48
    v_exp_f32 v35, v35
    v_exp_f32 v36, v36
    v_mfma_f32_32x32x16_bf16 v[16:31], a[8:11], v[96:99], 0
    v_exp_f32 v37, v37
    v_exp_f32 v38, v38
    v_exp_f32 v39, v39
    v_exp_f32 v40, v40
    v_exp_f32 v41, v41
    v_exp_f32 v42, v42
    s_add_u32 m0, s69, 0
    s_add_u32 s71, s68, 0
    buffer_load_dwordx4 v2, s[16:19], s71 offen offset:0 lds
    buffer_load_dwordx4 v3, s[16:19], s71 offen offset:1024 lds
    v_smfmac_f32_32x32x32_bf16 v[64:79], a[72:75], v[32:39], v48
    v_exp_f32 v43, v43
    v_exp_f32 v44, v44
    v_exp_f32 v45, v45
    v_exp_f32 v46, v46
    v_exp_f32 v47, v47
    v_exp_f32 v16, v16
    v_exp_f32 v17, v17
    v_exp_f32 v18, v18
    v_smfmac_f32_32x32x32_bf16 v[64:79], a[76:79], v[40:47], v48
    ds_write_b128 v56, v[80:83]
    v_exp_f32 v19, v19
    v_exp_f32 v20, v20
    v_mfma_f32_32x32x16_bf16 v[32:47], a[12:15], v[96:99], 0
    v_exp_f32 v21, v21
    ds_write_b128 v56, v[84:87] offset:1024
    v_exp_f32 v22, v22
    v_exp_f32 v23, v23
    ds_write_b32 v57, v88
    v_exp_f32 v24, v24
    v_exp_f32 v25, v25
    v_exp_f32 v26, v26
    buffer_load_dwordx4 v4, s[16:19], s71 offen offset:2048 lds
    s_add_u32 m0, s69, 12288
    s_nop 0
    buffer_load_dwordx4 v5, s[20:23], s71 offen offset:0 lds
    v_smfmac_f32_32x32x32_bf16 v[64:79], a[80:83], v[16:23], v48
    v_exp_f32 v27, v27
    v_exp_f32 v28, v28
    v_exp_f32 v29, v29
    v_exp_f32 v30, v30
    v_exp_f32 v31, v31
    v_exp_f32 v32, v32
    v_exp_f32 v33, v33
    v_exp_f32 v34, v34
    v_smfmac_f32_32x32x32_bf16 v[64:79], a[84:87], v[24:31], v48
    v_add_u32 v56, 9216, v56
    v_exp_f32 v35, v35
    v_exp_f32 v36, v36
    v_mfma_f32_32x32x16_bf16 v[16:31], a[16:19], v[96:99], 0
    v_exp_f32 v37, v37
    v_add_u32 v57, 9216, v57
    v_exp_f32 v38, v38
    v_exp_f32 v39, v39
    v_exp_f32 v40, v40
    v_exp_f32 v41, v41
    v_exp_f32 v42, v42
    buffer_load_dwordx4 v6, s[20:23], s71 offen offset:1024 lds
    buffer_load_dwordx4 v7, s[20:23], s71 offen offset:2048 lds
    v_smfmac_f32_32x32x32_bf16 v[64:79], a[88:91], v[32:39], v48
    v_exp_f32 v43, v43
    v_exp_f32 v44, v44
    v_exp_f32 v45, v45
    v_exp_f32 v46, v46
    v_exp_f32 v47, v47
    v_exp_f32 v16, v16
    v_exp_f32 v17, v17
    v_exp_f32 v18, v18
    v_smfmac_f32_32x32x32_bf16 v[64:79], a[92:95], v[40:47], v48
    ds_read_b128 v[100:103], v58
    v_exp_f32 v19, v19
    v_exp_f32 v20, v20
    v_mfma_f32_32x32x16_bf16 v[32:47], a[20:23], v[96:99], 0
    v_exp_f32 v21, v21
    v_exp_f32 v22, v22
    v_exp_f32 v23, v23
    v_exp_f32 v24, v24
    v_exp_f32 v25, v25
    v_exp_f32 v26, v26
    s_add_u32 m0, s69, 24576
    s_add_u32 s71, s68, 176128
    buffer_load_dwordx4 v2, s[16:19], s71 offen offset:0 lds
    buffer_load_dwordx4 v3, s[16:19], s71 offen offset:1024 lds
    v_smfmac_f32_32x32x32_bf16 v[64:79], a[96:99], v[16:23], v48
    v_exp_f32 v27, v27
    v_exp_f32 v28, v28
    v_exp_f32 v29, v29
    v_exp_f32 v30, v30
    v_exp_f32 v31, v31
    v_exp_f32 v32, v32
    v_exp_f32 v33, v33
    v_exp_f32 v34, v34
    v_smfmac_f32_32x32x32_bf16 v[64:79], a[100:103], v[24:31], v48
    v_add_u32 v58, 1024, v58
    v_exp_f32 v35, v35
    v_exp_f32 v36, v36
    v_mfma_f32_32x32x16_bf16 v[16:31], a[24:27], v[96:99], 0
    v_exp_f32 v37, v37
    v_exp_f32 v38, v38
    v_exp_f32 v39, v39
    v_exp_f32 v40, v40
    v_exp_f32 v41, v41
    v_exp_f32 v42, v42
    buffer_load_dwordx4 v4, s[16:19], s71 offen offset:2048 lds
    s_add_u32 m0, s69, 36864
    s_nop 0
    buffer_load_dwordx4 v5, s[20:23], s71 offen offset:0 lds
    v_smfmac_f32_32x32x32_bf16 v[64:79], a[104:107], v[32:39], v48
    v_exp_f32 v43, v43
    v_exp_f32 v44, v44
    v_exp_f32 v45, v45
    v_exp_f32 v46, v46
    v_exp_f32 v47, v47
    v_exp_f32 v16, v16
    v_exp_f32 v17, v17
    v_exp_f32 v18, v18
    v_smfmac_f32_32x32x32_bf16 v[64:79], a[108:111], v[40:47], v48
    v_exp_f32 v19, v19
    v_exp_f32 v20, v20
    v_mfma_f32_32x32x16_bf16 v[32:47], a[28:31], v[96:99], 0
    v_exp_f32 v21, v21
    v_exp_f32 v22, v22
    v_exp_f32 v23, v23
    v_exp_f32 v24, v24
    v_exp_f32 v25, v25
    v_exp_f32 v26, v26
    buffer_load_dwordx4 v6, s[20:23], s71 offen offset:1024 lds
    buffer_load_dwordx4 v7, s[20:23], s71 offen offset:2048 lds
    v_smfmac_f32_32x32x32_bf16 v[64:79], a[112:115], v[16:23], v48
    v_exp_f32 v27, v27
    v_exp_f32 v28, v28
    v_exp_f32 v29, v29
    v_exp_f32 v30, v30
    v_exp_f32 v31, v31
    v_exp_f32 v32, v32
    v_exp_f32 v33, v33
    v_exp_f32 v34, v34
    v_smfmac_f32_32x32x32_bf16 v[64:79], a[116:119], v[24:31], v48
    v_exp_f32 v35, v35
    v_exp_f32 v36, v36
    v_mfma_f32_32x32x16_bf16 v[16:31], a[32:35], v[96:99], 0
    v_exp_f32 v37, v37
    v_exp_f32 v38, v38
    v_exp_f32 v39, v39
    v_exp_f32 v40, v40
    v_exp_f32 v41, v41
    v_exp_f32 v42, v42
    s_add_u32 m0, s69, 49152
    s_add_u32 s71, s68, 352256
    buffer_load_dwordx4 v2, s[16:19], s71 offen offset:0 lds
    buffer_load_dwordx4 v3, s[16:19], s71 offen offset:1024 lds
    v_smfmac_f32_32x32x32_bf16 v[64:79], a[120:123], v[32:39], v48
    v_exp_f32 v43, v43
    v_exp_f32 v44, v44
    v_exp_f32 v45, v45
    v_exp_f32 v46, v46
    v_exp_f32 v47, v47
    v_exp_f32 v16, v16
    v_exp_f32 v17, v17
    v_exp_f32 v18, v18
    v_smfmac_f32_32x32x32_bf16 v[64:79], a[124:127], v[40:47], v48
    v_exp_f32 v19, v19
    v_exp_f32 v20, v20
    v_mfma_f32_32x32x16_bf16 v[32:47], a[36:39], v[96:99], 0
    v_exp_f32 v21, v21
    v_exp_f32 v22, v22
    v_exp_f32 v23, v23
    v_exp_f32 v24, v24
    v_exp_f32 v25, v25
    v_exp_f32 v26, v26
    buffer_load_dwordx4 v4, s[16:19], s71 offen offset:2048 lds
    s_add_u32 m0, s69, 61440
    s_nop 0
    buffer_load_dwordx4 v5, s[20:23], s71 offen offset:0 lds
    v_smfmac_f32_32x32x32_bf16 v[64:79], a[128:131], v[16:23], v48
    v_exp_f32 v27, v27
    v_exp_f32 v28, v28
    v_mfma_f32_32x32x16_bf16 v[80:95], v[52:55], v[52:55], 0
    v_exp_f32 v29, v29
    v_exp_f32 v30, v30
    v_exp_f32 v31, v31
    v_exp_f32 v32, v32
    v_exp_f32 v33, v33
    v_exp_f32 v34, v34
    v_smfmac_f32_32x32x32_bf16 v[64:79], a[132:135], v[24:31], v48
    v_exp_f32 v35, v35
    v_exp_f32 v36, v36
    v_mfma_f32_32x32x16_bf16 v[16:31], a[40:43], v[96:99], 0
    v_exp_f32 v37, v37
    v_exp_f32 v38, v38
    v_exp_f32 v39, v39
    v_exp_f32 v40, v40
    v_exp_f32 v41, v41
    v_exp_f32 v42, v42
    buffer_load_dwordx4 v6, s[20:23], s71 offen offset:1024 lds
    buffer_load_dwordx4 v7, s[20:23], s71 offen offset:2048 lds
    v_smfmac_f32_32x32x32_bf16 v[64:79], a[136:139], v[32:39], v48
    v_exp_f32 v43, v43
    v_exp_f32 v44, v44
    v_exp_f32 v45, v45
    v_exp_f32 v46, v46
    v_exp_f32 v47, v47
    v_exp_f32 v16, v16
    v_exp_f32 v17, v17
    v_exp_f32 v18, v18
    v_smfmac_f32_32x32x32_bf16 v[64:79], a[140:143], v[40:47], v48
    v_exp_f32 v19, v19
    v_exp_f32 v20, v20
    v_mfma_f32_32x32x16_bf16 v[32:47], a[44:47], v[96:99], 0
    v_exp_f32 v21, v21
    v_exp_f32 v22, v22
    v_exp_f32 v23, v23
    v_exp_f32 v24, v24
    v_exp_f32 v25, v25
    v_exp_f32 v26, v26
    v_smfmac_f32_32x32x32_bf16 v[64:79], a[144:147], v[16:23], v48
    v_exp_f32 v27, v27
    v_exp_f32 v28, v28
    v_exp_f32 v29, v29
    v_exp_f32 v30, v30
    v_exp_f32 v31, v31
    v_exp_f32 v32, v32
    v_exp_f32 v33, v33
    v_exp_f32 v34, v34
    v_smfmac_f32_32x32x32_bf16 v[64:79], a[148:151], v[24:31], v48
    v_exp_f32 v35, v35
    v_exp_f32 v36, v36
    v_mfma_f32_32x32x16_bf16 v[16:31], a[48:51], v[96:99], 0
    v_exp_f32 v37, v37
    v_exp_f32 v38, v38
    v_exp_f32 v39, v39
    v_exp_f32 v40, v40
    v_exp_f32 v41, v41
    v_exp_f32 v42, v42
    v_smfmac_f32_32x32x32_bf16 v[64:79], a[152:155], v[32:39], v48
    v_exp_f32 v43, v43
    v_exp_f32 v44, v44
    v_exp_f32 v45, v45
    v_exp_f32 v46, v46
    v_exp_f32 v47, v47
    v_exp_f32 v16, v16
    v_exp_f32 v17, v17
    v_exp_f32 v18, v18
    v_smfmac_f32_32x32x32_bf16 v[64:79], a[156:159], v[40:47], v48
    v_exp_f32 v19, v19
    v_exp_f32 v20, v20
    v_mfma_f32_32x32x16_bf16 v[32:47], a[52:55], v[96:99], 0
    v_exp_f32 v21, v21
    v_exp_f32 v22, v22
    v_exp_f32 v23, v23
    v_exp_f32 v24, v24
    v_exp_f32 v25, v25
    v_exp_f32 v26, v26
    v_smfmac_f32_32x32x32_bf16 v[64:79], a[160:163], v[16:23], v48
    v_exp_f32 v27, v27
    v_exp_f32 v28, v28
    v_exp_f32 v29, v29
    v_exp_f32 v30, v30
    v_exp_f32 v31, v31
    v_exp_f32 v32, v32
    v_exp_f32 v33, v33
    v_exp_f32 v34, v34
    v_smfmac_f32_32x32x32_bf16 v[64:79], a[164:167], v[24:31], v48
    v_exp_f32 v35, v35
    v_exp_f32 v36, v36
    v_mfma_f32_32x32x16_bf16 v[16:31], a[56:59], v[96:99], 0
    v_exp_f32 v37, v37
    v_exp_f32 v38, v38
    v_exp_f32 v39, v39
    v_exp_f32 v40, v40
    v_exp_f32 v41, v41
    v_exp_f32 v42, v42
    v_smfmac_f32_32x32x32_bf16 v[64:79], a[168:171], v[32:39], v48
    v_exp_f32 v43, v43
    v_exp_f32 v44, v44
    v_exp_f32 v45, v45
    v_exp_f32 v46, v46
    v_exp_f32 v47, v47
    s_waitcnt lgkmcnt(0)
    v_exp_f32 v16, v16
    v_exp_f32 v17, v17
    v_exp_f32 v18, v18
    v_smfmac_f32_32x32x32_bf16 v[64:79], a[172:175], v[40:47], v48
    v_exp_f32 v19, v19
    v_exp_f32 v20, v20
    v_mfma_f32_32x32x16_bf16 v[32:47], a[60:63], v[96:99], 0
    v_exp_f32 v21, v21
    v_exp_f32 v22, v22
    v_exp_f32 v23, v23
    v_exp_f32 v24, v24
    v_exp_f32 v25, v25
    v_exp_f32 v26, v26
    v_smfmac_f32_32x32x32_bf16 v[64:79], a[176:179], v[16:23], v48
    v_exp_f32 v27, v27
    v_exp_f32 v28, v28
    v_exp_f32 v29, v29
    v_exp_f32 v30, v30
    v_exp_f32 v31, v31
    v_exp_f32 v32, v32
    v_exp_f32 v33, v33
    v_exp_f32 v34, v34
    v_smfmac_f32_32x32x32_bf16 v[64:79], a[180:183], v[24:31], v48
    v_exp_f32 v35, v35
    v_exp_f32 v36, v36
    v_mfma_f32_32x32x16_bf16 v[16:31], a[0:3], v[100:103], 0
    v_exp_f32 v37, v37
    v_exp_f32 v38, v38
    v_exp_f32 v39, v39
    v_exp_f32 v40, v40
    v_exp_f32 v41, v41
    v_exp_f32 v42, v42
    v_smfmac_f32_32x32x32_bf16 v[64:79], a[184:187], v[32:39], v48
    v_exp_f32 v43, v43
    v_exp_f32 v44, v44
    v_exp_f32 v45, v45
    v_exp_f32 v46, v46
    v_exp_f32 v47, v47
    v_exp_f32 v16, v16
    v_exp_f32 v17, v17
    v_exp_f32 v18, v18
    v_smfmac_f32_32x32x32_bf16 v[64:79], a[188:191], v[40:47], v48
    v_exp_f32 v19, v19
    v_exp_f32 v20, v20
    v_mfma_f32_32x32x16_bf16 v[32:47], a[4:7], v[100:103], 0
    v_exp_f32 v21, v21
    v_exp_f32 v22, v22
    v_exp_f32 v23, v23
    v_exp_f32 v24, v24
    v_exp_f32 v25, v25
    v_exp_f32 v26, v26
    v_smfmac_f32_32x32x32_bf16 v[80:95], a[64:67], v[16:23], v48
    v_exp_f32 v27, v27
    v_exp_f32 v28, v28
    v_exp_f32 v29, v29
    v_exp_f32 v30, v30
    v_exp_f32 v31, v31
    v_exp_f32 v32, v32
    v_exp_f32 v33, v33
    v_exp_f32 v34, v34
    v_smfmac_f32_32x32x32_bf16 v[80:95], a[68:71], v[24:31], v48
    v_exp_f32 v35, v35
    v_exp_f32 v36, v36
    v_mfma_f32_32x32x16_bf16 v[16:31], a[8:11], v[100:103], 0
    v_exp_f32 v37, v37
    v_exp_f32 v38, v38
    v_exp_f32 v39, v39
    v_exp_f32 v40, v40
    v_exp_f32 v41, v41
    v_exp_f32 v42, v42
    v_smfmac_f32_32x32x32_bf16 v[80:95], a[72:75], v[32:39], v48
    v_exp_f32 v43, v43
    v_exp_f32 v44, v44
    v_exp_f32 v45, v45
    v_exp_f32 v46, v46
    v_exp_f32 v47, v47
    v_exp_f32 v16, v16
    v_exp_f32 v17, v17
    v_exp_f32 v18, v18
    v_smfmac_f32_32x32x32_bf16 v[80:95], a[76:79], v[40:47], v48
    ds_write_b128 v56, v[64:67]
    buffer_load_dword v49, v51, s[8:11], s82 offen
    v_exp_f32 v19, v19
    v_exp_f32 v20, v20
    v_mfma_f32_32x32x16_bf16 v[32:47], a[12:15], v[100:103], 0
    v_exp_f32 v21, v21
    ds_write_b128 v56, v[68:71] offset:1024
    v_exp_f32 v22, v22
    v_exp_f32 v23, v23
    ds_write_b32 v57, v72
    v_exp_f32 v24, v24
    v_exp_f32 v25, v25
    v_exp_f32 v26, v26
    v_smfmac_f32_32x32x32_bf16 v[80:95], a[80:83], v[16:23], v48
    v_exp_f32 v27, v27
    v_exp_f32 v28, v28
    v_exp_f32 v29, v29
    v_exp_f32 v30, v30
    v_exp_f32 v31, v31
    v_exp_f32 v32, v32
    v_exp_f32 v33, v33
    v_exp_f32 v34, v34
    v_smfmac_f32_32x32x32_bf16 v[80:95], a[84:87], v[24:31], v48
    v_add_u32 v56, 9216, v56
    v_exp_f32 v35, v35
    v_exp_f32 v36, v36
    v_mfma_f32_32x32x16_bf16 v[16:31], a[16:19], v[100:103], 0
    v_exp_f32 v37, v37
    v_add_u32 v57, 9216, v57
    v_exp_f32 v38, v38
    v_exp_f32 v39, v39
    v_exp_f32 v40, v40
    v_exp_f32 v41, v41
    v_exp_f32 v42, v42
    v_smfmac_f32_32x32x32_bf16 v[80:95], a[88:91], v[32:39], v48
    v_exp_f32 v43, v43
    v_exp_f32 v44, v44
    v_exp_f32 v45, v45
    v_exp_f32 v46, v46
    v_exp_f32 v47, v47
    v_exp_f32 v16, v16
    v_exp_f32 v17, v17
    v_exp_f32 v18, v18
    v_smfmac_f32_32x32x32_bf16 v[80:95], a[92:95], v[40:47], v48
    ds_read_b128 v[96:99], v58
    v_exp_f32 v19, v19
    v_exp_f32 v20, v20
    v_mfma_f32_32x32x16_bf16 v[32:47], a[20:23], v[100:103], 0
    v_exp_f32 v21, v21
    v_exp_f32 v22, v22
    v_exp_f32 v23, v23
    v_exp_f32 v24, v24
    v_exp_f32 v25, v25
    v_exp_f32 v26, v26
    v_smfmac_f32_32x32x32_bf16 v[80:95], a[96:99], v[16:23], v48
    v_exp_f32 v27, v27
    v_exp_f32 v28, v28
    v_exp_f32 v29, v29
    v_exp_f32 v30, v30
    v_exp_f32 v31, v31
    v_exp_f32 v32, v32
    v_exp_f32 v33, v33
    v_exp_f32 v34, v34
    v_smfmac_f32_32x32x32_bf16 v[80:95], a[100:103], v[24:31], v48
    v_add_u32 v58, 1024, v58
    v_exp_f32 v35, v35
    v_exp_f32 v36, v36
    v_mfma_f32_32x32x16_bf16 v[16:31], a[24:27], v[100:103], 0
    v_exp_f32 v37, v37
    v_exp_f32 v38, v38
    v_exp_f32 v39, v39
    v_exp_f32 v40, v40
    v_exp_f32 v41, v41
    v_exp_f32 v42, v42
    v_smfmac_f32_32x32x32_bf16 v[80:95], a[104:107], v[32:39], v48
    v_exp_f32 v43, v43
    v_exp_f32 v44, v44
    v_exp_f32 v45, v45
    v_exp_f32 v46, v46
    v_exp_f32 v47, v47
    v_exp_f32 v16, v16
    v_exp_f32 v17, v17
    v_exp_f32 v18, v18
    v_smfmac_f32_32x32x32_bf16 v[80:95], a[108:111], v[40:47], v48
    buffer_load_dword v49, v51, s[8:11], s83 offen
    v_exp_f32 v19, v19
    v_exp_f32 v20, v20
    v_mfma_f32_32x32x16_bf16 v[32:47], a[28:31], v[100:103], 0
    v_exp_f32 v21, v21
    v_exp_f32 v22, v22
    v_exp_f32 v23, v23
    v_exp_f32 v24, v24
    v_exp_f32 v25, v25
    v_exp_f32 v26, v26
    v_smfmac_f32_32x32x32_bf16 v[80:95], a[112:115], v[16:23], v48
    v_exp_f32 v27, v27
    v_exp_f32 v28, v28
    v_exp_f32 v29, v29
    v_exp_f32 v30, v30
    v_exp_f32 v31, v31
    v_exp_f32 v32, v32
    v_exp_f32 v33, v33
    v_exp_f32 v34, v34
    v_smfmac_f32_32x32x32_bf16 v[80:95], a[116:119], v[24:31], v48
    v_exp_f32 v35, v35
    v_exp_f32 v36, v36
    v_mfma_f32_32x32x16_bf16 v[16:31], a[32:35], v[100:103], 0
    v_exp_f32 v37, v37
    v_exp_f32 v38, v38
    v_exp_f32 v39, v39
    v_exp_f32 v40, v40
    v_exp_f32 v41, v41
    v_exp_f32 v42, v42
    v_smfmac_f32_32x32x32_bf16 v[80:95], a[120:123], v[32:39], v48
    v_exp_f32 v43, v43
    v_exp_f32 v44, v44
    v_exp_f32 v45, v45
    v_exp_f32 v46, v46
    v_exp_f32 v47, v47
    v_exp_f32 v16, v16
    v_exp_f32 v17, v17
    v_exp_f32 v18, v18
    v_smfmac_f32_32x32x32_bf16 v[80:95], a[124:127], v[40:47], v48
    v_exp_f32 v19, v19
    v_exp_f32 v20, v20
    v_mfma_f32_32x32x16_bf16 v[32:47], a[36:39], v[100:103], 0
    v_exp_f32 v21, v21
    v_exp_f32 v22, v22
    v_exp_f32 v23, v23
    v_exp_f32 v24, v24
    v_exp_f32 v25, v25
    v_exp_f32 v26, v26
    v_smfmac_f32_32x32x32_bf16 v[80:95], a[128:131], v[16:23], v48
    v_exp_f32 v27, v27
    v_exp_f32 v28, v28
    v_mfma_f32_32x32x16_bf16 v[64:79], v[52:55], v[52:55], 0
    v_exp_f32 v29, v29
    v_exp_f32 v30, v30
    v_exp_f32 v31, v31
    v_exp_f32 v32, v32
    v_exp_f32 v33, v33
    v_exp_f32 v34, v34
    v_smfmac_f32_32x32x32_bf16 v[80:95], a[132:135], v[24:31], v48
    v_exp_f32 v35, v35
    v_exp_f32 v36, v36
    v_mfma_f32_32x32x16_bf16 v[16:31], a[40:43], v[100:103], 0
    v_exp_f32 v37, v37
    v_exp_f32 v38, v38
    v_exp_f32 v39, v39
    v_exp_f32 v40, v40
    v_exp_f32 v41, v41
    v_exp_f32 v42, v42
    v_smfmac_f32_32x32x32_bf16 v[80:95], a[136:139], v[32:39], v48
    v_exp_f32 v43, v43
    v_exp_f32 v44, v44
    v_exp_f32 v45, v45
    v_exp_f32 v46, v46
    v_exp_f32 v47, v47
    v_exp_f32 v16, v16
    v_exp_f32 v17, v17
    v_exp_f32 v18, v18
    v_smfmac_f32_32x32x32_bf16 v[80:95], a[140:143], v[40:47], v48
    s_mov_b64 exec, 3
    buffer_load_dword v49, v51, s[8:11], s84 offen
    s_mov_b64 exec, -1
    v_exp_f32 v19, v19
    v_exp_f32 v20, v20
    v_mfma_f32_32x32x16_bf16 v[32:47], a[44:47], v[100:103], 0
    v_exp_f32 v21, v21
    v_exp_f32 v22, v22
    v_exp_f32 v23, v23
    v_exp_f32 v24, v24
    v_exp_f32 v25, v25
    v_exp_f32 v26, v26
    v_smfmac_f32_32x32x32_bf16 v[80:95], a[144:147], v[16:23], v48
    v_exp_f32 v27, v27
    v_exp_f32 v28, v28
    v_exp_f32 v29, v29
    v_exp_f32 v30, v30
    v_exp_f32 v31, v31
    v_exp_f32 v32, v32
    v_exp_f32 v33, v33
    v_exp_f32 v34, v34
    v_smfmac_f32_32x32x32_bf16 v[80:95], a[148:151], v[24:31], v48
    v_exp_f32 v35, v35
    v_exp_f32 v36, v36
    v_mfma_f32_32x32x16_bf16 v[16:31], a[48:51], v[100:103], 0
    v_exp_f32 v37, v37
    v_exp_f32 v38, v38
    v_exp_f32 v39, v39
    v_exp_f32 v40, v40
    v_exp_f32 v41, v41
    v_exp_f32 v42, v42
    v_smfmac_f32_32x32x32_bf16 v[80:95], a[152:155], v[32:39], v48
    v_exp_f32 v43, v43
    v_exp_f32 v44, v44
    v_exp_f32 v45, v45
    v_exp_f32 v46, v46
    v_exp_f32 v47, v47
    v_exp_f32 v16, v16
    v_exp_f32 v17, v17
    v_exp_f32 v18, v18
    v_smfmac_f32_32x32x32_bf16 v[80:95], a[156:159], v[40:47], v48
    v_exp_f32 v19, v19
    v_exp_f32 v20, v20
    v_mfma_f32_32x32x16_bf16 v[32:47], a[52:55], v[100:103], 0
    v_exp_f32 v21, v21
    v_exp_f32 v22, v22
    v_exp_f32 v23, v23
    v_exp_f32 v24, v24
    v_exp_f32 v25, v25
    v_exp_f32 v26, v26
    v_smfmac_f32_32x32x32_bf16 v[80:95], a[160:163], v[16:23], v48
    v_exp_f32 v27, v27
    v_exp_f32 v28, v28
    v_exp_f32 v29, v29
    v_exp_f32 v30, v30
    v_exp_f32 v31, v31
    v_exp_f32 v32, v32
    v_exp_f32 v33, v33
    v_exp_f32 v34, v34
    v_smfmac_f32_32x32x32_bf16 v[80:95], a[164:167], v[24:31], v48
    v_exp_f32 v35, v35
    v_exp_f32 v36, v36
    v_mfma_f32_32x32x16_bf16 v[16:31], a[56:59], v[100:103], 0
    v_exp_f32 v37, v37
    v_exp_f32 v38, v38
    v_exp_f32 v39, v39
    v_exp_f32 v40, v40
    v_exp_f32 v41, v41
    v_exp_f32 v42, v42
    v_smfmac_f32_32x32x32_bf16 v[80:95], a[168:171], v[32:39], v48
    v_exp_f32 v43, v43
    v_exp_f32 v44, v44
    v_exp_f32 v45, v45
    v_exp_f32 v46, v46
    v_exp_f32 v47, v47
    s_waitcnt lgkmcnt(0)
    v_exp_f32 v16, v16
    v_exp_f32 v17, v17
    v_exp_f32 v18, v18
    v_smfmac_f32_32x32x32_bf16 v[80:95], a[172:175], v[40:47], v48
    v_exp_f32 v19, v19
    v_exp_f32 v20, v20
    v_mfma_f32_32x32x16_bf16 v[32:47], a[60:63], v[100:103], 0
    v_exp_f32 v21, v21
    v_exp_f32 v22, v22
    v_exp_f32 v23, v23
    v_exp_f32 v24, v24
    v_exp_f32 v25, v25
    v_exp_f32 v26, v26
    v_smfmac_f32_32x32x32_bf16 v[80:95], a[176:179], v[16:23], v48
    v_exp_f32 v27, v27
    v_exp_f32 v28, v28
    v_exp_f32 v29, v29
    v_exp_f32 v30, v30
    v_exp_f32 v31, v31
    v_exp_f32 v32, v32
    v_exp_f32 v33, v33
    v_exp_f32 v34, v34
    v_smfmac_f32_32x32x32_bf16 v[80:95], a[180:183], v[24:31], v48
    v_exp_f32 v35, v35
    v_exp_f32 v36, v36
    v_mfma_f32_32x32x16_bf16 v[16:31], a[0:3], v[96:99], 0
    v_exp_f32 v37, v37
    v_exp_f32 v38, v38
    v_exp_f32 v39, v39
    v_exp_f32 v40, v40
    v_exp_f32 v41, v41
    v_exp_f32 v42, v42
    v_smfmac_f32_32x32x32_bf16 v[80:95], a[184:187], v[32:39], v48
    v_exp_f32 v43, v43
    v_exp_f32 v44, v44
    v_exp_f32 v45, v45
    v_exp_f32 v46, v46
    v_exp_f32 v47, v47
    v_exp_f32 v16, v16
    v_exp_f32 v17, v17
    v_exp_f32 v18, v18
    v_smfmac_f32_32x32x32_bf16 v[80:95], a[188:191], v[40:47], v48
    s_mov_b32 s24, s48
    s_mov_b32 s25, s49
    s_mov_b32 s26, 0x00158000
    s_lshr_b32 s79, s2, 3
    s_lshl_b32 s79, s79, 2
    s_add_u32 s79, s79, s6
    s_mul_i32 s79, s79, 11008
    v_lshlrev_b32 v51, 6, v0
    v_exp_f32 v19, v19
    v_exp_f32 v20, v20
    v_mfma_f32_32x32x16_bf16 v[32:47], a[4:7], v[96:99], 0
    v_exp_f32 v21, v21
    v_exp_f32 v22, v22
    v_exp_f32 v23, v23
    v_exp_f32 v24, v24
    v_exp_f32 v25, v25
    v_exp_f32 v26, v26
    v_smfmac_f32_32x32x32_bf16 v[64:79], a[64:67], v[16:23], v48
    v_exp_f32 v27, v27
    v_exp_f32 v28, v28
    v_exp_f32 v29, v29
    v_exp_f32 v30, v30
    v_exp_f32 v31, v31
    v_exp_f32 v32, v32
    v_exp_f32 v33, v33
    v_exp_f32 v34, v34
    v_smfmac_f32_32x32x32_bf16 v[64:79], a[68:71], v[24:31], v48
    v_exp_f32 v35, v35
    v_exp_f32 v36, v36
    v_mfma_f32_32x32x16_bf16 v[16:31], a[8:11], v[96:99], 0
    v_exp_f32 v37, v37
    v_exp_f32 v38, v38
    v_exp_f32 v39, v39
    v_exp_f32 v40, v40
    buffer_load_dword v49, v51, s[24:27], s79 offen
    s_add_u32 s79, s79, 4096
    v_exp_f32 v41, v41
    v_exp_f32 v42, v42
    v_smfmac_f32_32x32x32_bf16 v[64:79], a[72:75], v[32:39], v48
    v_exp_f32 v43, v43
    v_exp_f32 v44, v44
    v_exp_f32 v45, v45
    v_exp_f32 v46, v46
    v_exp_f32 v47, v47
    v_exp_f32 v16, v16
    v_exp_f32 v17, v17
    v_exp_f32 v18, v18
    v_smfmac_f32_32x32x32_bf16 v[64:79], a[76:79], v[40:47], v48
    ds_write_b128 v56, v[80:83]
    v_exp_f32 v19, v19
    v_exp_f32 v20, v20
    v_mfma_f32_32x32x16_bf16 v[32:47], a[12:15], v[96:99], 0
    v_exp_f32 v21, v21
    ds_write_b128 v56, v[84:87] offset:1024
    v_exp_f32 v22, v22
    v_exp_f32 v23, v23
    ds_write_b32 v57, v88
    v_exp_f32 v24, v24
    v_exp_f32 v25, v25
    v_exp_f32 v26, v26
    v_smfmac_f32_32x32x32_bf16 v[64:79], a[80:83], v[16:23], v48
    v_exp_f32 v27, v27
    v_exp_f32 v28, v28
    v_exp_f32 v29, v29
    v_exp_f32 v30, v30
    v_exp_f32 v31, v31
    v_exp_f32 v32, v32
    v_exp_f32 v33, v33
    v_exp_f32 v34, v34
    v_smfmac_f32_32x32x32_bf16 v[64:79], a[84:87], v[24:31], v48
    v_add_u32 v56, 9216, v56
    v_exp_f32 v35, v35
    v_exp_f32 v36, v36
    v_mfma_f32_32x32x16_bf16 v[16:31], a[16:19], v[96:99], 0
    v_exp_f32 v37, v37
    v_add_u32 v57, 9216, v57
    v_exp_f32 v38, v38
    v_exp_f32 v39, v39
    v_exp_f32 v40, v40
    buffer_load_dword v49, v51, s[24:27], s79 offen
    s_add_u32 s79, s79, 4096
    v_exp_f32 v41, v41
    v_exp_f32 v42, v42
    v_smfmac_f32_32x32x32_bf16 v[64:79], a[88:91], v[32:39], v48
    v_exp_f32 v43, v43
    v_exp_f32 v44, v44
    v_exp_f32 v45, v45
    v_exp_f32 v46, v46
    v_exp_f32 v47, v47
    v_exp_f32 v16, v16
    v_exp_f32 v17, v17
    v_exp_f32 v18, v18
    v_smfmac_f32_32x32x32_bf16 v[64:79], a[92:95], v[40:47], v48
    ds_read_b128 v[100:103], v58
    v_exp_f32 v19, v19
    v_exp_f32 v20, v20
    v_mfma_f32_32x32x16_bf16 v[32:47], a[20:23], v[96:99], 0
    v_exp_f32 v21, v21
    v_exp_f32 v22, v22
    v_exp_f32 v23, v23
    v_exp_f32 v24, v24
    v_exp_f32 v25, v25
    v_exp_f32 v26, v26
    v_smfmac_f32_32x32x32_bf16 v[64:79], a[96:99], v[16:23], v48
    v_exp_f32 v27, v27
    v_exp_f32 v28, v28
    v_exp_f32 v29, v29
    v_exp_f32 v30, v30
    v_exp_f32 v31, v31
    v_exp_f32 v32, v32
    v_exp_f32 v33, v33
    v_exp_f32 v34, v34
    v_smfmac_f32_32x32x32_bf16 v[64:79], a[100:103], v[24:31], v48
    v_add_u32 v58, 1024, v58
    v_exp_f32 v35, v35
    v_exp_f32 v36, v36
    v_mfma_f32_32x32x16_bf16 v[16:31], a[24:27], v[96:99], 0
    v_exp_f32 v37, v37
    v_exp_f32 v38, v38
    v_exp_f32 v39, v39
    v_exp_f32 v40, v40
    buffer_load_dword v49, v51, s[24:27], s79 offen
    v_exp_f32 v41, v41
    v_exp_f32 v42, v42
    v_smfmac_f32_32x32x32_bf16 v[64:79], a[104:107], v[32:39], v48
    v_exp_f32 v43, v43
    v_exp_f32 v44, v44
    v_exp_f32 v45, v45
    v_exp_f32 v46, v46
    v_exp_f32 v47, v47
    v_exp_f32 v16, v16
    v_exp_f32 v17, v17
    v_exp_f32 v18, v18
    v_smfmac_f32_32x32x32_bf16 v[64:79], a[108:111], v[40:47], v48
    v_exp_f32 v19, v19
    v_exp_f32 v20, v20
    v_mfma_f32_32x32x16_bf16 v[32:47], a[28:31], v[96:99], 0
    v_exp_f32 v21, v21
    v_exp_f32 v22, v22
    v_exp_f32 v23, v23
    v_exp_f32 v24, v24
    v_exp_f32 v25, v25
    v_exp_f32 v26, v26
    v_smfmac_f32_32x32x32_bf16 v[64:79], a[112:115], v[16:23], v48
    v_exp_f32 v27, v27
    v_exp_f32 v28, v28
    v_exp_f32 v29, v29
    v_exp_f32 v30, v30
    v_exp_f32 v31, v31
    v_exp_f32 v32, v32
    v_exp_f32 v33, v33
    v_exp_f32 v34, v34
    v_smfmac_f32_32x32x32_bf16 v[64:79], a[116:119], v[24:31], v48
    v_exp_f32 v35, v35
    v_exp_f32 v36, v36
    v_mfma_f32_32x32x16_bf16 v[16:31], a[32:35], v[96:99], 0
    v_exp_f32 v37, v37
    v_exp_f32 v38, v38
    v_exp_f32 v39, v39
    v_exp_f32 v40, v40
    v_exp_f32 v41, v41
    v_exp_f32 v42, v42
    v_smfmac_f32_32x32x32_bf16 v[64:79], a[120:123], v[32:39], v48
    v_exp_f32 v43, v43
    v_exp_f32 v44, v44
    v_exp_f32 v45, v45
    v_exp_f32 v46, v46
    v_exp_f32 v47, v47
    v_exp_f32 v16, v16
    v_exp_f32 v17, v17
    v_exp_f32 v18, v18
    v_smfmac_f32_32x32x32_bf16 v[64:79], a[124:127], v[40:47], v48
    s_getpc_b64 s[84:85]
PF2_HERE:
    s_lshr_b32 s3, s2, 3
    s_lshl_b32 s3, s3, 2
    s_add_u32 s3, s3, s6
    s_mul_i32 s3, s3, 256
    v_and_b32 v50, 3, v0
    v_lshlrev_b32 v50, 6, v50
    v_add_u32 v50, s3, v50
    v_add_u32 v50, L_att_tail-PF2_HERE, v50
    v_min_u32 v50, END_K-PF2_HERE-4, v50
    s_mov_b64 exec, 15
    global_load_dword v49, v50, s[84:85]
    s_mov_b64 exec, -1
    v_exp_f32 v19, v19
    v_exp_f32 v20, v20
    v_mfma_f32_32x32x16_bf16 v[32:47], a[36:39], v[96:99], 0
    v_exp_f32 v21, v21
    v_exp_f32 v22, v22
    v_exp_f32 v23, v23
    v_exp_f32 v24, v24
    v_exp_f32 v25, v25
    v_exp_f32 v26, v26
    v_smfmac_f32_32x32x32_bf16 v[64:79], a[128:131], v[16:23], v48
    v_exp_f32 v27, v27
    v_exp_f32 v28, v28
    v_mfma_f32_32x32x16_bf16 v[80:95], v[52:55], v[52:55], 0
    v_exp_f32 v29, v29
    v_exp_f32 v30, v30
    v_exp_f32 v31, v31
    v_exp_f32 v32, v32
    v_exp_f32 v33, v33
    v_exp_f32 v34, v34
    v_smfmac_f32_32x32x32_bf16 v[64:79], a[132:135], v[24:31], v48
    v_exp_f32 v35, v35
    v_exp_f32 v36, v36
    v_mfma_f32_32x32x16_bf16 v[16:31], a[40:43], v[96:99], 0
    v_exp_f32 v37, v37
    v_exp_f32 v38, v38
    v_exp_f32 v39, v39
    v_exp_f32 v40, v40
    v_exp_f32 v41, v41
    v_exp_f32 v42, v42
    v_smfmac_f32_32x32x32_bf16 v[64:79], a[136:139], v[32:39], v48
    v_exp_f32 v43, v43
    v_exp_f32 v44, v44
    v_exp_f32 v45, v45
    v_exp_f32 v46, v46
    v_exp_f32 v47, v47
    v_exp_f32 v16, v16
    v_exp_f32 v17, v17
    v_exp_f32 v18, v18
    v_smfmac_f32_32x32x32_bf16 v[64:79], a[140:143], v[40:47], v48
    v_exp_f32 v19, v19
    v_exp_f32 v20, v20
    v_mfma_f32_32x32x16_bf16 v[32:47], a[44:47], v[96:99], 0
    v_exp_f32 v21, v21
    v_exp_f32 v22, v22
    v_exp_f32 v23, v23
    v_exp_f32 v24, v24
    v_exp_f32 v25, v25
    v_exp_f32 v26, v26
    v_smfmac_f32_32x32x32_bf16 v[64:79], a[144:147], v[16:23], v48
    v_exp_f32 v27, v27
    v_exp_f32 v28, v28
    v_exp_f32 v29, v29
    v_exp_f32 v30, v30
    v_exp_f32 v31, v31
    v_exp_f32 v32, v32
    v_exp_f32 v33, v33
    v_exp_f32 v34, v34
    v_smfmac_f32_32x32x32_bf16 v[64:79], a[148:151], v[24:31], v48
    v_exp_f32 v35, v35
    v_exp_f32 v36, v36
    v_mfma_f32_32x32x16_bf16 v[16:31], a[48:51], v[96:99], 0
    v_exp_f32 v37, v37
    v_exp_f32 v38, v38
    v_exp_f32 v39, v39
    v_exp_f32 v40, v40
    v_exp_f32 v41, v41
    v_exp_f32 v42, v42
    v_smfmac_f32_32x32x32_bf16 v[64:79], a[152:155], v[32:39], v48
    v_exp_f32 v43, v43
    v_exp_f32 v44, v44
    v_exp_f32 v45, v45
    v_exp_f32 v46, v46
    v_exp_f32 v47, v47
    v_exp_f32 v16, v16
    v_exp_f32 v17, v17
    v_exp_f32 v18, v18
    v_smfmac_f32_32x32x32_bf16 v[64:79], a[156:159], v[40:47], v48
    v_and_b32 v13, 15, v0
    v_lshlrev_b32 v13, 2, v13
    buffer_load_dword v12, v13, s[8:11], s86 offen sc1
    v_exp_f32 v19, v19
    v_exp_f32 v20, v20
    v_mfma_f32_32x32x16_bf16 v[32:47], a[52:55], v[96:99], 0
    v_exp_f32 v21, v21
    v_exp_f32 v22, v22
    v_exp_f32 v23, v23
    v_exp_f32 v24, v24
    v_exp_f32 v25, v25
    v_exp_f32 v26, v26
    v_smfmac_f32_32x32x32_bf16 v[64:79], a[160:163], v[16:23], v48
    v_exp_f32 v27, v27
    v_exp_f32 v28, v28
    v_exp_f32 v29, v29
    v_exp_f32 v30, v30
    v_exp_f32 v31, v31
    v_exp_f32 v32, v32
    v_exp_f32 v33, v33
    v_exp_f32 v34, v34
    v_smfmac_f32_32x32x32_bf16 v[64:79], a[164:167], v[24:31], v48
    v_exp_f32 v35, v35
    v_exp_f32 v36, v36
    v_mfma_f32_32x32x16_bf16 v[16:31], a[56:59], v[96:99], 0
    v_exp_f32 v37, v37
    v_exp_f32 v38, v38
    v_exp_f32 v39, v39
    v_exp_f32 v40, v40
    v_exp_f32 v41, v41
    v_exp_f32 v42, v42
    v_smfmac_f32_32x32x32_bf16 v[64:79], a[168:171], v[32:39], v48
    v_exp_f32 v43, v43
    v_exp_f32 v44, v44
    v_exp_f32 v45, v45
    v_exp_f32 v46, v46
    v_exp_f32 v47, v47
    s_waitcnt lgkmcnt(0)
    v_exp_f32 v16, v16
    v_exp_f32 v17, v17
    v_exp_f32 v18, v18
    v_smfmac_f32_32x32x32_bf16 v[64:79], a[172:175], v[40:47], v48
    v_exp_f32 v19, v19
    v_exp_f32 v20, v20
    v_mfma_f32_32x32x16_bf16 v[32:47], a[60:63], v[96:99], 0
    v_exp_f32 v21, v21
    v_exp_f32 v22, v22
    v_exp_f32 v23, v23
    v_exp_f32 v24, v24
    v_exp_f32 v25, v25
    v_exp_f32 v26, v26
    v_smfmac_f32_32x32x32_bf16 v[64:79], a[176:179], v[16:23], v48
    v_exp_f32 v27, v27
    v_exp_f32 v28, v28
    v_exp_f32 v29, v29
    v_exp_f32 v30, v30
    v_exp_f32 v31, v31
    v_exp_f32 v32, v32
    v_exp_f32 v33, v33
    v_exp_f32 v34, v34
    v_smfmac_f32_32x32x32_bf16 v[64:79], a[180:183], v[24:31], v48
    v_exp_f32 v35, v35
    v_exp_f32 v36, v36
    v_mfma_f32_32x32x16_bf16 v[16:31], a[0:3], v[100:103], 0
    v_exp_f32 v37, v37
    v_exp_f32 v38, v38
    v_exp_f32 v39, v39
    v_exp_f32 v40, v40
    v_exp_f32 v41, v41
    v_exp_f32 v42, v42
    v_smfmac_f32_32x32x32_bf16 v[64:79], a[184:187], v[32:39], v48
    v_exp_f32 v43, v43
    v_exp_f32 v44, v44
    v_exp_f32 v45, v45
    v_exp_f32 v46, v46
    v_exp_f32 v47, v47
    v_exp_f32 v16, v16
    v_exp_f32 v17, v17
    v_exp_f32 v18, v18
    v_smfmac_f32_32x32x32_bf16 v[64:79], a[188:191], v[40:47], v48
    v_exp_f32 v19, v19
    v_exp_f32 v20, v20
    v_mfma_f32_32x32x16_bf16 v[32:47], a[4:7], v[100:103], 0
    v_exp_f32 v21, v21
    v_exp_f32 v22, v22
    v_exp_f32 v23, v23
    v_exp_f32 v24, v24
    v_exp_f32 v25, v25
    v_exp_f32 v26, v26
    v_smfmac_f32_32x32x32_bf16 v[80:95], a[64:67], v[16:23], v48
    v_exp_f32 v27, v27
    v_exp_f32 v28, v28
    v_exp_f32 v29, v29
    v_exp_f32 v30, v30
    v_exp_f32 v31, v31
    v_exp_f32 v32, v32
    v_exp_f32 v33, v33
    v_exp_f32 v34, v34
    v_smfmac_f32_32x32x32_bf16 v[80:95], a[68:71], v[24:31], v48
    v_exp_f32 v35, v35
    v_exp_f32 v36, v36
    v_mfma_f32_32x32x16_bf16 v[16:31], a[8:11], v[100:103], 0
    v_exp_f32 v37, v37
    v_exp_f32 v38, v38
    v_exp_f32 v39, v39
    v_exp_f32 v40, v40
    v_exp_f32 v41, v41
    v_exp_f32 v42, v42
    v_smfmac_f32_32x32x32_bf16 v[80:95], a[72:75], v[32:39], v48
    v_exp_f32 v43, v43
    v_exp_f32 v44, v44
    v_exp_f32 v45, v45
    v_exp_f32 v46, v46
    v_exp_f32 v47, v47
    v_exp_f32 v16, v16
    v_exp_f32 v17, v17
    v_exp_f32 v18, v18
    v_smfmac_f32_32x32x32_bf16 v[80:95], a[76:79], v[40:47], v48
    ds_write_b128 v56, v[64:67]
    v_exp_f32 v19, v19
    v_exp_f32 v20, v20
    v_mfma_f32_32x32x16_bf16 v[32:47], a[12:15], v[100:103], 0
    v_exp_f32 v21, v21
    ds_write_b128 v56, v[68:71] offset:1024
    v_exp_f32 v22, v22
    v_exp_f32 v23, v23
    ds_write_b32 v57, v72
    v_exp_f32 v24, v24
    v_exp_f32 v25, v25
    v_exp_f32 v26, v26
    v_smfmac_f32_32x32x32_bf16 v[80:95], a[80:83], v[16:23], v48
    v_exp_f32 v27, v27
    v_exp_f32 v28, v28
    v_exp_f32 v29, v29
    v_exp_f32 v30, v30
    v_exp_f32 v31, v31
    v_exp_f32 v32, v32
    v_exp_f32 v33, v33
    v_exp_f32 v34, v34
    v_smfmac_f32_32x32x32_bf16 v[80:95], a[84:87], v[24:31], v48
    v_add_u32 v56, 9216, v56
    v_exp_f32 v35, v35
    v_exp_f32 v36, v36
    v_mfma_f32_32x32x16_bf16 v[16:31], a[16:19], v[100:103], 0
    v_exp_f32 v37, v37
    v_add_u32 v57, 9216, v57
    v_exp_f32 v38, v38
    v_exp_f32 v39, v39
    v_exp_f32 v40, v40
    v_exp_f32 v41, v41
    v_exp_f32 v42, v42
    v_smfmac_f32_32x32x32_bf16 v[80:95], a[88:91], v[32:39], v48
    v_exp_f32 v43, v43
    v_exp_f32 v44, v44
    v_exp_f32 v45, v45
    v_exp_f32 v46, v46
    v_exp_f32 v47, v47
    v_exp_f32 v16, v16
    v_exp_f32 v17, v17
    v_exp_f32 v18, v18
    v_smfmac_f32_32x32x32_bf16 v[80:95], a[92:95], v[40:47], v48
    ds_read_b128 v[96:99], v58
    v_exp_f32 v19, v19
    v_exp_f32 v20, v20
    v_mfma_f32_32x32x16_bf16 v[32:47], a[20:23], v[100:103], 0
    v_exp_f32 v21, v21
    v_exp_f32 v22, v22
    v_exp_f32 v23, v23
    v_exp_f32 v24, v24
    v_exp_f32 v25, v25
    v_exp_f32 v26, v26
    v_smfmac_f32_32x32x32_bf16 v[80:95], a[96:99], v[16:23], v48
    v_exp_f32 v27, v27
    v_exp_f32 v28, v28
    v_exp_f32 v29, v29
    v_exp_f32 v30, v30
    v_exp_f32 v31, v31
    v_exp_f32 v32, v32
    v_exp_f32 v33, v33
    v_exp_f32 v34, v34
    v_smfmac_f32_32x32x32_bf16 v[80:95], a[100:103], v[24:31], v48
    v_add_u32 v58, 1024, v58
    v_exp_f32 v35, v35
    v_exp_f32 v36, v36
    v_mfma_f32_32x32x16_bf16 v[16:31], a[24:27], v[100:103], 0
    v_exp_f32 v37, v37
    v_exp_f32 v38, v38
    v_exp_f32 v39, v39
    v_exp_f32 v40, v40
    v_exp_f32 v41, v41
    v_exp_f32 v42, v42
    v_smfmac_f32_32x32x32_bf16 v[80:95], a[104:107], v[32:39], v48
    v_exp_f32 v43, v43
    v_exp_f32 v44, v44
    v_exp_f32 v45, v45
    v_exp_f32 v46, v46
    v_exp_f32 v47, v47
    v_exp_f32 v16, v16
    v_exp_f32 v17, v17
    v_exp_f32 v18, v18
    v_smfmac_f32_32x32x32_bf16 v[80:95], a[108:111], v[40:47], v48
    v_exp_f32 v19, v19
    v_exp_f32 v20, v20
    v_mfma_f32_32x32x16_bf16 v[32:47], a[28:31], v[100:103], 0
    v_exp_f32 v21, v21
    v_exp_f32 v22, v22
    v_exp_f32 v23, v23
    v_exp_f32 v24, v24
    v_exp_f32 v25, v25
    v_exp_f32 v26, v26
    v_smfmac_f32_32x32x32_bf16 v[80:95], a[112:115], v[16:23], v48
    v_exp_f32 v27, v27
    v_exp_f32 v28, v28
    v_exp_f32 v29, v29
    v_exp_f32 v30, v30
    v_exp_f32 v31, v31
    v_exp_f32 v32, v32
    v_exp_f32 v33, v33
    v_exp_f32 v34, v34
    v_smfmac_f32_32x32x32_bf16 v[80:95], a[116:119], v[24:31], v48
    v_exp_f32 v35, v35
    v_exp_f32 v36, v36
    v_mfma_f32_32x32x16_bf16 v[16:31], a[32:35], v[100:103], 0
    v_exp_f32 v37, v37
    v_exp_f32 v38, v38
    v_exp_f32 v39, v39
    v_exp_f32 v40, v40
    v_exp_f32 v41, v41
    v_exp_f32 v42, v42
    v_smfmac_f32_32x32x32_bf16 v[80:95], a[120:123], v[32:39], v48
    v_exp_f32 v43, v43
    v_exp_f32 v44, v44
    v_exp_f32 v45, v45
    v_exp_f32 v46, v46
    v_exp_f32 v47, v47
    v_exp_f32 v16, v16
    v_exp_f32 v17, v17
    v_exp_f32 v18, v18
    v_smfmac_f32_32x32x32_bf16 v[80:95], a[124:127], v[40:47], v48
    v_exp_f32 v19, v19
    v_exp_f32 v20, v20
    v_mfma_f32_32x32x16_bf16 v[32:47], a[36:39], v[100:103], 0
    v_exp_f32 v21, v21
    v_exp_f32 v22, v22
    v_exp_f32 v23, v23
    v_exp_f32 v24, v24
    v_exp_f32 v25, v25
    v_exp_f32 v26, v26
    v_smfmac_f32_32x32x32_bf16 v[80:95], a[128:131], v[16:23], v48
    v_exp_f32 v27, v27
    v_exp_f32 v28, v28
    v_mfma_f32_32x32x16_bf16 v[64:79], v[52:55], v[52:55], 0
    v_exp_f32 v29, v29
    v_exp_f32 v30, v30
    v_exp_f32 v31, v31
    v_exp_f32 v32, v32
    v_exp_f32 v33, v33
    v_exp_f32 v34, v34
    v_smfmac_f32_32x32x32_bf16 v[80:95], a[132:135], v[24:31], v48
    v_exp_f32 v35, v35
    v_exp_f32 v36, v36
    v_mfma_f32_32x32x16_bf16 v[16:31], a[40:43], v[100:103], 0
    v_exp_f32 v37, v37
    v_exp_f32 v38, v38
    v_exp_f32 v39, v39
    v_exp_f32 v40, v40
    v_exp_f32 v41, v41
    v_exp_f32 v42, v42
    v_smfmac_f32_32x32x32_bf16 v[80:95], a[136:139], v[32:39], v48
    v_exp_f32 v43, v43
    v_exp_f32 v44, v44
    v_exp_f32 v45, v45
    v_exp_f32 v46, v46
    v_exp_f32 v47, v47
    v_exp_f32 v16, v16
    v_exp_f32 v17, v17
    v_exp_f32 v18, v18
    v_smfmac_f32_32x32x32_bf16 v[80:95], a[140:143], v[40:47], v48
    v_exp_f32 v19, v19
    v_exp_f32 v20, v20
    v_mfma_f32_32x32x16_bf16 v[32:47], a[44:47], v[100:103], 0
    v_exp_f32 v21, v21
    v_exp_f32 v22, v22
    v_exp_f32 v23, v23
    v_exp_f32 v24, v24
    v_exp_f32 v25, v25
    v_exp_f32 v26, v26
    v_smfmac_f32_32x32x32_bf16 v[80:95], a[144:147], v[16:23], v48
    v_exp_f32 v27, v27
    v_exp_f32 v28, v28
    v_exp_f32 v29, v29
    v_exp_f32 v30, v30
    v_exp_f32 v31, v31
    v_exp_f32 v32, v32
    v_exp_f32 v33, v33
    v_exp_f32 v34, v34
    v_smfmac_f32_32x32x32_bf16 v[80:95], a[148:151], v[24:31], v48
    v_exp_f32 v35, v35
    v_exp_f32 v36, v36
    v_mfma_f32_32x32x16_bf16 v[16:31], a[48:51], v[100:103], 0
    v_exp_f32 v37, v37
    v_exp_f32 v38, v38
    v_exp_f32 v39, v39
    v_exp_f32 v40, v40
    v_exp_f32 v41, v41
    v_exp_f32 v42, v42
    v_smfmac_f32_32x32x32_bf16 v[80:95], a[152:155], v[32:39], v48
    v_exp_f32 v43, v43
    v_exp_f32 v44, v44
    v_exp_f32 v45, v45
    v_exp_f32 v46, v46
    v_exp_f32 v47, v47
    v_exp_f32 v16, v16
    v_exp_f32 v17, v17
    v_exp_f32 v18, v18
    v_smfmac_f32_32x32x32_bf16 v[80:95], a[156:159], v[40:47], v48
    v_exp_f32 v19, v19
    v_exp_f32 v20, v20
    v_mfma_f32_32x32x16_bf16 v[32:47], a[52:55], v[100:103], 0
    v_exp_f32 v21, v21
    v_exp_f32 v22, v22
    v_exp_f32 v23, v23
    v_exp_f32 v24, v24
    v_exp_f32 v25, v25
    v_exp_f32 v26, v26
    v_smfmac_f32_32x32x32_bf16 v[80:95], a[160:163], v[16:23], v48
    v_exp_f32 v27, v27
    v_exp_f32 v28, v28
    v_exp_f32 v29, v29
    v_exp_f32 v30, v30
    v_exp_f32 v31, v31
    v_exp_f32 v32, v32
    v_exp_f32 v33, v33
    v_exp_f32 v34, v34
    v_smfmac_f32_32x32x32_bf16 v[80:95], a[164:167], v[24:31], v48
    v_exp_f32 v35, v35
    v_exp_f32 v36, v36
    v_mfma_f32_32x32x16_bf16 v[16:31], a[56:59], v[100:103], 0
    v_exp_f32 v37, v37
    v_exp_f32 v38, v38
    v_exp_f32 v39, v39
    v_exp_f32 v40, v40
    v_exp_f32 v41, v41
    v_exp_f32 v42, v42
    v_smfmac_f32_32x32x32_bf16 v[80:95], a[168:171], v[32:39], v48
    v_exp_f32 v43, v43
    v_exp_f32 v44, v44
    v_exp_f32 v45, v45
    v_exp_f32 v46, v46
    v_exp_f32 v47, v47
    s_waitcnt lgkmcnt(0)
    v_exp_f32 v16, v16
    v_exp_f32 v17, v17
    v_exp_f32 v18, v18
    v_smfmac_f32_32x32x32_bf16 v[80:95], a[172:175], v[40:47], v48
    v_exp_f32 v19, v19
    v_exp_f32 v20, v20
    v_mfma_f32_32x32x16_bf16 v[32:47], a[60:63], v[100:103], 0
    v_exp_f32 v21, v21
    v_exp_f32 v22, v22
    v_exp_f32 v23, v23
    v_exp_f32 v24, v24
    v_exp_f32 v25, v25
    v_exp_f32 v26, v26
    v_smfmac_f32_32x32x32_bf16 v[80:95], a[176:179], v[16:23], v48
    v_exp_f32 v27, v27
    v_exp_f32 v28, v28
    v_exp_f32 v29, v29
    v_exp_f32 v30, v30
    v_exp_f32 v31, v31
    v_exp_f32 v32, v32
    v_exp_f32 v33, v33
    v_exp_f32 v34, v34
    v_smfmac_f32_32x32x32_bf16 v[80:95], a[180:183], v[24:31], v48
    v_exp_f32 v35, v35
    v_exp_f32 v36, v36
    v_mfma_f32_32x32x16_bf16 v[16:31], a[0:3], v[96:99], 0
    v_exp_f32 v37, v37
    v_exp_f32 v38, v38
    v_exp_f32 v39, v39
    v_exp_f32 v40, v40
    v_exp_f32 v41, v41
    v_exp_f32 v42, v42
    v_smfmac_f32_32x32x32_bf16 v[80:95], a[184:187], v[32:39], v48
    v_exp_f32 v43, v43
    v_exp_f32 v44, v44
    v_exp_f32 v45, v45
    v_exp_f32 v46, v46
    v_exp_f32 v47, v47
L_att_tail:
    s_nop 1
    v_smfmac_f32_32x32x32_bf16 v[80:95], a[188:191], v[40:47], v48
    s_mul_i32 s3, s6, 18432
    s_add_u32 s3, s3, 73728
    v_add_u32 v118, s3, v9
    s_add_u32 s3, s3, 2048
    v_lshl_add_u32 v119, v0, 2, s3
    s_lshr_b32 s3, s6, 1
    s_lshl_b32 s7, s4, 1
    s_add_u32 s3, s3, s7
    s_lshl_b32 s3, s3, 5
    s_lshl_b32 s7, s5, 2
    s_add_u32 s3, s3, s7
    s_and_b32 s7, s6, 1
    s_lshl_b32 s7, s7, 1
    s_add_u32 s3, s3, s7
    s_lshl_b32 s3, s3, 10
    s_add_u32 s63, s3, 3145728
    s_waitcnt vmcnt(0)
    s_mov_b32 s29, 131072
XC_CHKM:
    v_cmp_eq_u32 vcc, 0, v12
    s_nop 0
    s_cmp_eq_u64 vcc, 0
    s_cbranch_scc1 XC_OKM
    s_sub_u32 s29, s29, 1
    s_cmp_eq_u32 s29, 0
    s_cbranch_scc1 XC_OKM
    buffer_load_dword v12, v13, s[8:11], s86 offen sc1
    s_waitcnt vmcnt(0)
    s_branch XC_CHKM
XC_OKM:
    v_cmp_ne_u32 vcc, s43, v12
    s_nop 0
    s_cmp_lg_u64 vcc, 0
    s_cselect_b32 s43, 1, 0
    ds_write_b128 v56, v[80:83]
    ds_write_b128 v56, v[84:87] offset:1024
    ds_write_b32 v57, v88
L_att_done:
    s_waitcnt vmcnt(0) lgkmcnt(0)
    s_barrier
    ds_read_b128 v[16:19], v118 offset:0
    ds_read_b128 v[20:23], v118 offset:1024
    ds_read_b32 v80, v119 offset:0
    ds_read_b128 v[24:27], v118 offset:2304
    ds_read_b128 v[28:31], v118 offset:3328
    ds_read_b32 v81, v119 offset:2304
    ds_read_b128 v[32:35], v118 offset:4608
    ds_read_b128 v[36:39], v118 offset:5632
    ds_read_b32 v82, v119 offset:4608
    ds_read_b128 v[40:43], v118 offset:6912
    ds_read_b128 v[44:47], v118 offset:7936
    ds_read_b32 v83, v119 offset:6912
    s_waitcnt lgkmcnt(6)
    v_pk_add_f32 v[16:17], v[16:17], v[24:25]
    v_pk_add_f32 v[18:19], v[18:19], v[26:27]
    v_pk_add_f32 v[20:21], v[20:21], v[28:29]
    v_pk_add_f32 v[22:23], v[22:23], v[30:31]
    v_add_f32 v80, v80, v81
    ds_read_b128 v[48:51], v118 offset:9216
    ds_read_b128 v[52:55], v118 offset:10240
    ds_read_b32 v84, v119 offset:9216
    ds_read_b128 v[56:59], v118 offset:11520
    ds_read_b128 v[60:63], v118 offset:12544
    ds_read_b32 v85, v119 offset:11520
    ds_read_b128 v[64:67], v118 offset:13824
    ds_read_b128 v[68:71], v118 offset:14848
    ds_read_b32 v86, v119 offset:13824
    ds_read_b128 v[72:75], v118 offset:16128
    ds_read_b128 v[76:79], v118 offset:17152
    ds_read_b32 v87, v119 offset:16128
    s_waitcnt lgkmcnt(12)
    v_pk_add_f32 v[32:33], v[32:33], v[40:41]
    v_pk_add_f32 v[34:35], v[34:35], v[42:43]
    v_pk_add_f32 v[36:37], v[36:37], v[44:45]
    v_pk_add_f32 v[38:39], v[38:39], v[46:47]
    v_add_f32 v82, v82, v83
    v_pk_add_f32 v[96:97], v[16:17], v[32:33]
    v_pk_add_f32 v[98:99], v[18:19], v[34:35]
    v_pk_add_f32 v[100:101], v[20:21], v[36:37]
    v_pk_add_f32 v[102:103], v[22:23], v[38:39]
    v_add_f32 v104, v80, v82
    v_rcp_f32 v120, v104
    v_mov_b32 v121, v104
    v_mov_b32 v121, v120
    v_pk_mul_f32 v[96:97], v[96:97], v[120:121]
    v_pk_mul_f32 v[98:99], v[98:99], v[120:121]
    v_pk_mul_f32 v[100:101], v[100:101], v[120:121]
    v_pk_mul_f32 v[102:103], v[102:103], v[120:121]
    v_cvt_pk_bf16_f32 v124, v96, v97
    v_cvt_pk_bf16_f32 v125, v98, v99
    v_cvt_pk_bf16_f32 v126, v100, v101
    v_cvt_pk_bf16_f32 v127, v102, v103
    s_cmp_lg_u32 s43, 0
    s_cbranch_scc1 HST_0
    buffer_store_dwordx4 v[124:127], v9, s[8:11], s63 offen offset:0
HSB_0:
    s_waitcnt lgkmcnt(6)
    v_pk_add_f32 v[48:49], v[48:49], v[56:57]
    v_pk_add_f32 v[50:51], v[50:51], v[58:59]
    v_pk_add_f32 v[52:53], v[52:53], v[60:61]
    v_pk_add_f32 v[54:55], v[54:55], v[62:63]
    v_add_f32 v84, v84, v85
    s_waitcnt lgkmcnt(0)
    v_pk_add_f32 v[64:65], v[64:65], v[72:73]
    v_pk_add_f32 v[66:67], v[66:67], v[74:75]
    v_pk_add_f32 v[68:69], v[68:69], v[76:77]
    v_pk_add_f32 v[70:71], v[70:71], v[78:79]
    v_add_f32 v86, v86, v87
    v_pk_add_f32 v[106:107], v[48:49], v[64:65]
    v_pk_add_f32 v[108:109], v[50:51], v[66:67]
    v_pk_add_f32 v[110:111], v[52:53], v[68:69]
    v_pk_add_f32 v[112:113], v[54:55], v[70:71]
    v_add_f32 v114, v84, v86
    v_rcp_f32 v120, v114
    v_mov_b32 v121, v114
    v_mov_b32 v121, v120
    v_pk_mul_f32 v[106:107], v[106:107], v[120:121]
    v_pk_mul_f32 v[108:109], v[108:109], v[120:121]
    v_pk_mul_f32 v[110:111], v[110:111], v[120:121]
    v_pk_mul_f32 v[112:113], v[112:113], v[120:121]
    v_cvt_pk_bf16_f32 v124, v106, v107
    v_cvt_pk_bf16_f32 v125, v108, v109
    v_cvt_pk_bf16_f32 v126, v110, v111
    v_cvt_pk_bf16_f32 v127, v112, v113
    s_cmp_lg_u32 s43, 0
    s_cbranch_scc1 HST_1
    buffer_store_dwordx4 v[124:127], v9, s[8:11], s63 offen offset:1024
HSB_1:
    s_lshl_b32 s3, s4, 7
    s_lshl_b32 s7, s5, 4
    s_add_u32 s3, s3, s7
    s_lshl_b32 s7, s6, 2
    s_add_u32 s3, s3, s7
    s_add_u32 s3, s3, 2326528
    s_waitcnt vmcnt(0)
    v_mov_b32 v12, 1
    v_mov_b32 v13, 0
    s_mov_b64 exec, 1
    s_cmp_lg_u32 s43, 0
    s_cbranch_scc1 HST_2
    buffer_store_dword v12, v13, s[8:11], s3 offen
HSB_2:
    s_mov_b64 exec, -1
    s_barrier
    v_and_b32 v12, 31, v0
    v_lshlrev_b32 v12, 2, v12
    s_lshl_b32 s30, s4, 7
    s_add_u32 s30, s30, 2326528
    s_lshl_b32 s31, s61, 5
    s_and_b32 s3, s6, 1
    s_lshl_b32 s3, s3, 4
    s_add_u32 s31, s31, s3
    s_lshl_b32 s31, s31, 10
    s_add_u32 s31, s31, 3145728
    s_mov_b32 s29, 131072
POLL_s2:
    buffer_load_dword v13, v12, s[8:11], s30 offen sc1
    s_waitcnt vmcnt(0)
    v_cmp_ne_u32 vcc, 1, v13
    s_nop 0
    s_cmp_eq_u64 vcc, 0
    s_cbranch_scc1 POLLD_s2
    s_sub_u32 s29, s29, 1
    s_cmp_lg_u32 s29, 0
    s_cbranch_scc1 POLL_s2
POLLD_s2:
    buffer_load_dwordx4 a[0:3], v9, s[8:11], s31 offen offset:0 sc1
    buffer_load_dwordx4 a[4:7], v9, s[8:11], s31 offen offset:1024 sc1
    buffer_load_dwordx4 a[8:11], v9, s[8:11], s31 offen offset:2048 sc1
    buffer_load_dwordx4 a[12:15], v9, s[8:11], s31 offen offset:3072 sc1
    s_add_u32 s31, s31, 4096
    buffer_load_dwordx4 a[16:19], v9, s[8:11], s31 offen offset:0 sc1
    buffer_load_dwordx4 a[20:23], v9, s[8:11], s31 offen offset:1024 sc1
    buffer_load_dwordx4 a[24:27], v9, s[8:11], s31 offen offset:2048 sc1
    buffer_load_dwordx4 a[28:31], v9, s[8:11], s31 offen offset:3072 sc1
    v_accvgpr_read_b32 v112, a192
    v_accvgpr_read_b32 v113, a193
    v_accvgpr_read_b32 v114, a194
    v_accvgpr_read_b32 v115, a195
    v_accvgpr_read_b32 v116, a196
    v_accvgpr_read_b32 v117, a197
    v_accvgpr_read_b32 v118, a198
    v_accvgpr_read_b32 v119, a199
    v_lshlrev_b32 v64, 16, v112
    v_and_b32 v65, 0xffff0000, v112
    v_lshlrev_b32 v66, 16, v113
    v_and_b32 v67, 0xffff0000, v113
    v_lshlrev_b32 v68, 16, v114
    v_and_b32 v69, 0xffff0000, v114
    v_lshlrev_b32 v70, 16, v115
    v_and_b32 v71, 0xffff0000, v115
    v_lshlrev_b32 v72, 16, v116
    v_and_b32 v73, 0xffff0000, v116
    v_lshlrev_b32 v74, 16, v117
    v_and_b32 v75, 0xffff0000, v117
    v_lshlrev_b32 v76, 16, v118
    v_and_b32 v77, 0xffff0000, v118
    v_lshlrev_b32 v78, 16, v119
    v_and_b32 v79, 0xffff0000, v119
    s_waitcnt vmcnt(7)
    v_mfma_f32_32x32x16_bf16 v[80:95], v[132:135], a[0:3], 0
    s_add_u32 s31, s31, 4096
    buffer_load_dwordx4 a[32:35], v9, s[8:11], s31 offen offset:0 sc1
    v_mfma_f32_32x32x16_bf16 v[64:79], v[128:131], a[0:3], v[64:79]
    s_waitcnt vmcnt(7)
    v_mfma_f32_32x32x16_bf16 v[80:95], v[140:143], a[4:7], v[80:95]
    buffer_load_dwordx4 a[36:39], v9, s[8:11], s31 offen offset:1024 sc1
    v_mfma_f32_32x32x16_bf16 v[64:79], v[136:139], a[4:7], v[64:79]
    s_waitcnt vmcnt(7)
    v_mfma_f32_32x32x16_bf16 v[80:95], v[148:151], a[8:11], v[80:95]
    buffer_load_dwordx4 a[40:43], v9, s[8:11], s31 offen offset:2048 sc1
    v_mfma_f32_32x32x16_bf16 v[64:79], v[144:147], a[8:11], v[64:79]
    s_waitcnt vmcnt(7)
    v_mfma_f32_32x32x16_bf16 v[80:95], v[156:159], a[12:15], v[80:95]
    buffer_load_dwordx4 a[44:47], v9, s[8:11], s31 offen offset:3072 sc1
    v_mfma_f32_32x32x16_bf16 v[64:79], v[152:155], a[12:15], v[64:79]
    s_waitcnt vmcnt(7)
    v_mfma_f32_32x32x16_bf16 v[80:95], v[164:167], a[16:19], v[80:95]
    s_add_u32 s31, s31, 4096
    buffer_load_dwordx4 a[48:51], v9, s[8:11], s31 offen offset:0 sc1
    v_mfma_f32_32x32x16_bf16 v[64:79], v[160:163], a[16:19], v[64:79]
    s_waitcnt vmcnt(7)
    v_mfma_f32_32x32x16_bf16 v[80:95], v[172:175], a[20:23], v[80:95]
    buffer_load_dwordx4 a[52:55], v9, s[8:11], s31 offen offset:1024 sc1
    v_mfma_f32_32x32x16_bf16 v[64:79], v[168:171], a[20:23], v[64:79]
    s_waitcnt vmcnt(7)
    v_mfma_f32_32x32x16_bf16 v[80:95], v[180:183], a[24:27], v[80:95]
    buffer_load_dwordx4 a[56:59], v9, s[8:11], s31 offen offset:2048 sc1
    v_mfma_f32_32x32x16_bf16 v[64:79], v[176:179], a[24:27], v[64:79]
    s_waitcnt vmcnt(7)
    v_mfma_f32_32x32x16_bf16 v[80:95], v[188:191], a[28:31], v[80:95]
    buffer_load_dwordx4 a[60:63], v9, s[8:11], s31 offen offset:3072 sc1
    v_mfma_f32_32x32x16_bf16 v[64:79], v[184:187], a[28:31], v[64:79]
    s_waitcnt vmcnt(7)
    v_mfma_f32_32x32x16_bf16 v[80:95], v[196:199], a[32:35], v[80:95]
    v_mfma_f32_32x32x16_bf16 v[64:79], v[192:195], a[32:35], v[64:79]
    s_waitcnt vmcnt(6)
    v_mfma_f32_32x32x16_bf16 v[80:95], v[204:207], a[36:39], v[80:95]
    v_mfma_f32_32x32x16_bf16 v[64:79], v[200:203], a[36:39], v[64:79]
    s_waitcnt vmcnt(5)
    v_mfma_f32_32x32x16_bf16 v[80:95], v[212:215], a[40:43], v[80:95]
    v_mfma_f32_32x32x16_bf16 v[64:79], v[208:211], a[40:43], v[64:79]
    s_waitcnt vmcnt(4)
    v_mfma_f32_32x32x16_bf16 v[80:95], v[220:223], a[44:47], v[80:95]
    v_mfma_f32_32x32x16_bf16 v[64:79], v[216:219], a[44:47], v[64:79]
    s_waitcnt vmcnt(3)
    v_mfma_f32_32x32x16_bf16 v[80:95], v[228:231], a[48:51], v[80:95]
    v_mfma_f32_32x32x16_bf16 v[64:79], v[224:227], a[48:51], v[64:79]
    s_waitcnt vmcnt(2)
    v_mfma_f32_32x32x16_bf16 v[80:95], v[236:239], a[52:55], v[80:95]
    v_mfma_f32_32x32x16_bf16 v[64:79], v[232:235], a[52:55], v[64:79]
    s_waitcnt vmcnt(1)
    v_mfma_f32_32x32x16_bf16 v[80:95], v[244:247], a[56:59], v[80:95]
    v_mfma_f32_32x32x16_bf16 v[64:79], v[240:243], a[56:59], v[64:79]
    s_waitcnt vmcnt(0)
    v_mfma_f32_32x32x16_bf16 v[80:95], v[252:255], a[60:63], v[80:95]
    v_mfma_f32_32x32x16_bf16 v[64:79], v[248:251], a[60:63], v[64:79]
    s_lshl_b32 s71, s61, 5
    s_lshl_b32 s7, s62, 1
    s_add_u32 s71, s71, s7
    s_lshl_b32 s71, s71, 10
    s_add_u32 s71, s71, 5242880
    s_lshl_b32 s3, s6, 12
    s_add_u32 s3, s3, 147456
    v_add_u32 v12, s3, v9
    s_nop 2
    ds_write_b128 v12, v[80:83] offset:0
    ds_write_b128 v12, v[84:87] offset:1024
    ds_write_b128 v12, v[88:91] offset:2048
    ds_write_b128 v12, v[92:95] offset:3072
    v_xor_b32 v12, 4096, v12
    s_waitcnt lgkmcnt(0)
    s_barrier
    ds_read_b128 v[80:83], v12 offset:0
    ds_read_b128 v[84:87], v12 offset:1024
    ds_read_b128 v[88:91], v12 offset:2048
    ds_read_b128 v[92:95], v12 offset:3072
    s_waitcnt lgkmcnt(3)
    v_pk_add_f32 v[64:65], v[64:65], v[80:81]
    v_pk_add_f32 v[66:67], v[66:67], v[82:83]
    s_waitcnt lgkmcnt(2)
    v_pk_add_f32 v[68:69], v[68:69], v[84:85]
    v_pk_add_f32 v[70:71], v[70:71], v[86:87]
    s_waitcnt lgkmcnt(1)
    v_pk_add_f32 v[72:73], v[72:73], v[88:89]
    v_pk_add_f32 v[74:75], v[74:75], v[90:91]
    s_waitcnt lgkmcnt(0)
    v_pk_add_f32 v[76:77], v[76:77], v[92:93]
    v_pk_add_f32 v[78:79], v[78:79], v[94:95]
    v_cvt_pk_bf16_f32 v32, v64, v65
    v_cvt_pk_bf16_f32 v33, v66, v67
    v_cvt_pk_bf16_f32 v34, v68, v69
    v_cvt_pk_bf16_f32 v35, v70, v71
    v_cvt_pk_bf16_f32 v36, v72, v73
    v_cvt_pk_bf16_f32 v37, v74, v75
    v_cvt_pk_bf16_f32 v38, v76, v77
    v_cvt_pk_bf16_f32 v39, v78, v79
    s_cmp_lg_u32 s43, 0
    s_cbranch_scc1 HST_3
    buffer_store_dwordx4 v[32:35], v9, s[8:11], s71 offen
    buffer_store_dwordx4 v[36:39], v9, s[8:11], s71 offen offset:1024
HSB_3:
    v_pk_mul_f32 v[42:43], v[64:65], v[64:65]
    v_pk_add_f32 v[40:41], v[64:65], v[66:67]
    v_pk_fma_f32 v[42:43], v[66:67], v[66:67], v[42:43]
    v_pk_add_f32 v[40:41], v[40:41], v[68:69]
    v_pk_fma_f32 v[42:43], v[68:69], v[68:69], v[42:43]
    v_pk_add_f32 v[40:41], v[40:41], v[70:71]
    v_pk_fma_f32 v[42:43], v[70:71], v[70:71], v[42:43]
    v_pk_add_f32 v[40:41], v[40:41], v[72:73]
    v_pk_fma_f32 v[42:43], v[72:73], v[72:73], v[42:43]
    v_pk_add_f32 v[40:41], v[40:41], v[74:75]
    v_pk_fma_f32 v[42:43], v[74:75], v[74:75], v[42:43]
    v_pk_add_f32 v[40:41], v[40:41], v[76:77]
    v_pk_fma_f32 v[42:43], v[76:77], v[76:77], v[42:43]
    v_pk_add_f32 v[40:41], v[40:41], v[78:79]
    v_pk_fma_f32 v[42:43], v[78:79], v[78:79], v[42:43]
    v_add_f32 v40, v40, v41
    v_add_f32 v41, v42, v43
    v_mov_b32 v42, v40
    v_mov_b32 v43, v41
    s_nop 0
    v_permlane32_swap_b32 v40, v42
    v_permlane32_swap_b32 v41, v43
    v_add_f32 v40, v40, v42
    v_add_f32 v41, v41, v43
    s_lshl_b32 s3, s61, 12
    s_lshl_b32 s7, s62, 8
    s_add_u32 s3, s3, s7
    s_add_u32 s3, s3, 7340032
    v_lshlrev_b32 v12, 3, v0
    v_accvgpr_write_b32 a248, v32
    v_accvgpr_write_b32 a249, v33
    v_accvgpr_write_b32 a250, v34
    v_accvgpr_write_b32 a251, v35
    v_accvgpr_write_b32 a252, v36
    v_accvgpr_write_b32 a253, v37
    v_accvgpr_write_b32 a254, v38
    v_accvgpr_write_b32 a255, v39
    s_waitcnt vmcnt(0)
    s_mov_b32 exec_hi, 0
    s_cmp_lg_u32 s43, 0
    s_cbranch_scc1 HST_4
    buffer_store_dwordx2 v[40:41], v12, s[8:11], s3 offen
HSB_4:
    s_mov_b64 exec, -1
    s_lshr_b32 s70, s4, 1
    s_lshl_b32 s70, s70, 2
    s_add_u32 s70, s70, s6
    v_lshrrev_b32 v1, 3, v0
    v_and_b32 v10, 7, v0
    v_lshrrev_b32 v11, 4, v0
    v_and_b32 v11, 1, v11
    v_lshlrev_b32 v11, 2, v11
    v_xor_b32 v11, v11, v10
    v_lshlrev_b32 v11, 4, v11
    v_lshl_add_u32 v1, v1, 10, v11
    s_lshl_b32 s3, s5, 7
    v_add_u32 v1, s3, v1
    s_lshl_b32 s74, s6, 12
    s_lshl_b32 s77, s6, 15
    s_lshr_b32 s3, s6, 1
    s_mul_i32 s75, s3, 704512
    v_lshrrev_b32 v11, 4, v0
    v_bfe_u32 v12, v0, 2, 2
    v_and_b32 v13, 3, v0
    v_lshrrev_b32 v14, 1, v11
    v_lshl_add_u32 v14, v14, 3, v12
    v_and_b32 v15, 1, v11
    v_and_b32 v96, 1, v13
    v_lshlrev_b32 v96, 4, v96
    v_lshrrev_b32 v97, 1, v13
    v_lshl_add_u32 v96, v97, 3, v96
    v_mul_u32_u24 v10, 192, v14
    v_add_u32 v10, v10, v96
    v_mul_u32_u24 v97, 12320, v15
    v_add_u32 v28, v10, v97
    v_mul_u32_u24 v97, 12128, v15
    v_add_u32 v29, v10, v97
    v_and_b32 v12, 31, v0
    v_lshlrev_b32 v12, 3, v12
    v_lshrrev_b32 v13, 5, v0
    v_lshl_add_u32 v30, v13, 11, v12
    v_lshlrev_b32 v12, 2, v0
    s_lshr_b32 s30, s4, 1
    s_lshl_b32 s30, s30, 8
    s_add_u32 s30, s30, 2330624
    s_mov_b32 s24, s48
    s_mov_b32 s25, s49
    s_mov_b32 s26, 0x00158000
    s_mov_b32 s27, 0x20000
    s_lshr_b32 s79, s2, 3
    s_lshl_b32 s79, s79, 2
    s_add_u32 s79, s79, s6
    s_mul_i32 s79, s79, 11008
    v_lshlrev_b32 v14, 6, v0
    s_lshl_b32 s30, s70, 15
    s_add_u32 s30, s30, 5242880
    s_lshl_b32 s31, s70, 12
    s_add_u32 s31, s31, 7340032
    s_mov_b32 s29, 131072
POLL_hs3:
    buffer_load_dwordx2 v[32:33], v30, s[8:11], s31 offen offset:0 sc1
    buffer_load_dwordx2 v[34:35], v30, s[8:11], s31 offen offset:256 sc1
    buffer_load_dwordx2 v[36:37], v30, s[8:11], s31 offen offset:512 sc1
    buffer_load_dwordx2 v[38:39], v30, s[8:11], s31 offen offset:768 sc1
    buffer_load_dwordx2 v[40:41], v30, s[8:11], s31 offen offset:1024 sc1
    buffer_load_dwordx2 v[42:43], v30, s[8:11], s31 offen offset:1280 sc1
    buffer_load_dwordx2 v[44:45], v30, s[8:11], s31 offen offset:1536 sc1
    buffer_load_dwordx2 v[46:47], v30, s[8:11], s31 offen offset:1792 sc1
    s_waitcnt vmcnt(0)
    v_max3_u32 v48, v33, v35, v37
    v_max3_u32 v49, v39, v41, v43
    v_max3_u32 v48, v48, v45, v47
    v_max_u32 v48, v48, v49
    v_cmp_eq_u32 vcc, -1, v48
    s_nop 0
    s_cmp_eq_u64 vcc, 0
    s_cbranch_scc1 POLLD_hs3
    s_sub_u32 s29, s29, 1
    s_cmp_lg_u32 s29, 0
    s_cbranch_scc1 POLL_hs3
POLLD_hs3:
    s_add_u32 s3, s30, 0
    buffer_load_dwordx4 v[128:131], v9, s[8:11], s3 offen sc1
    s_add_u32 s3, s30, 1024
    buffer_load_dwordx4 v[132:135], v9, s[8:11], s3 offen sc1
    s_add_u32 s3, s30, 2048
    buffer_load_dwordx4 v[136:139], v9, s[8:11], s3 offen sc1
    s_add_u32 s3, s30, 3072
    buffer_load_dwordx4 v[140:143], v9, s[8:11], s3 offen sc1
    s_add_u32 s3, s30, 4096
    buffer_load_dwordx4 v[144:147], v9, s[8:11], s3 offen sc1
    s_add_u32 s3, s30, 5120
    buffer_load_dwordx4 v[148:151], v9, s[8:11], s3 offen sc1
    s_add_u32 s3, s30, 6144
    buffer_load_dwordx4 v[152:155], v9, s[8:11], s3 offen sc1
    s_add_u32 s3, s30, 7168
    buffer_load_dwordx4 v[156:159], v9, s[8:11], s3 offen sc1
    v_add_u32 v10, 0, v28
    v_add_u32 v11, 0, v29
    ds_read_b64_tr_b16 a[0:1], v10 offset:0
    ds_read_b64_tr_b16 a[2:3], v10 offset:768
    ds_read_b64_tr_b16 a[4:5], v10 offset:32
    ds_read_b64_tr_b16 a[6:7], v10 offset:800
    ds_read_b64_tr_b16 a[8:9], v10 offset:64
    ds_read_b64_tr_b16 a[10:11], v10 offset:832
    ds_read_b64_tr_b16 a[12:13], v10 offset:96
    ds_read_b64_tr_b16 a[14:15], v10 offset:864
    ds_read_b64_tr_b16 a[16:17], v10 offset:128
    ds_read_b64_tr_b16 a[18:19], v10 offset:896
    ds_read_b64_tr_b16 a[20:21], v11 offset:160
    ds_read_b64_tr_b16 a[22:23], v11 offset:928
    v_pk_add_f32 v[32:33], v[32:33], v[34:35]
    v_pk_add_f32 v[40:41], v[40:41], v[42:43]
    v_pk_add_f32 v[36:37], v[36:37], v[38:39]
    v_pk_add_f32 v[44:45], v[44:45], v[46:47]
    v_pk_add_f32 v[32:33], v[32:33], v[36:37]
    v_pk_add_f32 v[40:41], v[40:41], v[44:45]
    v_pk_add_f32 v[16:17], v[32:33], v[40:41]
    v_mov_b32 v18, v16
    v_mov_b32 v19, v17
    s_nop 0
    v_permlane32_swap_b32 v16, v18
    v_permlane32_swap_b32 v17, v19
    v_add_f32 v16, v16, v18
    v_add_f32 v17, v17, v19
    v_mul_f32 v16, 0x3b000000, v16
    v_mul_f32 v17, 0x3b000000, v17
    v_fma_f32 v17, -v16, v16, v17
    v_max_f32 v17, 0, v17
    v_add_f32 v17, 0x3727c5ac, v17
    v_rsq_f32 v17, v17
    s_nop 0
    v_mul_f32 v16, v16, v17
    v_sub_f32 v18, 0, v16
    v_mov_b32 v19, v18
    v_mov_b32 v16, v17
    s_waitcnt vmcnt(7)
    v_lshlrev_b32 v20, 16, v128
    v_and_b32 v21, 0xffff0000, v128
    v_lshlrev_b32 v22, 16, v129
    v_and_b32 v23, 0xffff0000, v129
    v_fma_f32 v20, v20, v16, v18
    v_fma_f32 v21, v21, v16, v18
    v_fma_f32 v22, v22, v16, v18
    v_fma_f32 v23, v23, v16, v18
    v_cvt_pk_bf16_f32 v128, v20, v21
    v_cvt_pk_bf16_f32 v129, v22, v23
    v_lshlrev_b32 v24, 16, v130
    v_and_b32 v25, 0xffff0000, v130
    v_lshlrev_b32 v26, 16, v131
    v_and_b32 v27, 0xffff0000, v131
    v_fma_f32 v24, v24, v16, v18
    v_fma_f32 v25, v25, v16, v18
    v_fma_f32 v26, v26, v16, v18
    v_fma_f32 v27, v27, v16, v18
    v_cvt_pk_bf16_f32 v130, v24, v25
    v_cvt_pk_bf16_f32 v131, v26, v27
    s_cmp_eq_u32 s67, 4
    s_cbranch_scc1 F1L_4
    s_waitcnt vmcnt(6)
    s_waitcnt lgkmcnt(6)
    v_mfma_f32_32x32x16_bf16 v[32:47], a[0:3], v[128:131], 0
    ds_read_b64_tr_b16 a[24:25], v10 offset:3072
    ds_read_b64_tr_b16 a[26:27], v10 offset:3840
    v_lshlrev_b32 v20, 16, v132
    v_and_b32 v21, 0xffff0000, v132
    v_lshlrev_b32 v22, 16, v133
    v_mfma_f32_32x32x16_bf16 v[48:63], a[4:7], v[128:131], 0
    ds_read_b64_tr_b16 a[28:29], v10 offset:3104
    ds_read_b64_tr_b16 a[30:31], v10 offset:3872
    v_and_b32 v23, 0xffff0000, v133
    v_fma_f32 v20, v20, v16, v18
    v_fma_f32 v21, v21, v16, v18
    v_fma_f32 v22, v22, v16, v18
    s_add_u32 s3, s30, 8192
    buffer_load_dwordx4 v[160:163], v9, s[8:11], s3 offen sc1
    v_mfma_f32_32x32x16_bf16 v[64:79], a[8:11], v[128:131], 0
    ds_read_b64_tr_b16 a[32:33], v10 offset:3136
    ds_read_b64_tr_b16 a[34:35], v10 offset:3904
    v_fma_f32 v23, v23, v16, v18
    v_cvt_pk_bf16_f32 v132, v20, v21
    v_cvt_pk_bf16_f32 v133, v22, v23
    s_waitcnt lgkmcnt(6)
    v_mfma_f32_32x32x16_bf16 v[80:95], a[12:15], v[128:131], 0
    ds_read_b64_tr_b16 a[36:37], v10 offset:3168
    ds_read_b64_tr_b16 a[38:39], v10 offset:3936
    v_lshlrev_b32 v24, 16, v134
    v_and_b32 v25, 0xffff0000, v134
    v_lshlrev_b32 v26, 16, v135
    s_add_u32 m0, s69, 73728
    s_add_u32 s71, s68, 528384
    buffer_load_dwordx4 v2, s[16:19], s71 offen offset:0 lds
    v_mfma_f32_32x32x16_bf16 v[96:111], a[16:19], v[128:131], 0
    ds_read_b64_tr_b16 a[40:41], v10 offset:3200
    ds_read_b64_tr_b16 a[42:43], v10 offset:3968
    v_and_b32 v27, 0xffff0000, v135
    v_fma_f32 v24, v24, v16, v18
    v_fma_f32 v25, v25, v16, v18
    v_fma_f32 v26, v26, v16, v18
    v_mfma_f32_32x32x16_bf16 v[112:127], a[20:23], v[128:131], 0
    ds_read_b64_tr_b16 a[44:45], v11 offset:3232
    ds_read_b64_tr_b16 a[46:47], v11 offset:4000
    v_fma_f32 v27, v27, v16, v18
    v_cvt_pk_bf16_f32 v134, v24, v25
    v_cvt_pk_bf16_f32 v135, v26, v27
    buffer_load_dwordx4 v3, s[16:19], s71 offen offset:1024 lds
    s_waitcnt vmcnt(8)
    s_waitcnt lgkmcnt(6)
    v_mfma_f32_32x32x16_bf16 v[32:47], a[24:27], v[132:135], v[32:47]
    ds_read_b64_tr_b16 a[0:1], v10 offset:6144
    ds_read_b64_tr_b16 a[2:3], v10 offset:6912
    v_lshlrev_b32 v20, 16, v136
    v_and_b32 v21, 0xffff0000, v136
    v_lshlrev_b32 v22, 16, v137
    v_mfma_f32_32x32x16_bf16 v[48:63], a[28:31], v[132:135], v[48:63]
    ds_read_b64_tr_b16 a[4:5], v10 offset:6176
    ds_read_b64_tr_b16 a[6:7], v10 offset:6944
    v_and_b32 v23, 0xffff0000, v137
    v_fma_f32 v20, v20, v16, v18
    v_fma_f32 v21, v21, v16, v18
    v_fma_f32 v22, v22, v16, v18
    s_add_u32 s3, s30, 9216
    buffer_load_dwordx4 v[164:167], v9, s[8:11], s3 offen sc1
    v_mfma_f32_32x32x16_bf16 v[64:79], a[32:35], v[132:135], v[64:79]
    ds_read_b64_tr_b16 a[8:9], v10 offset:6208
    ds_read_b64_tr_b16 a[10:11], v10 offset:6976
    v_fma_f32 v23, v23, v16, v18
    v_cvt_pk_bf16_f32 v136, v20, v21
    v_cvt_pk_bf16_f32 v137, v22, v23
    s_waitcnt lgkmcnt(6)
    v_mfma_f32_32x32x16_bf16 v[80:95], a[36:39], v[132:135], v[80:95]
    ds_read_b64_tr_b16 a[12:13], v10 offset:6240
    ds_read_b64_tr_b16 a[14:15], v10 offset:7008
    v_lshlrev_b32 v24, 16, v138
    v_and_b32 v25, 0xffff0000, v138
    v_lshlrev_b32 v26, 16, v139
    buffer_load_dwordx4 v4, s[16:19], s71 offen offset:2048 lds
    v_mfma_f32_32x32x16_bf16 v[96:111], a[40:43], v[132:135], v[96:111]
    ds_read_b64_tr_b16 a[16:17], v10 offset:6272
    ds_read_b64_tr_b16 a[18:19], v10 offset:7040
    v_and_b32 v27, 0xffff0000, v139
    v_fma_f32 v24, v24, v16, v18
    v_fma_f32 v25, v25, v16, v18
    v_fma_f32 v26, v26, v16, v18
    v_mfma_f32_32x32x16_bf16 v[112:127], a[44:47], v[132:135], v[112:127]
    ds_read_b64_tr_b16 a[20:21], v11 offset:6304
    ds_read_b64_tr_b16 a[22:23], v11 offset:7072
    v_fma_f32 v27, v27, v16, v18
    v_cvt_pk_bf16_f32 v138, v24, v25
    v_cvt_pk_bf16_f32 v139, v26, v27
    s_add_u32 m0, s69, 86016
    s_nop 0
    buffer_load_dwordx4 v5, s[20:23], s71 offen offset:0 lds
    s_waitcnt vmcnt(10)
    s_waitcnt lgkmcnt(6)
    v_mfma_f32_32x32x16_bf16 v[32:47], a[0:3], v[136:139], v[32:47]
    ds_read_b64_tr_b16 a[24:25], v10 offset:9216
    ds_read_b64_tr_b16 a[26:27], v10 offset:9984
    v_lshlrev_b32 v20, 16, v140
    v_and_b32 v21, 0xffff0000, v140
    v_lshlrev_b32 v22, 16, v141
    v_mfma_f32_32x32x16_bf16 v[48:63], a[4:7], v[136:139], v[48:63]
    ds_read_b64_tr_b16 a[28:29], v10 offset:9248
    ds_read_b64_tr_b16 a[30:31], v10 offset:10016
    v_and_b32 v23, 0xffff0000, v141
    v_fma_f32 v20, v20, v16, v18
    v_fma_f32 v21, v21, v16, v18
    v_fma_f32 v22, v22, v16, v18
    s_add_u32 s3, s30, 10240
    buffer_load_dwordx4 v[168:171], v9, s[8:11], s3 offen sc1
    v_mfma_f32_32x32x16_bf16 v[64:79], a[8:11], v[136:139], v[64:79]
    ds_read_b64_tr_b16 a[32:33], v10 offset:9280
    ds_read_b64_tr_b16 a[34:35], v10 offset:10048
    v_fma_f32 v23, v23, v16, v18
    v_cvt_pk_bf16_f32 v140, v20, v21
    v_cvt_pk_bf16_f32 v141, v22, v23
    s_waitcnt lgkmcnt(6)
    v_mfma_f32_32x32x16_bf16 v[80:95], a[12:15], v[136:139], v[80:95]
    ds_read_b64_tr_b16 a[36:37], v10 offset:9312
    ds_read_b64_tr_b16 a[38:39], v10 offset:10080
    v_lshlrev_b32 v24, 16, v142
    v_and_b32 v25, 0xffff0000, v142
    v_lshlrev_b32 v26, 16, v143
    buffer_load_dwordx4 v6, s[20:23], s71 offen offset:1024 lds
    v_mfma_f32_32x32x16_bf16 v[96:111], a[16:19], v[136:139], v[96:111]
    ds_read_b64_tr_b16 a[40:41], v10 offset:9344
    ds_read_b64_tr_b16 a[42:43], v10 offset:10112
    v_and_b32 v27, 0xffff0000, v143
    v_fma_f32 v24, v24, v16, v18
    v_fma_f32 v25, v25, v16, v18
    v_fma_f32 v26, v26, v16, v18
    v_mfma_f32_32x32x16_bf16 v[112:127], a[20:23], v[136:139], v[112:127]
    ds_read_b64_tr_b16 a[44:45], v11 offset:9376
    ds_read_b64_tr_b16 a[46:47], v11 offset:10144
    v_fma_f32 v27, v27, v16, v18
    v_cvt_pk_bf16_f32 v142, v24, v25
    v_cvt_pk_bf16_f32 v143, v26, v27
    buffer_load_dwordx4 v7, s[20:23], s71 offen offset:2048 lds
    v_add_u32 v10, 24576, v28
    v_add_u32 v11, 24576, v29
    s_waitcnt vmcnt(12)
    s_waitcnt lgkmcnt(6)
    v_mfma_f32_32x32x16_bf16 v[32:47], a[24:27], v[140:143], v[32:47]
    ds_read_b64_tr_b16 a[0:1], v10 offset:0
    ds_read_b64_tr_b16 a[2:3], v10 offset:768
    v_lshlrev_b32 v20, 16, v144
    v_and_b32 v21, 0xffff0000, v144
    v_lshlrev_b32 v22, 16, v145
    v_mfma_f32_32x32x16_bf16 v[48:63], a[28:31], v[140:143], v[48:63]
    ds_read_b64_tr_b16 a[4:5], v10 offset:32
    ds_read_b64_tr_b16 a[6:7], v10 offset:800
    v_and_b32 v23, 0xffff0000, v145
    v_fma_f32 v20, v20, v16, v18
    v_fma_f32 v21, v21, v16, v18
    v_fma_f32 v22, v22, v16, v18
    s_add_u32 s3, s30, 11264
    buffer_load_dwordx4 v[172:175], v9, s[8:11], s3 offen sc1
    v_mfma_f32_32x32x16_bf16 v[64:79], a[32:35], v[140:143], v[64:79]
    ds_read_b64_tr_b16 a[8:9], v10 offset:64
    ds_read_b64_tr_b16 a[10:11], v10 offset:832
    v_fma_f32 v23, v23, v16, v18
    v_cvt_pk_bf16_f32 v144, v20, v21
    v_cvt_pk_bf16_f32 v145, v22, v23
    s_waitcnt lgkmcnt(6)
    v_mfma_f32_32x32x16_bf16 v[80:95], a[36:39], v[140:143], v[80:95]
    ds_read_b64_tr_b16 a[12:13], v10 offset:96
    ds_read_b64_tr_b16 a[14:15], v10 offset:864
    v_lshlrev_b32 v24, 16, v146
    v_and_b32 v25, 0xffff0000, v146
    v_lshlrev_b32 v26, 16, v147
    s_add_u32 m0, s69, 98304
    s_add_u32 s71, s68, 704512
    buffer_load_dwordx4 v2, s[16:19], s71 offen offset:0 lds
    v_mfma_f32_32x32x16_bf16 v[96:111], a[40:43], v[140:143], v[96:111]
    ds_read_b64_tr_b16 a[16:17], v10 offset:128
    ds_read_b64_tr_b16 a[18:19], v10 offset:896
    v_and_b32 v27, 0xffff0000, v147
    v_fma_f32 v24, v24, v16, v18
    v_fma_f32 v25, v25, v16, v18
    v_fma_f32 v26, v26, v16, v18
    v_mfma_f32_32x32x16_bf16 v[112:127], a[44:47], v[140:143], v[112:127]
    ds_read_b64_tr_b16 a[20:21], v11 offset:160
    ds_read_b64_tr_b16 a[22:23], v11 offset:928
    v_fma_f32 v27, v27, v16, v18
    v_cvt_pk_bf16_f32 v146, v24, v25
    v_cvt_pk_bf16_f32 v147, v26, v27
    buffer_load_dwordx4 v3, s[16:19], s71 offen offset:1024 lds
    s_waitcnt vmcnt(14)
    s_waitcnt lgkmcnt(6)
    v_mfma_f32_32x32x16_bf16 v[32:47], a[0:3], v[144:147], v[32:47]
    ds_read_b64_tr_b16 a[24:25], v10 offset:3072
    ds_read_b64_tr_b16 a[26:27], v10 offset:3840
    v_lshlrev_b32 v20, 16, v148
    v_and_b32 v21, 0xffff0000, v148
    v_lshlrev_b32 v22, 16, v149
    v_mfma_f32_32x32x16_bf16 v[48:63], a[4:7], v[144:147], v[48:63]
    ds_read_b64_tr_b16 a[28:29], v10 offset:3104
    ds_read_b64_tr_b16 a[30:31], v10 offset:3872
    v_and_b32 v23, 0xffff0000, v149
    v_fma_f32 v20, v20, v16, v18
    v_fma_f32 v21, v21, v16, v18
    v_fma_f32 v22, v22, v16, v18
    s_add_u32 s3, s30, 12288
    buffer_load_dwordx4 v[176:179], v9, s[8:11], s3 offen sc1
    v_mfma_f32_32x32x16_bf16 v[64:79], a[8:11], v[144:147], v[64:79]
    ds_read_b64_tr_b16 a[32:33], v10 offset:3136
    ds_read_b64_tr_b16 a[34:35], v10 offset:3904
    v_fma_f32 v23, v23, v16, v18
    v_cvt_pk_bf16_f32 v148, v20, v21
    v_cvt_pk_bf16_f32 v149, v22, v23
    s_waitcnt lgkmcnt(6)
    v_mfma_f32_32x32x16_bf16 v[80:95], a[12:15], v[144:147], v[80:95]
    ds_read_b64_tr_b16 a[36:37], v10 offset:3168
    ds_read_b64_tr_b16 a[38:39], v10 offset:3936
    v_lshlrev_b32 v24, 16, v150
    v_and_b32 v25, 0xffff0000, v150
    v_lshlrev_b32 v26, 16, v151
    buffer_load_dwordx4 v4, s[16:19], s71 offen offset:2048 lds
    v_mfma_f32_32x32x16_bf16 v[96:111], a[16:19], v[144:147], v[96:111]
    ds_read_b64_tr_b16 a[40:41], v10 offset:3200
    ds_read_b64_tr_b16 a[42:43], v10 offset:3968
    v_and_b32 v27, 0xffff0000, v151
    v_fma_f32 v24, v24, v16, v18
    v_fma_f32 v25, v25, v16, v18
    v_fma_f32 v26, v26, v16, v18
    v_mfma_f32_32x32x16_bf16 v[112:127], a[20:23], v[144:147], v[112:127]
    ds_read_b64_tr_b16 a[44:45], v11 offset:3232
    ds_read_b64_tr_b16 a[46:47], v11 offset:4000
    v_fma_f32 v27, v27, v16, v18
    v_cvt_pk_bf16_f32 v150, v24, v25
    v_cvt_pk_bf16_f32 v151, v26, v27
    s_add_u32 m0, s69, 110592
    s_nop 0
    buffer_load_dwordx4 v5, s[20:23], s71 offen offset:0 lds
    s_waitcnt vmcnt(16)
    s_waitcnt lgkmcnt(6)
    v_mfma_f32_32x32x16_bf16 v[32:47], a[24:27], v[148:151], v[32:47]
    ds_read_b64_tr_b16 a[0:1], v10 offset:6144
    ds_read_b64_tr_b16 a[2:3], v10 offset:6912
    v_lshlrev_b32 v20, 16, v152
    v_and_b32 v21, 0xffff0000, v152
    v_lshlrev_b32 v22, 16, v153
    v_mfma_f32_32x32x16_bf16 v[48:63], a[28:31], v[148:151], v[48:63]
    ds_read_b64_tr_b16 a[4:5], v10 offset:6176
    ds_read_b64_tr_b16 a[6:7], v10 offset:6944
    v_and_b32 v23, 0xffff0000, v153
    v_fma_f32 v20, v20, v16, v18
    v_fma_f32 v21, v21, v16, v18
    v_fma_f32 v22, v22, v16, v18
    s_add_u32 s3, s30, 13312
    buffer_load_dwordx4 v[180:183], v9, s[8:11], s3 offen sc1
    v_mfma_f32_32x32x16_bf16 v[64:79], a[32:35], v[148:151], v[64:79]
    ds_read_b64_tr_b16 a[8:9], v10 offset:6208
    ds_read_b64_tr_b16 a[10:11], v10 offset:6976
    v_fma_f32 v23, v23, v16, v18
    v_cvt_pk_bf16_f32 v152, v20, v21
    v_cvt_pk_bf16_f32 v153, v22, v23
    s_waitcnt lgkmcnt(6)
    v_mfma_f32_32x32x16_bf16 v[80:95], a[36:39], v[148:151], v[80:95]
    ds_read_b64_tr_b16 a[12:13], v10 offset:6240
    ds_read_b64_tr_b16 a[14:15], v10 offset:7008
    v_lshlrev_b32 v24, 16, v154
    v_and_b32 v25, 0xffff0000, v154
    v_lshlrev_b32 v26, 16, v155
    buffer_load_dwordx4 v6, s[20:23], s71 offen offset:1024 lds
    v_mfma_f32_32x32x16_bf16 v[96:111], a[40:43], v[148:151], v[96:111]
    ds_read_b64_tr_b16 a[16:17], v10 offset:6272
    ds_read_b64_tr_b16 a[18:19], v10 offset:7040
    v_and_b32 v27, 0xffff0000, v155
    v_fma_f32 v24, v24, v16, v18
    v_fma_f32 v25, v25, v16, v18
    v_fma_f32 v26, v26, v16, v18
    v_mfma_f32_32x32x16_bf16 v[112:127], a[44:47], v[148:151], v[112:127]
    ds_read_b64_tr_b16 a[20:21], v11 offset:6304
    ds_read_b64_tr_b16 a[22:23], v11 offset:7072
    v_fma_f32 v27, v27, v16, v18
    v_cvt_pk_bf16_f32 v154, v24, v25
    v_cvt_pk_bf16_f32 v155, v26, v27
    buffer_load_dwordx4 v7, s[20:23], s71 offen offset:2048 lds
    s_waitcnt vmcnt(18)
    s_waitcnt lgkmcnt(6)
    v_mfma_f32_32x32x16_bf16 v[32:47], a[0:3], v[152:155], v[32:47]
    ds_read_b64_tr_b16 a[24:25], v10 offset:9216
    ds_read_b64_tr_b16 a[26:27], v10 offset:9984
    v_lshlrev_b32 v20, 16, v156
    v_and_b32 v21, 0xffff0000, v156
    v_lshlrev_b32 v22, 16, v157
    v_mfma_f32_32x32x16_bf16 v[48:63], a[4:7], v[152:155], v[48:63]
    ds_read_b64_tr_b16 a[28:29], v10 offset:9248
    ds_read_b64_tr_b16 a[30:31], v10 offset:10016
    v_and_b32 v23, 0xffff0000, v157
    v_fma_f32 v20, v20, v16, v18
    v_fma_f32 v21, v21, v16, v18
    v_fma_f32 v22, v22, v16, v18
    s_add_u32 s3, s30, 14336
    buffer_load_dwordx4 v[184:187], v9, s[8:11], s3 offen sc1
    v_mfma_f32_32x32x16_bf16 v[64:79], a[8:11], v[152:155], v[64:79]
    ds_read_b64_tr_b16 a[32:33], v10 offset:9280
    ds_read_b64_tr_b16 a[34:35], v10 offset:10048
    v_fma_f32 v23, v23, v16, v18
    v_cvt_pk_bf16_f32 v156, v20, v21
    v_cvt_pk_bf16_f32 v157, v22, v23
    s_waitcnt lgkmcnt(6)
    v_mfma_f32_32x32x16_bf16 v[80:95], a[12:15], v[152:155], v[80:95]
    ds_read_b64_tr_b16 a[36:37], v10 offset:9312
    ds_read_b64_tr_b16 a[38:39], v10 offset:10080
    v_lshlrev_b32 v24, 16, v158
    v_and_b32 v25, 0xffff0000, v158
    v_lshlrev_b32 v26, 16, v159
    s_add_u32 m0, s69, 122880
    s_add_u32 s71, s68, 880640
    buffer_load_dwordx4 v2, s[16:19], s71 offen offset:0 lds
    v_mfma_f32_32x32x16_bf16 v[96:111], a[16:19], v[152:155], v[96:111]
    ds_read_b64_tr_b16 a[40:41], v10 offset:9344
    ds_read_b64_tr_b16 a[42:43], v10 offset:10112
    v_and_b32 v27, 0xffff0000, v159
    v_fma_f32 v24, v24, v16, v18
    v_fma_f32 v25, v25, v16, v18
    v_fma_f32 v26, v26, v16, v18
    v_mfma_f32_32x32x16_bf16 v[112:127], a[20:23], v[152:155], v[112:127]
    ds_read_b64_tr_b16 a[44:45], v11 offset:9376
    ds_read_b64_tr_b16 a[46:47], v11 offset:10144
    v_fma_f32 v27, v27, v16, v18
    v_cvt_pk_bf16_f32 v158, v24, v25
    v_cvt_pk_bf16_f32 v159, v26, v27
    buffer_load_dwordx4 v3, s[16:19], s71 offen offset:1024 lds
    v_add_u32 v10, 49152, v28
    v_add_u32 v11, 49152, v29
    s_waitcnt vmcnt(20)
    s_waitcnt lgkmcnt(6)
    v_mfma_f32_32x32x16_bf16 v[32:47], a[24:27], v[156:159], v[32:47]
    ds_read_b64_tr_b16 a[0:1], v10 offset:0
    ds_read_b64_tr_b16 a[2:3], v10 offset:768
    v_lshlrev_b32 v20, 16, v160
    v_and_b32 v21, 0xffff0000, v160
    v_lshlrev_b32 v22, 16, v161
    v_mfma_f32_32x32x16_bf16 v[48:63], a[28:31], v[156:159], v[48:63]
    ds_read_b64_tr_b16 a[4:5], v10 offset:32
    ds_read_b64_tr_b16 a[6:7], v10 offset:800
    v_and_b32 v23, 0xffff0000, v161
    v_fma_f32 v20, v20, v16, v18
    v_fma_f32 v21, v21, v16, v18
    v_fma_f32 v22, v22, v16, v18
    s_add_u32 s3, s30, 15360
    buffer_load_dwordx4 v[188:191], v9, s[8:11], s3 offen sc1
    v_mfma_f32_32x32x16_bf16 v[64:79], a[32:35], v[156:159], v[64:79]
    ds_read_b64_tr_b16 a[8:9], v10 offset:64
    ds_read_b64_tr_b16 a[10:11], v10 offset:832
    v_fma_f32 v23, v23, v16, v18
    v_cvt_pk_bf16_f32 v160, v20, v21
    v_cvt_pk_bf16_f32 v161, v22, v23
    s_waitcnt lgkmcnt(6)
    v_mfma_f32_32x32x16_bf16 v[80:95], a[36:39], v[156:159], v[80:95]
    ds_read_b64_tr_b16 a[12:13], v10 offset:96
    ds_read_b64_tr_b16 a[14:15], v10 offset:864
    v_lshlrev_b32 v24, 16, v162
    v_and_b32 v25, 0xffff0000, v162
    v_lshlrev_b32 v26, 16, v163
    buffer_load_dwordx4 v4, s[16:19], s71 offen offset:2048 lds
    v_mfma_f32_32x32x16_bf16 v[96:111], a[40:43], v[156:159], v[96:111]
    ds_read_b64_tr_b16 a[16:17], v10 offset:128
    ds_read_b64_tr_b16 a[18:19], v10 offset:896
    v_and_b32 v27, 0xffff0000, v163
    v_fma_f32 v24, v24, v16, v18
    v_fma_f32 v25, v25, v16, v18
    v_fma_f32 v26, v26, v16, v18
    v_mfma_f32_32x32x16_bf16 v[112:127], a[44:47], v[156:159], v[112:127]
    ds_read_b64_tr_b16 a[20:21], v11 offset:160
    ds_read_b64_tr_b16 a[22:23], v11 offset:928
    v_fma_f32 v27, v27, v16, v18
    v_cvt_pk_bf16_f32 v162, v24, v25
    v_cvt_pk_bf16_f32 v163, v26, v27
    s_add_u32 m0, s69, 135168
    s_nop 0
    buffer_load_dwordx4 v5, s[20:23], s71 offen offset:0 lds
    s_waitcnt vmcnt(15)
    s_barrier
    s_waitcnt vmcnt(20)
    s_waitcnt lgkmcnt(6)
    v_mfma_f32_32x32x16_bf16 v[32:47], a[0:3], v[160:163], v[32:47]
    ds_read_b64_tr_b16 a[24:25], v10 offset:3072
    ds_read_b64_tr_b16 a[26:27], v10 offset:3840
    v_lshlrev_b32 v20, 16, v164
    v_and_b32 v21, 0xffff0000, v164
    v_lshlrev_b32 v22, 16, v165
    v_mfma_f32_32x32x16_bf16 v[48:63], a[4:7], v[160:163], v[48:63]
    ds_read_b64_tr_b16 a[28:29], v10 offset:3104
    ds_read_b64_tr_b16 a[30:31], v10 offset:3872
    v_and_b32 v23, 0xffff0000, v165
    v_fma_f32 v20, v20, v16, v18
    v_fma_f32 v21, v21, v16, v18
    v_fma_f32 v22, v22, v16, v18
    s_add_u32 s3, s30, 16384
    buffer_load_dwordx4 v[192:195], v9, s[8:11], s3 offen sc1
    v_mfma_f32_32x32x16_bf16 v[64:79], a[8:11], v[160:163], v[64:79]
    ds_read_b64_tr_b16 a[32:33], v10 offset:3136
    ds_read_b64_tr_b16 a[34:35], v10 offset:3904
    v_fma_f32 v23, v23, v16, v18
    v_cvt_pk_bf16_f32 v164, v20, v21
    v_cvt_pk_bf16_f32 v165, v22, v23
    s_waitcnt lgkmcnt(6)
    v_mfma_f32_32x32x16_bf16 v[80:95], a[12:15], v[160:163], v[80:95]
    ds_read_b64_tr_b16 a[36:37], v10 offset:3168
    ds_read_b64_tr_b16 a[38:39], v10 offset:3936
    v_lshlrev_b32 v24, 16, v166
    v_and_b32 v25, 0xffff0000, v166
    v_lshlrev_b32 v26, 16, v167
    buffer_load_dwordx4 v6, s[20:23], s71 offen offset:1024 lds
    v_mfma_f32_32x32x16_bf16 v[96:111], a[16:19], v[160:163], v[96:111]
    ds_read_b64_tr_b16 a[40:41], v10 offset:3200
    ds_read_b64_tr_b16 a[42:43], v10 offset:3968
    v_and_b32 v27, 0xffff0000, v167
    v_fma_f32 v24, v24, v16, v18
    v_fma_f32 v25, v25, v16, v18
    v_fma_f32 v26, v26, v16, v18
    v_mfma_f32_32x32x16_bf16 v[112:127], a[20:23], v[160:163], v[112:127]
    ds_read_b64_tr_b16 a[44:45], v11 offset:3232
    ds_read_b64_tr_b16 a[46:47], v11 offset:4000
    v_fma_f32 v27, v27, v16, v18
    v_cvt_pk_bf16_f32 v166, v24, v25
    v_cvt_pk_bf16_f32 v167, v26, v27
    buffer_load_dwordx4 v7, s[20:23], s71 offen offset:2048 lds
    s_waitcnt vmcnt(20)
    s_waitcnt lgkmcnt(6)
    v_mfma_f32_32x32x16_bf16 v[32:47], a[24:27], v[164:167], v[32:47]
    ds_read_b64_tr_b16 a[0:1], v10 offset:6144
    ds_read_b64_tr_b16 a[2:3], v10 offset:6912
    v_lshlrev_b32 v20, 16, v168
    v_and_b32 v21, 0xffff0000, v168
    v_lshlrev_b32 v22, 16, v169
    v_mfma_f32_32x32x16_bf16 v[48:63], a[28:31], v[164:167], v[48:63]
    ds_read_b64_tr_b16 a[4:5], v10 offset:6176
    ds_read_b64_tr_b16 a[6:7], v10 offset:6944
    v_and_b32 v23, 0xffff0000, v169
    v_fma_f32 v20, v20, v16, v18
    v_fma_f32 v21, v21, v16, v18
    v_fma_f32 v22, v22, v16, v18
    s_add_u32 s3, s30, 17408
    buffer_load_dwordx4 v[196:199], v9, s[8:11], s3 offen sc1
    v_mfma_f32_32x32x16_bf16 v[64:79], a[32:35], v[164:167], v[64:79]
    ds_read_b64_tr_b16 a[8:9], v10 offset:6208
    ds_read_b64_tr_b16 a[10:11], v10 offset:6976
    v_fma_f32 v23, v23, v16, v18
    v_cvt_pk_bf16_f32 v168, v20, v21
    v_cvt_pk_bf16_f32 v169, v22, v23
    s_waitcnt lgkmcnt(6)
    v_mfma_f32_32x32x16_bf16 v[80:95], a[36:39], v[164:167], v[80:95]
    ds_read_b64_tr_b16 a[12:13], v10 offset:6240
    ds_read_b64_tr_b16 a[14:15], v10 offset:7008
    v_lshlrev_b32 v24, 16, v170
    v_and_b32 v25, 0xffff0000, v170
    v_lshlrev_b32 v26, 16, v171
    s_add_u32 m0, s69, 0
    s_add_u32 s71, s68, 1056768
    buffer_load_dwordx4 v2, s[16:19], s71 offen offset:0 lds
    v_mfma_f32_32x32x16_bf16 v[96:111], a[40:43], v[164:167], v[96:111]
    ds_read_b64_tr_b16 a[16:17], v10 offset:6272
    ds_read_b64_tr_b16 a[18:19], v10 offset:7040
    v_and_b32 v27, 0xffff0000, v171
    v_fma_f32 v24, v24, v16, v18
    v_fma_f32 v25, v25, v16, v18
    v_fma_f32 v26, v26, v16, v18
    v_mfma_f32_32x32x16_bf16 v[112:127], a[44:47], v[164:167], v[112:127]
    ds_read_b64_tr_b16 a[20:21], v11 offset:6304
    ds_read_b64_tr_b16 a[22:23], v11 offset:7072
    v_fma_f32 v27, v27, v16, v18
    v_cvt_pk_bf16_f32 v170, v24, v25
    v_cvt_pk_bf16_f32 v171, v26, v27
    buffer_load_dwordx4 v3, s[16:19], s71 offen offset:1024 lds
    s_waitcnt vmcnt(20)
    s_waitcnt lgkmcnt(6)
    v_mfma_f32_32x32x16_bf16 v[32:47], a[0:3], v[168:171], v[32:47]
    ds_read_b64_tr_b16 a[24:25], v10 offset:9216
    ds_read_b64_tr_b16 a[26:27], v10 offset:9984
    v_lshlrev_b32 v20, 16, v172
    v_and_b32 v21, 0xffff0000, v172
    v_lshlrev_b32 v22, 16, v173
    v_mfma_f32_32x32x16_bf16 v[48:63], a[4:7], v[168:171], v[48:63]
    ds_read_b64_tr_b16 a[28:29], v10 offset:9248
    ds_read_b64_tr_b16 a[30:31], v10 offset:10016
    v_and_b32 v23, 0xffff0000, v173
    v_fma_f32 v20, v20, v16, v18
    v_fma_f32 v21, v21, v16, v18
    v_fma_f32 v22, v22, v16, v18
    s_add_u32 s3, s30, 18432
    buffer_load_dwordx4 v[200:203], v9, s[8:11], s3 offen sc1
    v_mfma_f32_32x32x16_bf16 v[64:79], a[8:11], v[168:171], v[64:79]
    ds_read_b64_tr_b16 a[32:33], v10 offset:9280
    ds_read_b64_tr_b16 a[34:35], v10 offset:10048
    v_fma_f32 v23, v23, v16, v18
    v_cvt_pk_bf16_f32 v172, v20, v21
    v_cvt_pk_bf16_f32 v173, v22, v23
    s_waitcnt lgkmcnt(6)
    v_mfma_f32_32x32x16_bf16 v[80:95], a[12:15], v[168:171], v[80:95]
    ds_read_b64_tr_b16 a[36:37], v10 offset:9312
    ds_read_b64_tr_b16 a[38:39], v10 offset:10080
    v_lshlrev_b32 v24, 16, v174
    v_and_b32 v25, 0xffff0000, v174
    v_lshlrev_b32 v26, 16, v175
    buffer_load_dwordx4 v4, s[16:19], s71 offen offset:2048 lds
    v_mfma_f32_32x32x16_bf16 v[96:111], a[16:19], v[168:171], v[96:111]
    ds_read_b64_tr_b16 a[40:41], v10 offset:9344
    ds_read_b64_tr_b16 a[42:43], v10 offset:10112
    v_and_b32 v27, 0xffff0000, v175
    v_fma_f32 v24, v24, v16, v18
    v_fma_f32 v25, v25, v16, v18
    v_fma_f32 v26, v26, v16, v18
    v_mfma_f32_32x32x16_bf16 v[112:127], a[20:23], v[168:171], v[112:127]
    ds_read_b64_tr_b16 a[44:45], v11 offset:9376
    ds_read_b64_tr_b16 a[46:47], v11 offset:10144
    v_fma_f32 v27, v27, v16, v18
    v_cvt_pk_bf16_f32 v174, v24, v25
    v_cvt_pk_bf16_f32 v175, v26, v27
    s_add_u32 m0, s69, 12288
    s_nop 0
    buffer_load_dwordx4 v5, s[20:23], s71 offen offset:0 lds
    v_add_u32 v10, 73728, v28
    v_add_u32 v11, 73728, v29
    s_waitcnt vmcnt(20)
    s_waitcnt lgkmcnt(6)
    v_mfma_f32_32x32x16_bf16 v[32:47], a[24:27], v[172:175], v[32:47]
    ds_read_b64_tr_b16 a[0:1], v10 offset:0
    ds_read_b64_tr_b16 a[2:3], v10 offset:768
    v_lshlrev_b32 v20, 16, v176
    v_and_b32 v21, 0xffff0000, v176
    v_lshlrev_b32 v22, 16, v177
    v_mfma_f32_32x32x16_bf16 v[48:63], a[28:31], v[172:175], v[48:63]
    ds_read_b64_tr_b16 a[4:5], v10 offset:32
    ds_read_b64_tr_b16 a[6:7], v10 offset:800
    v_and_b32 v23, 0xffff0000, v177
    v_fma_f32 v20, v20, v16, v18
    v_fma_f32 v21, v21, v16, v18
    v_fma_f32 v22, v22, v16, v18
    s_add_u32 s3, s30, 19456
    buffer_load_dwordx4 v[204:207], v9, s[8:11], s3 offen sc1
    v_mfma_f32_32x32x16_bf16 v[64:79], a[32:35], v[172:175], v[64:79]
    ds_read_b64_tr_b16 a[8:9], v10 offset:64
    ds_read_b64_tr_b16 a[10:11], v10 offset:832
    v_fma_f32 v23, v23, v16, v18
    v_cvt_pk_bf16_f32 v176, v20, v21
    v_cvt_pk_bf16_f32 v177, v22, v23
    s_waitcnt lgkmcnt(6)
    v_mfma_f32_32x32x16_bf16 v[80:95], a[36:39], v[172:175], v[80:95]
    ds_read_b64_tr_b16 a[12:13], v10 offset:96
    ds_read_b64_tr_b16 a[14:15], v10 offset:864
    v_lshlrev_b32 v24, 16, v178
    v_and_b32 v25, 0xffff0000, v178
    v_lshlrev_b32 v26, 16, v179
    buffer_load_dwordx4 v6, s[20:23], s71 offen offset:1024 lds
    v_mfma_f32_32x32x16_bf16 v[96:111], a[40:43], v[172:175], v[96:111]
    ds_read_b64_tr_b16 a[16:17], v10 offset:128
    ds_read_b64_tr_b16 a[18:19], v10 offset:896
    v_and_b32 v27, 0xffff0000, v179
    v_fma_f32 v24, v24, v16, v18
    v_fma_f32 v25, v25, v16, v18
    v_fma_f32 v26, v26, v16, v18
    v_mfma_f32_32x32x16_bf16 v[112:127], a[44:47], v[172:175], v[112:127]
    ds_read_b64_tr_b16 a[20:21], v11 offset:160
    ds_read_b64_tr_b16 a[22:23], v11 offset:928
    v_fma_f32 v27, v27, v16, v18
    v_cvt_pk_bf16_f32 v178, v24, v25
    v_cvt_pk_bf16_f32 v179, v26, v27
    buffer_load_dwordx4 v7, s[20:23], s71 offen offset:2048 lds
    s_waitcnt vmcnt(20)
    s_waitcnt lgkmcnt(6)
    v_mfma_f32_32x32x16_bf16 v[32:47], a[0:3], v[176:179], v[32:47]
    ds_read_b64_tr_b16 a[24:25], v10 offset:3072
    ds_read_b64_tr_b16 a[26:27], v10 offset:3840
    v_lshlrev_b32 v20, 16, v180
    v_and_b32 v21, 0xffff0000, v180
    v_lshlrev_b32 v22, 16, v181
    v_mfma_f32_32x32x16_bf16 v[48:63], a[4:7], v[176:179], v[48:63]
    ds_read_b64_tr_b16 a[28:29], v10 offset:3104
    ds_read_b64_tr_b16 a[30:31], v10 offset:3872
    v_and_b32 v23, 0xffff0000, v181
    v_fma_f32 v20, v20, v16, v18
    v_fma_f32 v21, v21, v16, v18
    v_fma_f32 v22, v22, v16, v18
    s_add_u32 s3, s30, 20480
    buffer_load_dwordx4 v[208:211], v9, s[8:11], s3 offen sc1
    v_mfma_f32_32x32x16_bf16 v[64:79], a[8:11], v[176:179], v[64:79]
    ds_read_b64_tr_b16 a[32:33], v10 offset:3136
    ds_read_b64_tr_b16 a[34:35], v10 offset:3904
    v_fma_f32 v23, v23, v16, v18
    v_cvt_pk_bf16_f32 v180, v20, v21
    v_cvt_pk_bf16_f32 v181, v22, v23
    s_waitcnt lgkmcnt(6)
    v_mfma_f32_32x32x16_bf16 v[80:95], a[12:15], v[176:179], v[80:95]
    ds_read_b64_tr_b16 a[36:37], v10 offset:3168
    ds_read_b64_tr_b16 a[38:39], v10 offset:3936
    v_lshlrev_b32 v24, 16, v182
    v_and_b32 v25, 0xffff0000, v182
    v_lshlrev_b32 v26, 16, v183
    s_add_u32 m0, s69, 24576
    s_add_u32 s71, s68, 1232896
    buffer_load_dwordx4 v2, s[16:19], s71 offen offset:0 lds
    v_mfma_f32_32x32x16_bf16 v[96:111], a[16:19], v[176:179], v[96:111]
    ds_read_b64_tr_b16 a[40:41], v10 offset:3200
    ds_read_b64_tr_b16 a[42:43], v10 offset:3968
    v_and_b32 v27, 0xffff0000, v183
    v_fma_f32 v24, v24, v16, v18
    v_fma_f32 v25, v25, v16, v18
    v_fma_f32 v26, v26, v16, v18
    v_mfma_f32_32x32x16_bf16 v[112:127], a[20:23], v[176:179], v[112:127]
    ds_read_b64_tr_b16 a[44:45], v11 offset:3232
    ds_read_b64_tr_b16 a[46:47], v11 offset:4000
    v_fma_f32 v27, v27, v16, v18
    v_cvt_pk_bf16_f32 v182, v24, v25
    v_cvt_pk_bf16_f32 v183, v26, v27
    buffer_load_dwordx4 v3, s[16:19], s71 offen offset:1024 lds
    s_waitcnt vmcnt(20)
    s_waitcnt lgkmcnt(6)
    v_mfma_f32_32x32x16_bf16 v[32:47], a[24:27], v[180:183], v[32:47]
    ds_read_b64_tr_b16 a[0:1], v10 offset:6144
    ds_read_b64_tr_b16 a[2:3], v10 offset:6912
    v_lshlrev_b32 v20, 16, v184
    v_and_b32 v21, 0xffff0000, v184
    v_lshlrev_b32 v22, 16, v185
    v_mfma_f32_32x32x16_bf16 v[48:63], a[28:31], v[180:183], v[48:63]
    ds_read_b64_tr_b16 a[4:5], v10 offset:6176
    ds_read_b64_tr_b16 a[6:7], v10 offset:6944
    v_and_b32 v23, 0xffff0000, v185
    v_fma_f32 v20, v20, v16, v18
    v_fma_f32 v21, v21, v16, v18
    v_fma_f32 v22, v22, v16, v18
    s_add_u32 s3, s30, 21504
    buffer_load_dwordx4 v[212:215], v9, s[8:11], s3 offen sc1
    v_mfma_f32_32x32x16_bf16 v[64:79], a[32:35], v[180:183], v[64:79]
    ds_read_b64_tr_b16 a[8:9], v10 offset:6208
    ds_read_b64_tr_b16 a[10:11], v10 offset:6976
    v_fma_f32 v23, v23, v16, v18
    v_cvt_pk_bf16_f32 v184, v20, v21
    v_cvt_pk_bf16_f32 v185, v22, v23
    s_waitcnt lgkmcnt(6)
    v_mfma_f32_32x32x16_bf16 v[80:95], a[36:39], v[180:183], v[80:95]
    ds_read_b64_tr_b16 a[12:13], v10 offset:6240
    ds_read_b64_tr_b16 a[14:15], v10 offset:7008
    v_lshlrev_b32 v24, 16, v186
    v_and_b32 v25, 0xffff0000, v186
    v_lshlrev_b32 v26, 16, v187
    buffer_load_dwordx4 v4, s[16:19], s71 offen offset:2048 lds
    v_mfma_f32_32x32x16_bf16 v[96:111], a[40:43], v[180:183], v[96:111]
    ds_read_b64_tr_b16 a[16:17], v10 offset:6272
    ds_read_b64_tr_b16 a[18:19], v10 offset:7040
    v_and_b32 v27, 0xffff0000, v187
    v_fma_f32 v24, v24, v16, v18
    v_fma_f32 v25, v25, v16, v18
    v_fma_f32 v26, v26, v16, v18
    v_mfma_f32_32x32x16_bf16 v[112:127], a[44:47], v[180:183], v[112:127]
    ds_read_b64_tr_b16 a[20:21], v11 offset:6304
    ds_read_b64_tr_b16 a[22:23], v11 offset:7072
    v_fma_f32 v27, v27, v16, v18
    v_cvt_pk_bf16_f32 v186, v24, v25
    v_cvt_pk_bf16_f32 v187, v26, v27
    s_add_u32 m0, s69, 36864
    s_nop 0
    buffer_load_dwordx4 v5, s[20:23], s71 offen offset:0 lds
    s_waitcnt vmcnt(15)
    s_barrier
    s_waitcnt vmcnt(20)
    s_waitcnt lgkmcnt(6)
    v_mfma_f32_32x32x16_bf16 v[32:47], a[0:3], v[184:187], v[32:47]
    ds_read_b64_tr_b16 a[24:25], v10 offset:9216
    ds_read_b64_tr_b16 a[26:27], v10 offset:9984
    v_lshlrev_b32 v20, 16, v188
    v_and_b32 v21, 0xffff0000, v188
    v_lshlrev_b32 v22, 16, v189
    v_mfma_f32_32x32x16_bf16 v[48:63], a[4:7], v[184:187], v[48:63]
    ds_read_b64_tr_b16 a[28:29], v10 offset:9248
    ds_read_b64_tr_b16 a[30:31], v10 offset:10016
    v_and_b32 v23, 0xffff0000, v189
    v_fma_f32 v20, v20, v16, v18
    v_fma_f32 v21, v21, v16, v18
    v_fma_f32 v22, v22, v16, v18
    s_add_u32 s3, s30, 22528
    buffer_load_dwordx4 v[216:219], v9, s[8:11], s3 offen sc1
    v_mfma_f32_32x32x16_bf16 v[64:79], a[8:11], v[184:187], v[64:79]
    ds_read_b64_tr_b16 a[32:33], v10 offset:9280
    ds_read_b64_tr_b16 a[34:35], v10 offset:10048
    v_fma_f32 v23, v23, v16, v18
    v_cvt_pk_bf16_f32 v188, v20, v21
    v_cvt_pk_bf16_f32 v189, v22, v23
    s_waitcnt lgkmcnt(6)
    v_mfma_f32_32x32x16_bf16 v[80:95], a[12:15], v[184:187], v[80:95]
    ds_read_b64_tr_b16 a[36:37], v10 offset:9312
    ds_read_b64_tr_b16 a[38:39], v10 offset:10080
    v_lshlrev_b32 v24, 16, v190
    v_and_b32 v25, 0xffff0000, v190
    v_lshlrev_b32 v26, 16, v191
    buffer_load_dwordx4 v6, s[20:23], s71 offen offset:1024 lds
    v_mfma_f32_32x32x16_bf16 v[96:111], a[16:19], v[184:187], v[96:111]
    ds_read_b64_tr_b16 a[40:41], v10 offset:9344
    ds_read_b64_tr_b16 a[42:43], v10 offset:10112
    v_and_b32 v27, 0xffff0000, v191
    v_fma_f32 v24, v24, v16, v18
    v_fma_f32 v25, v25, v16, v18
    v_fma_f32 v26, v26, v16, v18
    v_mfma_f32_32x32x16_bf16 v[112:127], a[20:23], v[184:187], v[112:127]
    ds_read_b64_tr_b16 a[44:45], v11 offset:9376
    ds_read_b64_tr_b16 a[46:47], v11 offset:10144
    v_fma_f32 v27, v27, v16, v18
    v_cvt_pk_bf16_f32 v190, v24, v25
    v_cvt_pk_bf16_f32 v191, v26, v27
    buffer_load_dwordx4 v7, s[20:23], s71 offen offset:2048 lds
    v_add_u32 v10, 98304, v28
    v_add_u32 v11, 98304, v29
    s_waitcnt vmcnt(20)
    s_waitcnt lgkmcnt(6)
    v_mfma_f32_32x32x16_bf16 v[32:47], a[24:27], v[188:191], v[32:47]
    ds_read_b64_tr_b16 a[0:1], v10 offset:0
    ds_read_b64_tr_b16 a[2:3], v10 offset:768
    v_lshlrev_b32 v20, 16, v192
    v_and_b32 v21, 0xffff0000, v192
    v_lshlrev_b32 v22, 16, v193
    v_mfma_f32_32x32x16_bf16 v[48:63], a[28:31], v[188:191], v[48:63]
    ds_read_b64_tr_b16 a[4:5], v10 offset:32
    ds_read_b64_tr_b16 a[6:7], v10 offset:800
    v_and_b32 v23, 0xffff0000, v193
    v_fma_f32 v20, v20, v16, v18
    v_fma_f32 v21, v21, v16, v18
    v_fma_f32 v22, v22, v16, v18
    s_add_u32 s3, s30, 23552
    buffer_load_dwordx4 v[220:223], v9, s[8:11], s3 offen sc1
    v_mfma_f32_32x32x16_bf16 v[64:79], a[32:35], v[188:191], v[64:79]
    ds_read_b64_tr_b16 a[8:9], v10 offset:64
    ds_read_b64_tr_b16 a[10:11], v10 offset:832
    v_fma_f32 v23, v23, v16, v18
    v_cvt_pk_bf16_f32 v192, v20, v21
    v_cvt_pk_bf16_f32 v193, v22, v23
    s_waitcnt lgkmcnt(6)
    v_mfma_f32_32x32x16_bf16 v[80:95], a[36:39], v[188:191], v[80:95]
    ds_read_b64_tr_b16 a[12:13], v10 offset:96
    ds_read_b64_tr_b16 a[14:15], v10 offset:864
    v_lshlrev_b32 v24, 16, v194
    v_and_b32 v25, 0xffff0000, v194
    v_lshlrev_b32 v26, 16, v195
    v_mfma_f32_32x32x16_bf16 v[96:111], a[40:43], v[188:191], v[96:111]
    ds_read_b64_tr_b16 a[16:17], v10 offset:128
    ds_read_b64_tr_b16 a[18:19], v10 offset:896
    v_and_b32 v27, 0xffff0000, v195
    v_fma_f32 v24, v24, v16, v18
    v_fma_f32 v25, v25, v16, v18
    v_fma_f32 v26, v26, v16, v18
    v_mfma_f32_32x32x16_bf16 v[112:127], a[44:47], v[188:191], v[112:127]
    ds_read_b64_tr_b16 a[20:21], v11 offset:160
    ds_read_b64_tr_b16 a[22:23], v11 offset:928
    v_fma_f32 v27, v27, v16, v18
    v_cvt_pk_bf16_f32 v194, v24, v25
    v_cvt_pk_bf16_f32 v195, v26, v27
    v_mov_b32 v4, v1
    v_add_u32 v5, 7168, v1
    v_add_u32 v6, 14336, v1
    v_add_u32 v7, 21504, v1
    s_waitcnt vmcnt(18)
    s_waitcnt lgkmcnt(6)
    v_mfma_f32_32x32x16_bf16 v[32:47], a[0:3], v[192:195], v[32:47]
    ds_read_b64_tr_b16 a[24:25], v10 offset:3072
    ds_read_b64_tr_b16 a[26:27], v10 offset:3840
    v_lshlrev_b32 v20, 16, v196
    v_and_b32 v21, 0xffff0000, v196
    v_lshlrev_b32 v22, 16, v197
    v_mfma_f32_32x32x16_bf16 v[48:63], a[4:7], v[192:195], v[48:63]
    ds_read_b64_tr_b16 a[28:29], v10 offset:3104
    ds_read_b64_tr_b16 a[30:31], v10 offset:3872
    v_and_b32 v23, 0xffff0000, v197
    v_fma_f32 v20, v20, v16, v18
    v_fma_f32 v21, v21, v16, v18
    v_fma_f32 v22, v22, v16, v18
    s_add_u32 s3, s30, 24576
    buffer_load_dwordx4 v[224:227], v9, s[8:11], s3 offen sc1
    v_mfma_f32_32x32x16_bf16 v[64:79], a[8:11], v[192:195], v[64:79]
    ds_read_b64_tr_b16 a[32:33], v10 offset:3136
    ds_read_b64_tr_b16 a[34:35], v10 offset:3904
    v_fma_f32 v23, v23, v16, v18
    v_cvt_pk_bf16_f32 v196, v20, v21
    v_cvt_pk_bf16_f32 v197, v22, v23
    s_waitcnt lgkmcnt(6)
    v_mfma_f32_32x32x16_bf16 v[80:95], a[12:15], v[192:195], v[80:95]
    ds_read_b64_tr_b16 a[36:37], v10 offset:3168
    ds_read_b64_tr_b16 a[38:39], v10 offset:3936
    v_lshlrev_b32 v24, 16, v198
    v_and_b32 v25, 0xffff0000, v198
    v_lshlrev_b32 v26, 16, v199
    s_add_u32 m0, s74, 147456
    s_add_u32 s76, s77, 1228800
    buffer_load_dwordx4 v4, s[24:27], s76 offen offset:0 lds
    v_mfma_f32_32x32x16_bf16 v[96:111], a[16:19], v[192:195], v[96:111]
    ds_read_b64_tr_b16 a[40:41], v10 offset:3200
    ds_read_b64_tr_b16 a[42:43], v10 offset:3968
    v_and_b32 v27, 0xffff0000, v199
    v_fma_f32 v24, v24, v16, v18
    v_fma_f32 v25, v25, v16, v18
    v_fma_f32 v26, v26, v16, v18
    v_mfma_f32_32x32x16_bf16 v[112:127], a[20:23], v[192:195], v[112:127]
    ds_read_b64_tr_b16 a[44:45], v11 offset:3232
    ds_read_b64_tr_b16 a[46:47], v11 offset:4000
    v_fma_f32 v27, v27, v16, v18
    v_cvt_pk_bf16_f32 v198, v24, v25
    v_cvt_pk_bf16_f32 v199, v26, v27
    s_waitcnt vmcnt(17)
    s_waitcnt lgkmcnt(6)
    v_mfma_f32_32x32x16_bf16 v[32:47], a[24:27], v[196:199], v[32:47]
    ds_read_b64_tr_b16 a[0:1], v10 offset:6144
    ds_read_b64_tr_b16 a[2:3], v10 offset:6912
    v_lshlrev_b32 v20, 16, v200
    v_and_b32 v21, 0xffff0000, v200
    v_lshlrev_b32 v22, 16, v201
    v_mfma_f32_32x32x16_bf16 v[48:63], a[28:31], v[196:199], v[48:63]
    ds_read_b64_tr_b16 a[4:5], v10 offset:6176
    ds_read_b64_tr_b16 a[6:7], v10 offset:6944
    v_and_b32 v23, 0xffff0000, v201
    v_fma_f32 v20, v20, v16, v18
    v_fma_f32 v21, v21, v16, v18
    v_fma_f32 v22, v22, v16, v18
    s_add_u32 s3, s30, 25600
    buffer_load_dwordx4 v[228:231], v9, s[8:11], s3 offen sc1
    v_mfma_f32_32x32x16_bf16 v[64:79], a[32:35], v[196:199], v[64:79]
    ds_read_b64_tr_b16 a[8:9], v10 offset:6208
    ds_read_b64_tr_b16 a[10:11], v10 offset:6976
    v_fma_f32 v23, v23, v16, v18
    v_cvt_pk_bf16_f32 v200, v20, v21
    v_cvt_pk_bf16_f32 v201, v22, v23
    s_waitcnt lgkmcnt(6)
    v_mfma_f32_32x32x16_bf16 v[80:95], a[36:39], v[196:199], v[80:95]
    ds_read_b64_tr_b16 a[12:13], v10 offset:6240
    ds_read_b64_tr_b16 a[14:15], v10 offset:7008
    v_lshlrev_b32 v24, 16, v202
    v_and_b32 v25, 0xffff0000, v202
    v_lshlrev_b32 v26, 16, v203
    buffer_load_dwordx4 v5, s[24:27], s76 offen offset:1024 lds
    v_mfma_f32_32x32x16_bf16 v[96:111], a[40:43], v[196:199], v[96:111]
    ds_read_b64_tr_b16 a[16:17], v10 offset:6272
    ds_read_b64_tr_b16 a[18:19], v10 offset:7040
    v_and_b32 v27, 0xffff0000, v203
    v_fma_f32 v24, v24, v16, v18
    v_fma_f32 v25, v25, v16, v18
    v_fma_f32 v26, v26, v16, v18
    v_mfma_f32_32x32x16_bf16 v[112:127], a[44:47], v[196:199], v[112:127]
    ds_read_b64_tr_b16 a[20:21], v11 offset:6304
    ds_read_b64_tr_b16 a[22:23], v11 offset:7072
    v_fma_f32 v27, v27, v16, v18
    v_cvt_pk_bf16_f32 v202, v24, v25
    v_cvt_pk_bf16_f32 v203, v26, v27
    s_waitcnt vmcnt(16)
    s_waitcnt lgkmcnt(6)
    v_mfma_f32_32x32x16_bf16 v[32:47], a[0:3], v[200:203], v[32:47]
    ds_read_b64_tr_b16 a[24:25], v10 offset:9216
    ds_read_b64_tr_b16 a[26:27], v10 offset:9984
    v_lshlrev_b32 v20, 16, v204
    v_and_b32 v21, 0xffff0000, v204
    v_lshlrev_b32 v22, 16, v205
    v_mfma_f32_32x32x16_bf16 v[48:63], a[4:7], v[200:203], v[48:63]
    ds_read_b64_tr_b16 a[28:29], v10 offset:9248
    ds_read_b64_tr_b16 a[30:31], v10 offset:10016
    v_and_b32 v23, 0xffff0000, v205
    v_fma_f32 v20, v20, v16, v18
    v_fma_f32 v21, v21, v16, v18
    v_fma_f32 v22, v22, v16, v18
    s_add_u32 s3, s30, 26624
    buffer_load_dwordx4 v[232:235], v9, s[8:11], s3 offen sc1
    v_mfma_f32_32x32x16_bf16 v[64:79], a[8:11], v[200:203], v[64:79]
    ds_read_b64_tr_b16 a[32:33], v10 offset:9280
    ds_read_b64_tr_b16 a[34:35], v10 offset:10048
    v_fma_f32 v23, v23, v16, v18
    v_cvt_pk_bf16_f32 v204, v20, v21
    v_cvt_pk_bf16_f32 v205, v22, v23
    s_waitcnt lgkmcnt(6)
    v_mfma_f32_32x32x16_bf16 v[80:95], a[12:15], v[200:203], v[80:95]
    ds_read_b64_tr_b16 a[36:37], v10 offset:9312
    ds_read_b64_tr_b16 a[38:39], v10 offset:10080
    v_lshlrev_b32 v24, 16, v206
    v_and_b32 v25, 0xffff0000, v206
    v_lshlrev_b32 v26, 16, v207
    buffer_load_dwordx4 v6, s[24:27], s76 offen offset:2048 lds
    v_mfma_f32_32x32x16_bf16 v[96:111], a[16:19], v[200:203], v[96:111]
    ds_read_b64_tr_b16 a[40:41], v10 offset:9344
    ds_read_b64_tr_b16 a[42:43], v10 offset:10112
    v_and_b32 v27, 0xffff0000, v207
    v_fma_f32 v24, v24, v16, v18
    v_fma_f32 v25, v25, v16, v18
    v_fma_f32 v26, v26, v16, v18
    v_mfma_f32_32x32x16_bf16 v[112:127], a[20:23], v[200:203], v[112:127]
    ds_read_b64_tr_b16 a[44:45], v11 offset:9376
    ds_read_b64_tr_b16 a[46:47], v11 offset:10144
    v_fma_f32 v27, v27, v16, v18
    v_cvt_pk_bf16_f32 v206, v24, v25
    v_cvt_pk_bf16_f32 v207, v26, v27
    v_add_u32 v10, 122880, v28
    v_add_u32 v11, 122880, v29
    s_waitcnt vmcnt(15)
    s_waitcnt lgkmcnt(6)
    v_mfma_f32_32x32x16_bf16 v[32:47], a[24:27], v[204:207], v[32:47]
    ds_read_b64_tr_b16 a[0:1], v10 offset:0
    ds_read_b64_tr_b16 a[2:3], v10 offset:768
    v_lshlrev_b32 v20, 16, v208
    v_and_b32 v21, 0xffff0000, v208
    v_lshlrev_b32 v22, 16, v209
    v_mfma_f32_32x32x16_bf16 v[48:63], a[28:31], v[204:207], v[48:63]
    ds_read_b64_tr_b16 a[4:5], v10 offset:32
    ds_read_b64_tr_b16 a[6:7], v10 offset:800
    v_and_b32 v23, 0xffff0000, v209
    v_fma_f32 v20, v20, v16, v18
    v_fma_f32 v21, v21, v16, v18
    v_fma_f32 v22, v22, v16, v18
    s_add_u32 s3, s30, 27648
    buffer_load_dwordx4 v[236:239], v9, s[8:11], s3 offen sc1
    v_mfma_f32_32x32x16_bf16 v[64:79], a[32:35], v[204:207], v[64:79]
    ds_read_b64_tr_b16 a[8:9], v10 offset:64
    ds_read_b64_tr_b16 a[10:11], v10 offset:832
    v_fma_f32 v23, v23, v16, v18
    v_cvt_pk_bf16_f32 v208, v20, v21
    v_cvt_pk_bf16_f32 v209, v22, v23
    s_waitcnt lgkmcnt(6)
    v_mfma_f32_32x32x16_bf16 v[80:95], a[36:39], v[204:207], v[80:95]
    ds_read_b64_tr_b16 a[12:13], v10 offset:96
    ds_read_b64_tr_b16 a[14:15], v10 offset:864
    v_lshlrev_b32 v24, 16, v210
    v_and_b32 v25, 0xffff0000, v210
    v_lshlrev_b32 v26, 16, v211
    buffer_load_dwordx4 v7, s[24:27], s76 offen offset:3072 lds
    v_mfma_f32_32x32x16_bf16 v[96:111], a[40:43], v[204:207], v[96:111]
    ds_read_b64_tr_b16 a[16:17], v10 offset:128
    ds_read_b64_tr_b16 a[18:19], v10 offset:896
    v_and_b32 v27, 0xffff0000, v211
    v_fma_f32 v24, v24, v16, v18
    v_fma_f32 v25, v25, v16, v18
    v_fma_f32 v26, v26, v16, v18
    v_mfma_f32_32x32x16_bf16 v[112:127], a[44:47], v[204:207], v[112:127]
    ds_read_b64_tr_b16 a[20:21], v11 offset:160
    ds_read_b64_tr_b16 a[22:23], v11 offset:928
    v_fma_f32 v27, v27, v16, v18
    v_cvt_pk_bf16_f32 v210, v24, v25
    v_cvt_pk_bf16_f32 v211, v26, v27
    s_waitcnt vmcnt(9)
    s_barrier
    s_waitcnt vmcnt(14)
    s_waitcnt lgkmcnt(6)
    v_mfma_f32_32x32x16_bf16 v[32:47], a[0:3], v[208:211], v[32:47]
    ds_read_b64_tr_b16 a[24:25], v10 offset:3072
    ds_read_b64_tr_b16 a[26:27], v10 offset:3840
    v_lshlrev_b32 v20, 16, v212
    v_and_b32 v21, 0xffff0000, v212
    v_lshlrev_b32 v22, 16, v213
    v_mfma_f32_32x32x16_bf16 v[48:63], a[4:7], v[208:211], v[48:63]
    ds_read_b64_tr_b16 a[28:29], v10 offset:3104
    ds_read_b64_tr_b16 a[30:31], v10 offset:3872
    v_and_b32 v23, 0xffff0000, v213
    v_fma_f32 v20, v20, v16, v18
    v_fma_f32 v21, v21, v16, v18
    v_fma_f32 v22, v22, v16, v18
    s_add_u32 s3, s30, 28672
    buffer_load_dwordx4 v[240:243], v9, s[8:11], s3 offen sc1
    v_mfma_f32_32x32x16_bf16 v[64:79], a[8:11], v[208:211], v[64:79]
    ds_read_b64_tr_b16 a[32:33], v10 offset:3136
    ds_read_b64_tr_b16 a[34:35], v10 offset:3904
    v_fma_f32 v23, v23, v16, v18
    v_cvt_pk_bf16_f32 v212, v20, v21
    v_cvt_pk_bf16_f32 v213, v22, v23
    s_waitcnt lgkmcnt(6)
    v_mfma_f32_32x32x16_bf16 v[80:95], a[12:15], v[208:211], v[80:95]
    ds_read_b64_tr_b16 a[36:37], v10 offset:3168
    ds_read_b64_tr_b16 a[38:39], v10 offset:3936
    v_lshlrev_b32 v24, 16, v214
    v_and_b32 v25, 0xffff0000, v214
    v_lshlrev_b32 v26, 16, v215
    s_add_u32 m0, s74, 49152
    s_add_u32 s76, s77, 393216
    buffer_load_dwordx4 v4, s[24:27], s76 offen offset:0 lds
    v_mfma_f32_32x32x16_bf16 v[96:111], a[16:19], v[208:211], v[96:111]
    ds_read_b64_tr_b16 a[40:41], v10 offset:3200
    ds_read_b64_tr_b16 a[42:43], v10 offset:3968
    v_and_b32 v27, 0xffff0000, v215
    v_fma_f32 v24, v24, v16, v18
    v_fma_f32 v25, v25, v16, v18
    v_fma_f32 v26, v26, v16, v18
    v_mfma_f32_32x32x16_bf16 v[112:127], a[20:23], v[208:211], v[112:127]
    ds_read_b64_tr_b16 a[44:45], v11 offset:3232
    ds_read_b64_tr_b16 a[46:47], v11 offset:4000
    v_fma_f32 v27, v27, v16, v18
    v_cvt_pk_bf16_f32 v214, v24, v25
    v_cvt_pk_bf16_f32 v215, v26, v27
    buffer_load_dwordx4 v5, s[24:27], s76 offen offset:1024 lds
    s_waitcnt vmcnt(14)
    s_waitcnt lgkmcnt(6)
    v_mfma_f32_32x32x16_bf16 v[32:47], a[24:27], v[212:215], v[32:47]
    ds_read_b64_tr_b16 a[0:1], v10 offset:6144
    ds_read_b64_tr_b16 a[2:3], v10 offset:6912
    v_lshlrev_b32 v20, 16, v216
    v_and_b32 v21, 0xffff0000, v216
    v_lshlrev_b32 v22, 16, v217
    v_mfma_f32_32x32x16_bf16 v[48:63], a[28:31], v[212:215], v[48:63]
    ds_read_b64_tr_b16 a[4:5], v10 offset:6176
    ds_read_b64_tr_b16 a[6:7], v10 offset:6944
    v_and_b32 v23, 0xffff0000, v217
    v_fma_f32 v20, v20, v16, v18
    v_fma_f32 v21, v21, v16, v18
    v_fma_f32 v22, v22, v16, v18
    s_add_u32 s3, s30, 29696
    buffer_load_dwordx4 v[244:247], v9, s[8:11], s3 offen sc1
    v_mfma_f32_32x32x16_bf16 v[64:79], a[32:35], v[212:215], v[64:79]
    ds_read_b64_tr_b16 a[8:9], v10 offset:6208
    ds_read_b64_tr_b16 a[10:11], v10 offset:6976
    v_fma_f32 v23, v23, v16, v18
    v_cvt_pk_bf16_f32 v216, v20, v21
    v_cvt_pk_bf16_f32 v217, v22, v23
    s_waitcnt lgkmcnt(6)
    v_mfma_f32_32x32x16_bf16 v[80:95], a[36:39], v[212:215], v[80:95]
    ds_read_b64_tr_b16 a[12:13], v10 offset:6240
    ds_read_b64_tr_b16 a[14:15], v10 offset:7008
    v_lshlrev_b32 v24, 16, v218
    v_and_b32 v25, 0xffff0000, v218
    v_lshlrev_b32 v26, 16, v219
    buffer_load_dwordx4 v6, s[24:27], s76 offen offset:2048 lds
    v_mfma_f32_32x32x16_bf16 v[96:111], a[40:43], v[212:215], v[96:111]
    ds_read_b64_tr_b16 a[16:17], v10 offset:6272
    ds_read_b64_tr_b16 a[18:19], v10 offset:7040
    v_and_b32 v27, 0xffff0000, v219
    v_fma_f32 v24, v24, v16, v18
    v_fma_f32 v25, v25, v16, v18
    v_fma_f32 v26, v26, v16, v18
    v_mfma_f32_32x32x16_bf16 v[112:127], a[44:47], v[212:215], v[112:127]
    ds_read_b64_tr_b16 a[20:21], v11 offset:6304
    ds_read_b64_tr_b16 a[22:23], v11 offset:7072
    v_fma_f32 v27, v27, v16, v18
    v_cvt_pk_bf16_f32 v218, v24, v25
    v_cvt_pk_bf16_f32 v219, v26, v27
    buffer_load_dwordx4 v7, s[24:27], s76 offen offset:3072 lds
    s_waitcnt vmcnt(14)
    s_waitcnt lgkmcnt(6)
    v_mfma_f32_32x32x16_bf16 v[32:47], a[0:3], v[216:219], v[32:47]
    ds_read_b64_tr_b16 a[24:25], v10 offset:9216
    ds_read_b64_tr_b16 a[26:27], v10 offset:9984
    v_lshlrev_b32 v20, 16, v220
    v_and_b32 v21, 0xffff0000, v220
    v_lshlrev_b32 v22, 16, v221
    v_mfma_f32_32x32x16_bf16 v[48:63], a[4:7], v[216:219], v[48:63]
    ds_read_b64_tr_b16 a[28:29], v10 offset:9248
    ds_read_b64_tr_b16 a[30:31], v10 offset:10016
    v_and_b32 v23, 0xffff0000, v221
    v_fma_f32 v20, v20, v16, v18
    v_fma_f32 v21, v21, v16, v18
    v_fma_f32 v22, v22, v16, v18
    s_add_u32 s3, s30, 30720
    buffer_load_dwordx4 v[248:251], v9, s[8:11], s3 offen sc1
    v_mfma_f32_32x32x16_bf16 v[64:79], a[8:11], v[216:219], v[64:79]
    ds_read_b64_tr_b16 a[32:33], v10 offset:9280
    ds_read_b64_tr_b16 a[34:35], v10 offset:10048
    v_fma_f32 v23, v23, v16, v18
    v_cvt_pk_bf16_f32 v220, v20, v21
    v_cvt_pk_bf16_f32 v221, v22, v23
    s_waitcnt lgkmcnt(6)
    v_mfma_f32_32x32x16_bf16 v[80:95], a[12:15], v[216:219], v[80:95]
    ds_read_b64_tr_b16 a[36:37], v10 offset:9312
    ds_read_b64_tr_b16 a[38:39], v10 offset:10080
    v_lshlrev_b32 v24, 16, v222
    v_and_b32 v25, 0xffff0000, v222
    v_lshlrev_b32 v26, 16, v223
    s_add_u32 m0, s74, 65536
    s_add_u32 s76, s77, 524288
    buffer_load_dwordx4 v4, s[24:27], s76 offen offset:0 lds
    v_mfma_f32_32x32x16_bf16 v[96:111], a[16:19], v[216:219], v[96:111]
    ds_read_b64_tr_b16 a[40:41], v10 offset:9344
    ds_read_b64_tr_b16 a[42:43], v10 offset:10112
    v_and_b32 v27, 0xffff0000, v223
    v_fma_f32 v24, v24, v16, v18
    v_fma_f32 v25, v25, v16, v18
    v_fma_f32 v26, v26, v16, v18
    v_mfma_f32_32x32x16_bf16 v[112:127], a[20:23], v[216:219], v[112:127]
    ds_read_b64_tr_b16 a[44:45], v11 offset:9376
    ds_read_b64_tr_b16 a[46:47], v11 offset:10144
    v_fma_f32 v27, v27, v16, v18
    v_cvt_pk_bf16_f32 v222, v24, v25
    v_cvt_pk_bf16_f32 v223, v26, v27
    buffer_load_dwordx4 v5, s[24:27], s76 offen offset:1024 lds
    v_add_u32 v10, 0, v28
    v_add_u32 v11, 0, v29
    s_waitcnt vmcnt(16)
    s_waitcnt lgkmcnt(6)
    v_mfma_f32_32x32x16_bf16 v[32:47], a[24:27], v[220:223], v[32:47]
    ds_read_b64_tr_b16 a[0:1], v10 offset:0
    ds_read_b64_tr_b16 a[2:3], v10 offset:768
    v_lshlrev_b32 v20, 16, v224
    v_and_b32 v21, 0xffff0000, v224
    v_lshlrev_b32 v22, 16, v225
    v_mfma_f32_32x32x16_bf16 v[48:63], a[28:31], v[220:223], v[48:63]
    ds_read_b64_tr_b16 a[4:5], v10 offset:32
    ds_read_b64_tr_b16 a[6:7], v10 offset:800
    v_and_b32 v23, 0xffff0000, v225
    v_fma_f32 v20, v20, v16, v18
    v_fma_f32 v21, v21, v16, v18
    v_fma_f32 v22, v22, v16, v18
    s_add_u32 s3, s30, 31744
    buffer_load_dwordx4 v[252:255], v9, s[8:11], s3 offen sc1
    v_mfma_f32_32x32x16_bf16 v[64:79], a[32:35], v[220:223], v[64:79]
    ds_read_b64_tr_b16 a[8:9], v10 offset:64
    ds_read_b64_tr_b16 a[10:11], v10 offset:832
    v_fma_f32 v23, v23, v16, v18
    v_cvt_pk_bf16_f32 v224, v20, v21
    v_cvt_pk_bf16_f32 v225, v22, v23
    s_waitcnt lgkmcnt(6)
    v_mfma_f32_32x32x16_bf16 v[80:95], a[36:39], v[220:223], v[80:95]
    ds_read_b64_tr_b16 a[12:13], v10 offset:96
    ds_read_b64_tr_b16 a[14:15], v10 offset:864
    v_lshlrev_b32 v24, 16, v226
    v_and_b32 v25, 0xffff0000, v226
    v_lshlrev_b32 v26, 16, v227
    buffer_load_dwordx4 v6, s[24:27], s76 offen offset:2048 lds
    v_mfma_f32_32x32x16_bf16 v[96:111], a[40:43], v[220:223], v[96:111]
    ds_read_b64_tr_b16 a[16:17], v10 offset:128
    ds_read_b64_tr_b16 a[18:19], v10 offset:896
    v_and_b32 v27, 0xffff0000, v227
    v_fma_f32 v24, v24, v16, v18
    v_fma_f32 v25, v25, v16, v18
    v_fma_f32 v26, v26, v16, v18
    v_mfma_f32_32x32x16_bf16 v[112:127], a[44:47], v[220:223], v[112:127]
    ds_read_b64_tr_b16 a[20:21], v11 offset:160
    ds_read_b64_tr_b16 a[22:23], v11 offset:928
    v_fma_f32 v27, v27, v16, v18
    v_cvt_pk_bf16_f32 v226, v24, v25
    v_cvt_pk_bf16_f32 v227, v26, v27
    buffer_load_dwordx4 v7, s[24:27], s76 offen offset:3072 lds
    s_barrier
    s_waitcnt vmcnt(17)
    s_waitcnt lgkmcnt(6)
    v_mfma_f32_32x32x16_bf16 v[32:47], a[0:3], v[224:227], v[32:47]
    ds_read_b64_tr_b16 a[24:25], v10 offset:3072
    ds_read_b64_tr_b16 a[26:27], v10 offset:3840
    v_lshlrev_b32 v20, 16, v228
    v_and_b32 v21, 0xffff0000, v228
    v_lshlrev_b32 v22, 16, v229
    v_mfma_f32_32x32x16_bf16 v[48:63], a[4:7], v[224:227], v[48:63]
    ds_read_b64_tr_b16 a[28:29], v10 offset:3104
    ds_read_b64_tr_b16 a[30:31], v10 offset:3872
    v_and_b32 v23, 0xffff0000, v229
    v_fma_f32 v20, v20, v16, v18
    v_fma_f32 v21, v21, v16, v18
    v_fma_f32 v22, v22, v16, v18
    v_mfma_f32_32x32x16_bf16 v[64:79], a[8:11], v[224:227], v[64:79]
    ds_read_b64_tr_b16 a[32:33], v10 offset:3136
    ds_read_b64_tr_b16 a[34:35], v10 offset:3904
    v_fma_f32 v23, v23, v16, v18
    v_cvt_pk_bf16_f32 v228, v20, v21
    v_cvt_pk_bf16_f32 v229, v22, v23
    s_waitcnt lgkmcnt(6)
    v_mfma_f32_32x32x16_bf16 v[80:95], a[12:15], v[224:227], v[80:95]
    ds_read_b64_tr_b16 a[36:37], v10 offset:3168
    ds_read_b64_tr_b16 a[38:39], v10 offset:3936
    v_lshlrev_b32 v24, 16, v230
    v_and_b32 v25, 0xffff0000, v230
    v_lshlrev_b32 v26, 16, v231
    s_add_u32 m0, s74, 81920
    s_add_u32 s76, s77, 704512
    buffer_load_dwordx4 v4, s[24:27], s76 offen offset:0 lds
    s_mul_i32 s3, s70, 86
    s_add_u32 s3, s3, s66
    s_lshl_b32 s3, s3, 10
    s_add_u32 s3, s3, 8388608
    v_lshlrev_b32 v13, 7, v0
    s_lshl_b32 s7, s67, 3
    s_bfm_b64 exec, s7, 0
    buffer_load_dword v15, v13, s[8:11], s3 offen
    s_mov_b64 exec, -1
    v_mfma_f32_32x32x16_bf16 v[96:111], a[16:19], v[224:227], v[96:111]
    ds_read_b64_tr_b16 a[40:41], v10 offset:3200
    ds_read_b64_tr_b16 a[42:43], v10 offset:3968
    v_and_b32 v27, 0xffff0000, v231
    v_fma_f32 v24, v24, v16, v18
    v_fma_f32 v25, v25, v16, v18
    v_fma_f32 v26, v26, v16, v18
    v_mfma_f32_32x32x16_bf16 v[112:127], a[20:23], v[224:227], v[112:127]
    ds_read_b64_tr_b16 a[44:45], v11 offset:3232
    ds_read_b64_tr_b16 a[46:47], v11 offset:4000
    v_fma_f32 v27, v27, v16, v18
    v_cvt_pk_bf16_f32 v230, v24, v25
    v_cvt_pk_bf16_f32 v231, v26, v27
    buffer_load_dwordx4 v5, s[24:27], s76 offen offset:1024 lds
    s_waitcnt vmcnt(18)
    s_waitcnt lgkmcnt(6)
    v_mfma_f32_32x32x16_bf16 v[32:47], a[24:27], v[228:231], v[32:47]
    ds_read_b64_tr_b16 a[0:1], v10 offset:6144
    ds_read_b64_tr_b16 a[2:3], v10 offset:6912
    v_lshlrev_b32 v20, 16, v232
    v_and_b32 v21, 0xffff0000, v232
    v_lshlrev_b32 v22, 16, v233
    v_mfma_f32_32x32x16_bf16 v[48:63], a[28:31], v[228:231], v[48:63]
    ds_read_b64_tr_b16 a[4:5], v10 offset:6176
    ds_read_b64_tr_b16 a[6:7], v10 offset:6944
    v_and_b32 v23, 0xffff0000, v233
    v_fma_f32 v20, v20, v16, v18
    v_fma_f32 v21, v21, v16, v18
    v_fma_f32 v22, v22, v16, v18
    v_mfma_f32_32x32x16_bf16 v[64:79], a[32:35], v[228:231], v[64:79]
    ds_read_b64_tr_b16 a[8:9], v10 offset:6208
    ds_read_b64_tr_b16 a[10:11], v10 offset:6976
    v_fma_f32 v23, v23, v16, v18
    v_cvt_pk_bf16_f32 v232, v20, v21
    v_cvt_pk_bf16_f32 v233, v22, v23
    s_waitcnt lgkmcnt(6)
    v_mfma_f32_32x32x16_bf16 v[80:95], a[36:39], v[228:231], v[80:95]
    ds_read_b64_tr_b16 a[12:13], v10 offset:6240
    ds_read_b64_tr_b16 a[14:15], v10 offset:7008
    v_lshlrev_b32 v24, 16, v234
    v_and_b32 v25, 0xffff0000, v234
    v_lshlrev_b32 v26, 16, v235
    buffer_load_dwordx4 v6, s[24:27], s76 offen offset:2048 lds
    v_mfma_f32_32x32x16_bf16 v[96:111], a[40:43], v[228:231], v[96:111]
    ds_read_b64_tr_b16 a[16:17], v10 offset:6272
    ds_read_b64_tr_b16 a[18:19], v10 offset:7040
    v_and_b32 v27, 0xffff0000, v235
    v_fma_f32 v24, v24, v16, v18
    v_fma_f32 v25, v25, v16, v18
    v_fma_f32 v26, v26, v16, v18
    v_mfma_f32_32x32x16_bf16 v[112:127], a[44:47], v[228:231], v[112:127]
    ds_read_b64_tr_b16 a[20:21], v11 offset:6304
    ds_read_b64_tr_b16 a[22:23], v11 offset:7072
    v_fma_f32 v27, v27, v16, v18
    v_cvt_pk_bf16_f32 v234, v24, v25
    v_cvt_pk_bf16_f32 v235, v26, v27
    buffer_load_dwordx4 v7, s[24:27], s76 offen offset:3072 lds
    s_waitcnt vmcnt(18)
    s_waitcnt lgkmcnt(6)
    v_mfma_f32_32x32x16_bf16 v[32:47], a[0:3], v[232:235], v[32:47]
    ds_read_b64_tr_b16 a[24:25], v10 offset:9216
    ds_read_b64_tr_b16 a[26:27], v10 offset:9984
    v_lshlrev_b32 v20, 16, v236
    v_and_b32 v21, 0xffff0000, v236
    v_lshlrev_b32 v22, 16, v237
    v_mfma_f32_32x32x16_bf16 v[48:63], a[4:7], v[232:235], v[48:63]
    ds_read_b64_tr_b16 a[28:29], v10 offset:9248
    ds_read_b64_tr_b16 a[30:31], v10 offset:10016
    v_and_b32 v23, 0xffff0000, v237
    v_fma_f32 v20, v20, v16, v18
    v_fma_f32 v21, v21, v16, v18
    v_fma_f32 v22, v22, v16, v18
    v_mfma_f32_32x32x16_bf16 v[64:79], a[8:11], v[232:235], v[64:79]
    ds_read_b64_tr_b16 a[32:33], v10 offset:9280
    ds_read_b64_tr_b16 a[34:35], v10 offset:10048
    v_fma_f32 v23, v23, v16, v18
    v_cvt_pk_bf16_f32 v236, v20, v21
    v_cvt_pk_bf16_f32 v237, v22, v23
    s_waitcnt lgkmcnt(6)
    v_mfma_f32_32x32x16_bf16 v[80:95], a[12:15], v[232:235], v[80:95]
    ds_read_b64_tr_b16 a[36:37], v10 offset:9312
    ds_read_b64_tr_b16 a[38:39], v10 offset:10080
    v_lshlrev_b32 v24, 16, v238
    v_and_b32 v25, 0xffff0000, v238
    v_lshlrev_b32 v26, 16, v239
    s_add_u32 m0, s74, 98304
    s_add_u32 s76, s77, 835584
    buffer_load_dwordx4 v4, s[24:27], s76 offen offset:0 lds
    v_mfma_f32_32x32x16_bf16 v[96:111], a[16:19], v[232:235], v[96:111]
    ds_read_b64_tr_b16 a[40:41], v10 offset:9344
    ds_read_b64_tr_b16 a[42:43], v10 offset:10112
    v_and_b32 v27, 0xffff0000, v239
    v_fma_f32 v24, v24, v16, v18
    v_fma_f32 v25, v25, v16, v18
    v_fma_f32 v26, v26, v16, v18
    v_mfma_f32_32x32x16_bf16 v[112:127], a[20:23], v[232:235], v[112:127]
    ds_read_b64_tr_b16 a[44:45], v11 offset:9376
    ds_read_b64_tr_b16 a[46:47], v11 offset:10144
    v_fma_f32 v27, v27, v16, v18
    v_cvt_pk_bf16_f32 v238, v24, v25
    v_cvt_pk_bf16_f32 v239, v26, v27
    buffer_load_dwordx4 v5, s[24:27], s76 offen offset:1024 lds
    v_add_u32 v10, 24576, v28
    v_add_u32 v11, 24576, v29
    s_waitcnt vmcnt(18)
    s_waitcnt lgkmcnt(6)
    v_mfma_f32_32x32x16_bf16 v[32:47], a[24:27], v[236:239], v[32:47]
    ds_read_b64_tr_b16 a[0:1], v10 offset:0
    ds_read_b64_tr_b16 a[2:3], v10 offset:768
    v_lshlrev_b32 v20, 16, v240
    v_and_b32 v21, 0xffff0000, v240
    v_lshlrev_b32 v22, 16, v241
    v_mfma_f32_32x32x16_bf16 v[48:63], a[28:31], v[236:239], v[48:63]
    ds_read_b64_tr_b16 a[4:5], v10 offset:32
    ds_read_b64_tr_b16 a[6:7], v10 offset:800
    v_and_b32 v23, 0xffff0000, v241
    v_fma_f32 v20, v20, v16, v18
    v_fma_f32 v21, v21, v16, v18
    v_fma_f32 v22, v22, v16, v18
    v_mfma_f32_32x32x16_bf16 v[64:79], a[32:35], v[236:239], v[64:79]
    ds_read_b64_tr_b16 a[8:9], v10 offset:64
    ds_read_b64_tr_b16 a[10:11], v10 offset:832
    v_fma_f32 v23, v23, v16, v18
    v_cvt_pk_bf16_f32 v240, v20, v21
    v_cvt_pk_bf16_f32 v241, v22, v23
    s_waitcnt lgkmcnt(6)
    v_mfma_f32_32x32x16_bf16 v[80:95], a[36:39], v[236:239], v[80:95]
    ds_read_b64_tr_b16 a[12:13], v10 offset:96
    ds_read_b64_tr_b16 a[14:15], v10 offset:864
    v_lshlrev_b32 v24, 16, v242
    v_and_b32 v25, 0xffff0000, v242
    v_lshlrev_b32 v26, 16, v243
    buffer_load_dwordx4 v6, s[24:27], s76 offen offset:2048 lds
    v_mfma_f32_32x32x16_bf16 v[96:111], a[40:43], v[236:239], v[96:111]
    ds_read_b64_tr_b16 a[16:17], v10 offset:128
    ds_read_b64_tr_b16 a[18:19], v10 offset:896
    v_and_b32 v27, 0xffff0000, v243
    v_fma_f32 v24, v24, v16, v18
    v_fma_f32 v25, v25, v16, v18
    v_fma_f32 v26, v26, v16, v18
    v_mfma_f32_32x32x16_bf16 v[112:127], a[44:47], v[236:239], v[112:127]
    ds_read_b64_tr_b16 a[20:21], v11 offset:160
    ds_read_b64_tr_b16 a[22:23], v11 offset:928
    v_fma_f32 v27, v27, v16, v18
    v_cvt_pk_bf16_f32 v242, v24, v25
    v_cvt_pk_bf16_f32 v243, v26, v27
    buffer_load_dwordx4 v7, s[24:27], s76 offen offset:3072 lds
    s_waitcnt vmcnt(17)
    s_waitcnt lgkmcnt(6)
    v_mfma_f32_32x32x16_bf16 v[32:47], a[0:3], v[240:243], v[32:47]
    ds_read_b64_tr_b16 a[24:25], v10 offset:3072
    ds_read_b64_tr_b16 a[26:27], v10 offset:3840
    v_lshlrev_b32 v20, 16, v244
    v_and_b32 v21, 0xffff0000, v244
    v_lshlrev_b32 v22, 16, v245
    v_mfma_f32_32x32x16_bf16 v[48:63], a[4:7], v[240:243], v[48:63]
    ds_read_b64_tr_b16 a[28:29], v10 offset:3104
    ds_read_b64_tr_b16 a[30:31], v10 offset:3872
    v_and_b32 v23, 0xffff0000, v245
    v_fma_f32 v20, v20, v16, v18
    v_fma_f32 v21, v21, v16, v18
    v_fma_f32 v22, v22, v16, v18
    v_mfma_f32_32x32x16_bf16 v[64:79], a[8:11], v[240:243], v[64:79]
    ds_read_b64_tr_b16 a[32:33], v10 offset:3136
    ds_read_b64_tr_b16 a[34:35], v10 offset:3904
    v_fma_f32 v23, v23, v16, v18
    v_cvt_pk_bf16_f32 v244, v20, v21
    v_cvt_pk_bf16_f32 v245, v22, v23
    s_waitcnt lgkmcnt(6)
    v_mfma_f32_32x32x16_bf16 v[80:95], a[12:15], v[240:243], v[80:95]
    ds_read_b64_tr_b16 a[36:37], v10 offset:3168
    ds_read_b64_tr_b16 a[38:39], v10 offset:3936
    v_lshlrev_b32 v24, 16, v246
    v_and_b32 v25, 0xffff0000, v246
    v_lshlrev_b32 v26, 16, v247
    s_add_u32 m0, s74, 114688
    s_add_u32 s76, s77, 966656
    buffer_load_dwordx4 v4, s[24:27], s76 offen offset:0 lds
    v_mfma_f32_32x32x16_bf16 v[96:111], a[16:19], v[240:243], v[96:111]
    ds_read_b64_tr_b16 a[40:41], v10 offset:3200
    ds_read_b64_tr_b16 a[42:43], v10 offset:3968
    v_and_b32 v27, 0xffff0000, v247
    v_fma_f32 v24, v24, v16, v18
    v_fma_f32 v25, v25, v16, v18
    v_fma_f32 v26, v26, v16, v18
    v_mfma_f32_32x32x16_bf16 v[112:127], a[20:23], v[240:243], v[112:127]
    ds_read_b64_tr_b16 a[44:45], v11 offset:3232
    ds_read_b64_tr_b16 a[46:47], v11 offset:4000
    v_fma_f32 v27, v27, v16, v18
    v_cvt_pk_bf16_f32 v246, v24, v25
    v_cvt_pk_bf16_f32 v247, v26, v27
    buffer_load_dwordx4 v5, s[24:27], s76 offen offset:1024 lds
    s_waitcnt vmcnt(16)
    s_waitcnt lgkmcnt(6)
    v_mfma_f32_32x32x16_bf16 v[32:47], a[24:27], v[244:247], v[32:47]
    ds_read_b64_tr_b16 a[0:1], v10 offset:6144
    ds_read_b64_tr_b16 a[2:3], v10 offset:6912
    v_lshlrev_b32 v20, 16, v248
    v_and_b32 v21, 0xffff0000, v248
    v_lshlrev_b32 v22, 16, v249
    v_mfma_f32_32x32x16_bf16 v[48:63], a[28:31], v[244:247], v[48:63]
    ds_read_b64_tr_b16 a[4:5], v10 offset:6176
    ds_read_b64_tr_b16 a[6:7], v10 offset:6944
    v_and_b32 v23, 0xffff0000, v249
    v_fma_f32 v20, v20, v16, v18
    v_fma_f32 v21, v21, v16, v18
    v_fma_f32 v22, v22, v16, v18
    v_mfma_f32_32x32x16_bf16 v[64:79], a[32:35], v[244:247], v[64:79]
    ds_read_b64_tr_b16 a[8:9], v10 offset:6208
    ds_read_b64_tr_b16 a[10:11], v10 offset:6976
    v_fma_f32 v23, v23, v16, v18
    v_cvt_pk_bf16_f32 v248, v20, v21
    v_cvt_pk_bf16_f32 v249, v22, v23
    s_waitcnt lgkmcnt(6)
    v_mfma_f32_32x32x16_bf16 v[80:95], a[36:39], v[244:247], v[80:95]
    ds_read_b64_tr_b16 a[12:13], v10 offset:6240
    ds_read_b64_tr_b16 a[14:15], v10 offset:7008
    v_lshlrev_b32 v24, 16, v250
    v_and_b32 v25, 0xffff0000, v250
    v_lshlrev_b32 v26, 16, v251
    buffer_load_dwordx4 v6, s[24:27], s76 offen offset:2048 lds
    v_mfma_f32_32x32x16_bf16 v[96:111], a[40:43], v[244:247], v[96:111]
    ds_read_b64_tr_b16 a[16:17], v10 offset:6272
    ds_read_b64_tr_b16 a[18:19], v10 offset:7040
    v_and_b32 v27, 0xffff0000, v251
    v_fma_f32 v24, v24, v16, v18
    v_fma_f32 v25, v25, v16, v18
    v_fma_f32 v26, v26, v16, v18
    v_mfma_f32_32x32x16_bf16 v[112:127], a[44:47], v[244:247], v[112:127]
    ds_read_b64_tr_b16 a[20:21], v11 offset:6304
    ds_read_b64_tr_b16 a[22:23], v11 offset:7072
    v_fma_f32 v27, v27, v16, v18
    v_cvt_pk_bf16_f32 v250, v24, v25
    v_cvt_pk_bf16_f32 v251, v26, v27
    buffer_load_dwordx4 v7, s[24:27], s76 offen offset:3072 lds
    s_waitcnt vmcnt(15)
    s_waitcnt lgkmcnt(6)
    v_mfma_f32_32x32x16_bf16 v[32:47], a[0:3], v[248:251], v[32:47]
    ds_read_b64_tr_b16 a[24:25], v10 offset:9216
    ds_read_b64_tr_b16 a[26:27], v10 offset:9984
    v_lshlrev_b32 v20, 16, v252
    v_and_b32 v21, 0xffff0000, v252
    v_lshlrev_b32 v22, 16, v253
    v_mfma_f32_32x32x16_bf16 v[48:63], a[4:7], v[248:251], v[48:63]
    ds_read_b64_tr_b16 a[28:29], v10 offset:9248
    ds_read_b64_tr_b16 a[30:31], v10 offset:10016
    v_and_b32 v23, 0xffff0000, v253
    v_fma_f32 v20, v20, v16, v18
    v_fma_f32 v21, v21, v16, v18
    v_fma_f32 v22, v22, v16, v18
    v_mfma_f32_32x32x16_bf16 v[64:79], a[8:11], v[248:251], v[64:79]
    ds_read_b64_tr_b16 a[32:33], v10 offset:9280
    ds_read_b64_tr_b16 a[34:35], v10 offset:10048
    v_fma_f32 v23, v23, v16, v18
    v_cvt_pk_bf16_f32 v252, v20, v21
    v_cvt_pk_bf16_f32 v253, v22, v23
    s_waitcnt lgkmcnt(6)
    v_mfma_f32_32x32x16_bf16 v[80:95], a[12:15], v[248:251], v[80:95]
    ds_read_b64_tr_b16 a[36:37], v10 offset:9312
    ds_read_b64_tr_b16 a[38:39], v10 offset:10080
    v_lshlrev_b32 v24, 16, v254
    v_and_b32 v25, 0xffff0000, v254
    v_lshlrev_b32 v26, 16, v255
    s_add_u32 m0, s74, 131072
    s_add_u32 s76, s77, 1097728
    buffer_load_dwordx4 v4, s[24:27], s76 offen offset:0 lds
    v_mfma_f32_32x32x16_bf16 v[96:111], a[16:19], v[248:251], v[96:111]
    ds_read_b64_tr_b16 a[40:41], v10 offset:9344
    ds_read_b64_tr_b16 a[42:43], v10 offset:10112
    v_and_b32 v27, 0xffff0000, v255
    v_fma_f32 v24, v24, v16, v18
    v_fma_f32 v25, v25, v16, v18
    v_fma_f32 v26, v26, v16, v18
    v_mfma_f32_32x32x16_bf16 v[112:127], a[20:23], v[248:251], v[112:127]
    ds_read_b64_tr_b16 a[44:45], v11 offset:9376
    ds_read_b64_tr_b16 a[46:47], v11 offset:10144
    v_fma_f32 v27, v27, v16, v18
    v_cvt_pk_bf16_f32 v254, v24, v25
    v_cvt_pk_bf16_f32 v255, v26, v27
    buffer_load_dwordx4 v5, s[24:27], s76 offen offset:1024 lds
    s_waitcnt lgkmcnt(6)
    v_mfma_f32_32x32x16_bf16 v[32:47], a[24:27], v[252:255], v[32:47]
    v_mfma_f32_32x32x16_bf16 v[48:63], a[28:31], v[252:255], v[48:63]
    v_mfma_f32_32x32x16_bf16 v[64:79], a[32:35], v[252:255], v[64:79]
    s_waitcnt lgkmcnt(0)
    v_mfma_f32_32x32x16_bf16 v[80:95], a[36:39], v[252:255], v[80:95]
    buffer_load_dwordx4 v6, s[24:27], s76 offen offset:2048 lds
    v_mfma_f32_32x32x16_bf16 v[96:111], a[40:43], v[252:255], v[96:111]
    v_mfma_f32_32x32x16_bf16 v[112:127], a[44:47], v[252:255], v[112:127]
    buffer_load_dwordx4 v7, s[24:27], s76 offen offset:3072 lds
    s_branch F1L_end
F1L_4:
    s_waitcnt vmcnt(6)
    s_waitcnt lgkmcnt(4)
    v_mfma_f32_32x32x16_bf16 v[32:47], a[0:3], v[128:131], 0
    ds_read_b64_tr_b16 a[24:25], v10 offset:3072
    ds_read_b64_tr_b16 a[26:27], v10 offset:3840
    v_lshlrev_b32 v20, 16, v132
    v_and_b32 v21, 0xffff0000, v132
    v_lshlrev_b32 v22, 16, v133
    v_and_b32 v23, 0xffff0000, v133
    v_fma_f32 v20, v20, v16, v18
    v_mfma_f32_32x32x16_bf16 v[48:63], a[4:7], v[128:131], 0
    ds_read_b64_tr_b16 a[28:29], v10 offset:3104
    ds_read_b64_tr_b16 a[30:31], v10 offset:3872
    v_fma_f32 v21, v21, v16, v18
    v_fma_f32 v22, v22, v16, v18
    v_fma_f32 v23, v23, v16, v18
    v_cvt_pk_bf16_f32 v132, v20, v21
    v_cvt_pk_bf16_f32 v133, v22, v23
    s_add_u32 s3, s30, 8192
    buffer_load_dwordx4 v[160:163], v9, s[8:11], s3 offen sc1
    s_waitcnt lgkmcnt(4)
    v_mfma_f32_32x32x16_bf16 v[64:79], a[8:11], v[128:131], 0
    ds_read_b64_tr_b16 a[32:33], v10 offset:3136
    ds_read_b64_tr_b16 a[34:35], v10 offset:3904
    v_lshlrev_b32 v24, 16, v134
    v_and_b32 v25, 0xffff0000, v134
    v_lshlrev_b32 v26, 16, v135
    v_and_b32 v27, 0xffff0000, v135
    v_fma_f32 v24, v24, v16, v18
    s_add_u32 m0, s69, 73728
    s_add_u32 s71, s68, 528384
    buffer_load_dwordx4 v2, s[16:19], s71 offen offset:0 lds
    v_mfma_f32_32x32x16_bf16 v[80:95], a[12:15], v[128:131], 0
    ds_read_b64_tr_b16 a[36:37], v10 offset:3168
    ds_read_b64_tr_b16 a[38:39], v10 offset:3936
    v_fma_f32 v25, v25, v16, v18
    v_fma_f32 v26, v26, v16, v18
    v_fma_f32 v27, v27, v16, v18
    v_cvt_pk_bf16_f32 v134, v24, v25
    v_cvt_pk_bf16_f32 v135, v26, v27
    buffer_load_dwordx4 v3, s[16:19], s71 offen offset:1024 lds
    s_waitcnt vmcnt(8)
    s_waitcnt lgkmcnt(4)
    v_mfma_f32_32x32x16_bf16 v[32:47], a[24:27], v[132:135], v[32:47]
    ds_read_b64_tr_b16 a[0:1], v10 offset:6144
    ds_read_b64_tr_b16 a[2:3], v10 offset:6912
    v_lshlrev_b32 v20, 16, v136
    v_and_b32 v21, 0xffff0000, v136
    v_lshlrev_b32 v22, 16, v137
    v_and_b32 v23, 0xffff0000, v137
    v_fma_f32 v20, v20, v16, v18
    v_mfma_f32_32x32x16_bf16 v[48:63], a[28:31], v[132:135], v[48:63]
    ds_read_b64_tr_b16 a[4:5], v10 offset:6176
    ds_read_b64_tr_b16 a[6:7], v10 offset:6944
    v_fma_f32 v21, v21, v16, v18
    v_fma_f32 v22, v22, v16, v18
    v_fma_f32 v23, v23, v16, v18
    v_cvt_pk_bf16_f32 v136, v20, v21
    v_cvt_pk_bf16_f32 v137, v22, v23
    s_add_u32 s3, s30, 9216
    buffer_load_dwordx4 v[164:167], v9, s[8:11], s3 offen sc1
    s_waitcnt lgkmcnt(4)
    v_mfma_f32_32x32x16_bf16 v[64:79], a[32:35], v[132:135], v[64:79]
    ds_read_b64_tr_b16 a[8:9], v10 offset:6208
    ds_read_b64_tr_b16 a[10:11], v10 offset:6976
    v_lshlrev_b32 v24, 16, v138
    v_and_b32 v25, 0xffff0000, v138
    v_lshlrev_b32 v26, 16, v139
    v_and_b32 v27, 0xffff0000, v139
    v_fma_f32 v24, v24, v16, v18
    buffer_load_dwordx4 v4, s[16:19], s71 offen offset:2048 lds
    v_mfma_f32_32x32x16_bf16 v[80:95], a[36:39], v[132:135], v[80:95]
    ds_read_b64_tr_b16 a[12:13], v10 offset:6240
    ds_read_b64_tr_b16 a[14:15], v10 offset:7008
    v_fma_f32 v25, v25, v16, v18
    v_fma_f32 v26, v26, v16, v18
    v_fma_f32 v27, v27, v16, v18
    v_cvt_pk_bf16_f32 v138, v24, v25
    v_cvt_pk_bf16_f32 v139, v26, v27
    s_add_u32 m0, s69, 86016
    s_nop 0
    buffer_load_dwordx4 v5, s[20:23], s71 offen offset:0 lds
    s_waitcnt vmcnt(10)
    s_waitcnt lgkmcnt(4)
    v_mfma_f32_32x32x16_bf16 v[32:47], a[0:3], v[136:139], v[32:47]
    ds_read_b64_tr_b16 a[24:25], v10 offset:9216
    ds_read_b64_tr_b16 a[26:27], v10 offset:9984
    v_lshlrev_b32 v20, 16, v140
    v_and_b32 v21, 0xffff0000, v140
    v_lshlrev_b32 v22, 16, v141
    v_and_b32 v23, 0xffff0000, v141
    v_fma_f32 v20, v20, v16, v18
    v_mfma_f32_32x32x16_bf16 v[48:63], a[4:7], v[136:139], v[48:63]
    ds_read_b64_tr_b16 a[28:29], v10 offset:9248
    ds_read_b64_tr_b16 a[30:31], v10 offset:10016
    v_fma_f32 v21, v21, v16, v18
    v_fma_f32 v22, v22, v16, v18
    v_fma_f32 v23, v23, v16, v18
    v_cvt_pk_bf16_f32 v140, v20, v21
    v_cvt_pk_bf16_f32 v141, v22, v23
    s_add_u32 s3, s30, 10240
    buffer_load_dwordx4 v[168:171], v9, s[8:11], s3 offen sc1
    s_waitcnt lgkmcnt(4)
    v_mfma_f32_32x32x16_bf16 v[64:79], a[8:11], v[136:139], v[64:79]
    ds_read_b64_tr_b16 a[32:33], v10 offset:9280
    ds_read_b64_tr_b16 a[34:35], v10 offset:10048
    v_lshlrev_b32 v24, 16, v142
    v_and_b32 v25, 0xffff0000, v142
    v_lshlrev_b32 v26, 16, v143
    v_and_b32 v27, 0xffff0000, v143
    v_fma_f32 v24, v24, v16, v18
    buffer_load_dwordx4 v6, s[20:23], s71 offen offset:1024 lds
    v_mfma_f32_32x32x16_bf16 v[80:95], a[12:15], v[136:139], v[80:95]
    ds_read_b64_tr_b16 a[36:37], v10 offset:9312
    ds_read_b64_tr_b16 a[38:39], v10 offset:10080
    v_fma_f32 v25, v25, v16, v18
    v_fma_f32 v26, v26, v16, v18
    v_fma_f32 v27, v27, v16, v18
    v_cvt_pk_bf16_f32 v142, v24, v25
    v_cvt_pk_bf16_f32 v143, v26, v27
    buffer_load_dwordx4 v7, s[20:23], s71 offen offset:2048 lds
    v_add_u32 v10, 24576, v28
    v_add_u32 v11, 24576, v29
    s_waitcnt vmcnt(12)
    s_waitcnt lgkmcnt(4)
    v_mfma_f32_32x32x16_bf16 v[32:47], a[24:27], v[140:143], v[32:47]
    ds_read_b64_tr_b16 a[0:1], v10 offset:0
    ds_read_b64_tr_b16 a[2:3], v10 offset:768
    v_lshlrev_b32 v20, 16, v144
    v_and_b32 v21, 0xffff0000, v144
    v_lshlrev_b32 v22, 16, v145
    v_and_b32 v23, 0xffff0000, v145
    v_fma_f32 v20, v20, v16, v18
    v_mfma_f32_32x32x16_bf16 v[48:63], a[28:31], v[140:143], v[48:63]
    ds_read_b64_tr_b16 a[4:5], v10 offset:32
    ds_read_b64_tr_b16 a[6:7], v10 offset:800
    v_fma_f32 v21, v21, v16, v18
    v_fma_f32 v22, v22, v16, v18
    v_fma_f32 v23, v23, v16, v18
    v_cvt_pk_bf16_f32 v144, v20, v21
    v_cvt_pk_bf16_f32 v145, v22, v23
    s_add_u32 s3, s30, 11264
    buffer_load_dwordx4 v[172:175], v9, s[8:11], s3 offen sc1
    s_waitcnt lgkmcnt(4)
    v_mfma_f32_32x32x16_bf16 v[64:79], a[32:35], v[140:143], v[64:79]
    ds_read_b64_tr_b16 a[8:9], v10 offset:64
    ds_read_b64_tr_b16 a[10:11], v10 offset:832
    v_lshlrev_b32 v24, 16, v146
    v_and_b32 v25, 0xffff0000, v146
    v_lshlrev_b32 v26, 16, v147
    v_and_b32 v27, 0xffff0000, v147
    v_fma_f32 v24, v24, v16, v18
    s_add_u32 m0, s69, 98304
    s_add_u32 s71, s68, 704512
    buffer_load_dwordx4 v2, s[16:19], s71 offen offset:0 lds
    v_mfma_f32_32x32x16_bf16 v[80:95], a[36:39], v[140:143], v[80:95]
    ds_read_b64_tr_b16 a[12:13], v10 offset:96
    ds_read_b64_tr_b16 a[14:15], v10 offset:864
    v_fma_f32 v25, v25, v16, v18
    v_fma_f32 v26, v26, v16, v18
    v_fma_f32 v27, v27, v16, v18
    v_cvt_pk_bf16_f32 v146, v24, v25
    v_cvt_pk_bf16_f32 v147, v26, v27
    buffer_load_dwordx4 v3, s[16:19], s71 offen offset:1024 lds
    s_waitcnt vmcnt(14)
    s_waitcnt lgkmcnt(4)
    v_mfma_f32_32x32x16_bf16 v[32:47], a[0:3], v[144:147], v[32:47]
    ds_read_b64_tr_b16 a[24:25], v10 offset:3072
    ds_read_b64_tr_b16 a[26:27], v10 offset:3840
    v_lshlrev_b32 v20, 16, v148
    v_and_b32 v21, 0xffff0000, v148
    v_lshlrev_b32 v22, 16, v149
    v_and_b32 v23, 0xffff0000, v149
    v_fma_f32 v20, v20, v16, v18
    v_mfma_f32_32x32x16_bf16 v[48:63], a[4:7], v[144:147], v[48:63]
    ds_read_b64_tr_b16 a[28:29], v10 offset:3104
    ds_read_b64_tr_b16 a[30:31], v10 offset:3872
    v_fma_f32 v21, v21, v16, v18
    v_fma_f32 v22, v22, v16, v18
    v_fma_f32 v23, v23, v16, v18
    v_cvt_pk_bf16_f32 v148, v20, v21
    v_cvt_pk_bf16_f32 v149, v22, v23
    s_add_u32 s3, s30, 12288
    buffer_load_dwordx4 v[176:179], v9, s[8:11], s3 offen sc1
    s_waitcnt lgkmcnt(4)
    v_mfma_f32_32x32x16_bf16 v[64:79], a[8:11], v[144:147], v[64:79]
    ds_read_b64_tr_b16 a[32:33], v10 offset:3136
    ds_read_b64_tr_b16 a[34:35], v10 offset:3904
    v_lshlrev_b32 v24, 16, v150
    v_and_b32 v25, 0xffff0000, v150
    v_lshlrev_b32 v26, 16, v151
    v_and_b32 v27, 0xffff0000, v151
    v_fma_f32 v24, v24, v16, v18
    buffer_load_dwordx4 v4, s[16:19], s71 offen offset:2048 lds
    v_mfma_f32_32x32x16_bf16 v[80:95], a[12:15], v[144:147], v[80:95]
    ds_read_b64_tr_b16 a[36:37], v10 offset:3168
    ds_read_b64_tr_b16 a[38:39], v10 offset:3936
    v_fma_f32 v25, v25, v16, v18
    v_fma_f32 v26, v26, v16, v18
    v_fma_f32 v27, v27, v16, v18
    v_cvt_pk_bf16_f32 v150, v24, v25
    v_cvt_pk_bf16_f32 v151, v26, v27
    s_add_u32 m0, s69, 110592
    s_nop 0
    buffer_load_dwordx4 v5, s[20:23], s71 offen offset:0 lds
    s_waitcnt vmcnt(16)
    s_waitcnt lgkmcnt(4)
    v_mfma_f32_32x32x16_bf16 v[32:47], a[24:27], v[148:151], v[32:47]
    ds_read_b64_tr_b16 a[0:1], v10 offset:6144
    ds_read_b64_tr_b16 a[2:3], v10 offset:6912
    v_lshlrev_b32 v20, 16, v152
    v_and_b32 v21, 0xffff0000, v152
    v_lshlrev_b32 v22, 16, v153
    v_and_b32 v23, 0xffff0000, v153
    v_fma_f32 v20, v20, v16, v18
    v_mfma_f32_32x32x16_bf16 v[48:63], a[28:31], v[148:151], v[48:63]
    ds_read_b64_tr_b16 a[4:5], v10 offset:6176
    ds_read_b64_tr_b16 a[6:7], v10 offset:6944
    v_fma_f32 v21, v21, v16, v18
    v_fma_f32 v22, v22, v16, v18
    v_fma_f32 v23, v23, v16, v18
    v_cvt_pk_bf16_f32 v152, v20, v21
    v_cvt_pk_bf16_f32 v153, v22, v23
    s_add_u32 s3, s30, 13312
    buffer_load_dwordx4 v[180:183], v9, s[8:11], s3 offen sc1
    s_waitcnt lgkmcnt(4)
    v_mfma_f32_32x32x16_bf16 v[64:79], a[32:35], v[148:151], v[64:79]
    ds_read_b64_tr_b16 a[8:9], v10 offset:6208
    ds_read_b64_tr_b16 a[10:11], v10 offset:6976
    v_lshlrev_b32 v24, 16, v154
    v_and_b32 v25, 0xffff0000, v154
    v_lshlrev_b32 v26, 16, v155
    v_and_b32 v27, 0xffff0000, v155
    v_fma_f32 v24, v24, v16, v18
    buffer_load_dwordx4 v6, s[20:23], s71 offen offset:1024 lds
    v_mfma_f32_32x32x16_bf16 v[80:95], a[36:39], v[148:151], v[80:95]
    ds_read_b64_tr_b16 a[12:13], v10 offset:6240
    ds_read_b64_tr_b16 a[14:15], v10 offset:7008
    v_fma_f32 v25, v25, v16, v18
    v_fma_f32 v26, v26, v16, v18
    v_fma_f32 v27, v27, v16, v18
    v_cvt_pk_bf16_f32 v154, v24, v25
    v_cvt_pk_bf16_f32 v155, v26, v27
    buffer_load_dwordx4 v7, s[20:23], s71 offen offset:2048 lds
    s_waitcnt vmcnt(18)
    s_waitcnt lgkmcnt(4)
    v_mfma_f32_32x32x16_bf16 v[32:47], a[0:3], v[152:155], v[32:47]
    ds_read_b64_tr_b16 a[24:25], v10 offset:9216
    ds_read_b64_tr_b16 a[26:27], v10 offset:9984
    v_lshlrev_b32 v20, 16, v156
    v_and_b32 v21, 0xffff0000, v156
    v_lshlrev_b32 v22, 16, v157
    v_and_b32 v23, 0xffff0000, v157
    v_fma_f32 v20, v20, v16, v18
    v_mfma_f32_32x32x16_bf16 v[48:63], a[4:7], v[152:155], v[48:63]
    ds_read_b64_tr_b16 a[28:29], v10 offset:9248
    ds_read_b64_tr_b16 a[30:31], v10 offset:10016
    v_fma_f32 v21, v21, v16, v18
    v_fma_f32 v22, v22, v16, v18
    v_fma_f32 v23, v23, v16, v18
    v_cvt_pk_bf16_f32 v156, v20, v21
    v_cvt_pk_bf16_f32 v157, v22, v23
    s_add_u32 s3, s30, 14336
    buffer_load_dwordx4 v[184:187], v9, s[8:11], s3 offen sc1
    s_waitcnt lgkmcnt(4)
    v_mfma_f32_32x32x16_bf16 v[64:79], a[8:11], v[152:155], v[64:79]
    ds_read_b64_tr_b16 a[32:33], v10 offset:9280
    ds_read_b64_tr_b16 a[34:35], v10 offset:10048
    v_lshlrev_b32 v24, 16, v158
    v_and_b32 v25, 0xffff0000, v158
    v_lshlrev_b32 v26, 16, v159
    v_and_b32 v27, 0xffff0000, v159
    v_fma_f32 v24, v24, v16, v18
    s_add_u32 m0, s69, 122880
    s_add_u32 s71, s68, 880640
    buffer_load_dwordx4 v2, s[16:19], s71 offen offset:0 lds
    v_mfma_f32_32x32x16_bf16 v[80:95], a[12:15], v[152:155], v[80:95]
    ds_read_b64_tr_b16 a[36:37], v10 offset:9312
    ds_read_b64_tr_b16 a[38:39], v10 offset:10080
    v_fma_f32 v25, v25, v16, v18
    v_fma_f32 v26, v26, v16, v18
    v_fma_f32 v27, v27, v16, v18
    v_cvt_pk_bf16_f32 v158, v24, v25
    v_cvt_pk_bf16_f32 v159, v26, v27
    buffer_load_dwordx4 v3, s[16:19], s71 offen offset:1024 lds
    v_add_u32 v10, 49152, v28
    v_add_u32 v11, 49152, v29
    s_waitcnt vmcnt(20)
    s_waitcnt lgkmcnt(4)
    v_mfma_f32_32x32x16_bf16 v[32:47], a[24:27], v[156:159], v[32:47]
    ds_read_b64_tr_b16 a[0:1], v10 offset:0
    ds_read_b64_tr_b16 a[2:3], v10 offset:768
    v_lshlrev_b32 v20, 16, v160
    v_and_b32 v21, 0xffff0000, v160
    v_lshlrev_b32 v22, 16, v161
    v_and_b32 v23, 0xffff0000, v161
    v_fma_f32 v20, v20, v16, v18
    v_mfma_f32_32x32x16_bf16 v[48:63], a[28:31], v[156:159], v[48:63]
    ds_read_b64_tr_b16 a[4:5], v10 offset:32
    ds_read_b64_tr_b16 a[6:7], v10 offset:800
    v_fma_f32 v21, v21, v16, v18
    v_fma_f32 v22, v22, v16, v18
    v_fma_f32 v23, v23, v16, v18
    v_cvt_pk_bf16_f32 v160, v20, v21
    v_cvt_pk_bf16_f32 v161, v22, v23
    s_add_u32 s3, s30, 15360
    buffer_load_dwordx4 v[188:191], v9, s[8:11], s3 offen sc1
    s_waitcnt lgkmcnt(4)
    v_mfma_f32_32x32x16_bf16 v[64:79], a[32:35], v[156:159], v[64:79]
    ds_read_b64_tr_b16 a[8:9], v10 offset:64
    ds_read_b64_tr_b16 a[10:11], v10 offset:832
    v_lshlrev_b32 v24, 16, v162
    v_and_b32 v25, 0xffff0000, v162
    v_lshlrev_b32 v26, 16, v163
    v_and_b32 v27, 0xffff0000, v163
    v_fma_f32 v24, v24, v16, v18
    buffer_load_dwordx4 v4, s[16:19], s71 offen offset:2048 lds
    v_mfma_f32_32x32x16_bf16 v[80:95], a[36:39], v[156:159], v[80:95]
    ds_read_b64_tr_b16 a[12:13], v10 offset:96
    ds_read_b64_tr_b16 a[14:15], v10 offset:864
    v_fma_f32 v25, v25, v16, v18
    v_fma_f32 v26, v26, v16, v18
    v_fma_f32 v27, v27, v16, v18
    v_cvt_pk_bf16_f32 v162, v24, v25
    v_cvt_pk_bf16_f32 v163, v26, v27
    s_add_u32 m0, s69, 135168
    s_nop 0
    buffer_load_dwordx4 v5, s[20:23], s71 offen offset:0 lds
    s_waitcnt vmcnt(15)
    s_barrier
    s_waitcnt vmcnt(20)
    s_waitcnt lgkmcnt(4)
    v_mfma_f32_32x32x16_bf16 v[32:47], a[0:3], v[160:163], v[32:47]
    ds_read_b64_tr_b16 a[24:25], v10 offset:3072
    ds_read_b64_tr_b16 a[26:27], v10 offset:3840
    v_lshlrev_b32 v20, 16, v164
    v_and_b32 v21, 0xffff0000, v164
    v_lshlrev_b32 v22, 16, v165
    v_and_b32 v23, 0xffff0000, v165
    v_fma_f32 v20, v20, v16, v18
    v_mfma_f32_32x32x16_bf16 v[48:63], a[4:7], v[160:163], v[48:63]
    ds_read_b64_tr_b16 a[28:29], v10 offset:3104
    ds_read_b64_tr_b16 a[30:31], v10 offset:3872
    v_fma_f32 v21, v21, v16, v18
    v_fma_f32 v22, v22, v16, v18
    v_fma_f32 v23, v23, v16, v18
    v_cvt_pk_bf16_f32 v164, v20, v21
    v_cvt_pk_bf16_f32 v165, v22, v23
    s_add_u32 s3, s30, 16384
    buffer_load_dwordx4 v[192:195], v9, s[8:11], s3 offen sc1
    s_waitcnt lgkmcnt(4)
    v_mfma_f32_32x32x16_bf16 v[64:79], a[8:11], v[160:163], v[64:79]
    ds_read_b64_tr_b16 a[32:33], v10 offset:3136
    ds_read_b64_tr_b16 a[34:35], v10 offset:3904
    v_lshlrev_b32 v24, 16, v166
    v_and_b32 v25, 0xffff0000, v166
    v_lshlrev_b32 v26, 16, v167
    v_and_b32 v27, 0xffff0000, v167
    v_fma_f32 v24, v24, v16, v18
    buffer_load_dwordx4 v6, s[20:23], s71 offen offset:1024 lds
    v_mfma_f32_32x32x16_bf16 v[80:95], a[12:15], v[160:163], v[80:95]
    ds_read_b64_tr_b16 a[36:37], v10 offset:3168
    ds_read_b64_tr_b16 a[38:39], v10 offset:3936
    v_fma_f32 v25, v25, v16, v18
    v_fma_f32 v26, v26, v16, v18
    v_fma_f32 v27, v27, v16, v18
    v_cvt_pk_bf16_f32 v166, v24, v25
    v_cvt_pk_bf16_f32 v167, v26, v27
    buffer_load_dwordx4 v7, s[20:23], s71 offen offset:2048 lds
    s_waitcnt vmcnt(20)
    s_waitcnt lgkmcnt(4)
    v_mfma_f32_32x32x16_bf16 v[32:47], a[24:27], v[164:167], v[32:47]
    ds_read_b64_tr_b16 a[0:1], v10 offset:6144
    ds_read_b64_tr_b16 a[2:3], v10 offset:6912
    v_lshlrev_b32 v20, 16, v168
    v_and_b32 v21, 0xffff0000, v168
    v_lshlrev_b32 v22, 16, v169
    v_and_b32 v23, 0xffff0000, v169
    v_fma_f32 v20, v20, v16, v18
    v_mfma_f32_32x32x16_bf16 v[48:63], a[28:31], v[164:167], v[48:63]
    ds_read_b64_tr_b16 a[4:5], v10 offset:6176
    ds_read_b64_tr_b16 a[6:7], v10 offset:6944
    v_fma_f32 v21, v21, v16, v18
    v_fma_f32 v22, v22, v16, v18
    v_fma_f32 v23, v23, v16, v18
    v_cvt_pk_bf16_f32 v168, v20, v21
    v_cvt_pk_bf16_f32 v169, v22, v23
    s_add_u32 s3, s30, 17408
    buffer_load_dwordx4 v[196:199], v9, s[8:11], s3 offen sc1
    s_waitcnt lgkmcnt(4)
    v_mfma_f32_32x32x16_bf16 v[64:79], a[32:35], v[164:167], v[64:79]
    ds_read_b64_tr_b16 a[8:9], v10 offset:6208
    ds_read_b64_tr_b16 a[10:11], v10 offset:6976
    v_lshlrev_b32 v24, 16, v170
    v_and_b32 v25, 0xffff0000, v170
    v_lshlrev_b32 v26, 16, v171
    v_and_b32 v27, 0xffff0000, v171
    v_fma_f32 v24, v24, v16, v18
    s_add_u32 m0, s69, 0
    s_add_u32 s71, s68, 1056768
    buffer_load_dwordx4 v2, s[16:19], s71 offen offset:0 lds
    v_mfma_f32_32x32x16_bf16 v[80:95], a[36:39], v[164:167], v[80:95]
    ds_read_b64_tr_b16 a[12:13], v10 offset:6240
    ds_read_b64_tr_b16 a[14:15], v10 offset:7008
    v_fma_f32 v25, v25, v16, v18
    v_fma_f32 v26, v26, v16, v18
    v_fma_f32 v27, v27, v16, v18
    v_cvt_pk_bf16_f32 v170, v24, v25
    v_cvt_pk_bf16_f32 v171, v26, v27
    buffer_load_dwordx4 v3, s[16:19], s71 offen offset:1024 lds
    s_waitcnt vmcnt(20)
    s_waitcnt lgkmcnt(4)
    v_mfma_f32_32x32x16_bf16 v[32:47], a[0:3], v[168:171], v[32:47]
    ds_read_b64_tr_b16 a[24:25], v10 offset:9216
    ds_read_b64_tr_b16 a[26:27], v10 offset:9984
    v_lshlrev_b32 v20, 16, v172
    v_and_b32 v21, 0xffff0000, v172
    v_lshlrev_b32 v22, 16, v173
    v_and_b32 v23, 0xffff0000, v173
    v_fma_f32 v20, v20, v16, v18
    v_mfma_f32_32x32x16_bf16 v[48:63], a[4:7], v[168:171], v[48:63]
    ds_read_b64_tr_b16 a[28:29], v10 offset:9248
    ds_read_b64_tr_b16 a[30:31], v10 offset:10016
    v_fma_f32 v21, v21, v16, v18
    v_fma_f32 v22, v22, v16, v18
    v_fma_f32 v23, v23, v16, v18
    v_cvt_pk_bf16_f32 v172, v20, v21
    v_cvt_pk_bf16_f32 v173, v22, v23
    s_add_u32 s3, s30, 18432
    buffer_load_dwordx4 v[200:203], v9, s[8:11], s3 offen sc1
    s_waitcnt lgkmcnt(4)
    v_mfma_f32_32x32x16_bf16 v[64:79], a[8:11], v[168:171], v[64:79]
    ds_read_b64_tr_b16 a[32:33], v10 offset:9280
    ds_read_b64_tr_b16 a[34:35], v10 offset:10048
    v_lshlrev_b32 v24, 16, v174
    v_and_b32 v25, 0xffff0000, v174
    v_lshlrev_b32 v26, 16, v175
    v_and_b32 v27, 0xffff0000, v175
    v_fma_f32 v24, v24, v16, v18
    buffer_load_dwordx4 v4, s[16:19], s71 offen offset:2048 lds
    v_mfma_f32_32x32x16_bf16 v[80:95], a[12:15], v[168:171], v[80:95]
    ds_read_b64_tr_b16 a[36:37], v10 offset:9312
    ds_read_b64_tr_b16 a[38:39], v10 offset:10080
    v_fma_f32 v25, v25, v16, v18
    v_fma_f32 v26, v26, v16, v18
    v_fma_f32 v27, v27, v16, v18
    v_cvt_pk_bf16_f32 v174, v24, v25
    v_cvt_pk_bf16_f32 v175, v26, v27
    s_add_u32 m0, s69, 12288
    s_nop 0
    buffer_load_dwordx4 v5, s[20:23], s71 offen offset:0 lds
    v_add_u32 v10, 73728, v28
    v_add_u32 v11, 73728, v29
    s_waitcnt vmcnt(20)
    s_waitcnt lgkmcnt(4)
    v_mfma_f32_32x32x16_bf16 v[32:47], a[24:27], v[172:175], v[32:47]
    ds_read_b64_tr_b16 a[0:1], v10 offset:0
    ds_read_b64_tr_b16 a[2:3], v10 offset:768
    v_lshlrev_b32 v20, 16, v176
    v_and_b32 v21, 0xffff0000, v176
    v_lshlrev_b32 v22, 16, v177
    v_and_b32 v23, 0xffff0000, v177
    v_fma_f32 v20, v20, v16, v18
    v_mfma_f32_32x32x16_bf16 v[48:63], a[28:31], v[172:175], v[48:63]
    ds_read_b64_tr_b16 a[4:5], v10 offset:32
    ds_read_b64_tr_b16 a[6:7], v10 offset:800
    v_fma_f32 v21, v21, v16, v18
    v_fma_f32 v22, v22, v16, v18
    v_fma_f32 v23, v23, v16, v18
    v_cvt_pk_bf16_f32 v176, v20, v21
    v_cvt_pk_bf16_f32 v177, v22, v23
    s_add_u32 s3, s30, 19456
    buffer_load_dwordx4 v[204:207], v9, s[8:11], s3 offen sc1
    s_waitcnt lgkmcnt(4)
    v_mfma_f32_32x32x16_bf16 v[64:79], a[32:35], v[172:175], v[64:79]
    ds_read_b64_tr_b16 a[8:9], v10 offset:64
    ds_read_b64_tr_b16 a[10:11], v10 offset:832
    v_lshlrev_b32 v24, 16, v178
    v_and_b32 v25, 0xffff0000, v178
    v_lshlrev_b32 v26, 16, v179
    v_and_b32 v27, 0xffff0000, v179
    v_fma_f32 v24, v24, v16, v18
    buffer_load_dwordx4 v6, s[20:23], s71 offen offset:1024 lds
    v_mfma_f32_32x32x16_bf16 v[80:95], a[36:39], v[172:175], v[80:95]
    ds_read_b64_tr_b16 a[12:13], v10 offset:96
    ds_read_b64_tr_b16 a[14:15], v10 offset:864
    v_fma_f32 v25, v25, v16, v18
    v_fma_f32 v26, v26, v16, v18
    v_fma_f32 v27, v27, v16, v18
    v_cvt_pk_bf16_f32 v178, v24, v25
    v_cvt_pk_bf16_f32 v179, v26, v27
    buffer_load_dwordx4 v7, s[20:23], s71 offen offset:2048 lds
    s_waitcnt vmcnt(20)
    s_waitcnt lgkmcnt(4)
    v_mfma_f32_32x32x16_bf16 v[32:47], a[0:3], v[176:179], v[32:47]
    ds_read_b64_tr_b16 a[24:25], v10 offset:3072
    ds_read_b64_tr_b16 a[26:27], v10 offset:3840
    v_lshlrev_b32 v20, 16, v180
    v_and_b32 v21, 0xffff0000, v180
    v_lshlrev_b32 v22, 16, v181
    v_and_b32 v23, 0xffff0000, v181
    v_fma_f32 v20, v20, v16, v18
    v_mfma_f32_32x32x16_bf16 v[48:63], a[4:7], v[176:179], v[48:63]
    ds_read_b64_tr_b16 a[28:29], v10 offset:3104
    ds_read_b64_tr_b16 a[30:31], v10 offset:3872
    v_fma_f32 v21, v21, v16, v18
    v_fma_f32 v22, v22, v16, v18
    v_fma_f32 v23, v23, v16, v18
    v_cvt_pk_bf16_f32 v180, v20, v21
    v_cvt_pk_bf16_f32 v181, v22, v23
    s_add_u32 s3, s30, 20480
    buffer_load_dwordx4 v[208:211], v9, s[8:11], s3 offen sc1
    s_waitcnt lgkmcnt(4)
    v_mfma_f32_32x32x16_bf16 v[64:79], a[8:11], v[176:179], v[64:79]
    ds_read_b64_tr_b16 a[32:33], v10 offset:3136
    ds_read_b64_tr_b16 a[34:35], v10 offset:3904
    v_lshlrev_b32 v24, 16, v182
    v_and_b32 v25, 0xffff0000, v182
    v_lshlrev_b32 v26, 16, v183
    v_and_b32 v27, 0xffff0000, v183
    v_fma_f32 v24, v24, v16, v18
    s_add_u32 m0, s69, 24576
    s_add_u32 s71, s68, 1232896
    buffer_load_dwordx4 v2, s[16:19], s71 offen offset:0 lds
    v_mfma_f32_32x32x16_bf16 v[80:95], a[12:15], v[176:179], v[80:95]
    ds_read_b64_tr_b16 a[36:37], v10 offset:3168
    ds_read_b64_tr_b16 a[38:39], v10 offset:3936
    v_fma_f32 v25, v25, v16, v18
    v_fma_f32 v26, v26, v16, v18
    v_fma_f32 v27, v27, v16, v18
    v_cvt_pk_bf16_f32 v182, v24, v25
    v_cvt_pk_bf16_f32 v183, v26, v27
    buffer_load_dwordx4 v3, s[16:19], s71 offen offset:1024 lds
    s_waitcnt vmcnt(20)
    s_waitcnt lgkmcnt(4)
    v_mfma_f32_32x32x16_bf16 v[32:47], a[24:27], v[180:183], v[32:47]
    ds_read_b64_tr_b16 a[0:1], v10 offset:6144
    ds_read_b64_tr_b16 a[2:3], v10 offset:6912
    v_lshlrev_b32 v20, 16, v184
    v_and_b32 v21, 0xffff0000, v184
    v_lshlrev_b32 v22, 16, v185
    v_and_b32 v23, 0xffff0000, v185
    v_fma_f32 v20, v20, v16, v18
    v_mfma_f32_32x32x16_bf16 v[48:63], a[28:31], v[180:183], v[48:63]
    ds_read_b64_tr_b16 a[4:5], v10 offset:6176
    ds_read_b64_tr_b16 a[6:7], v10 offset:6944
    v_fma_f32 v21, v21, v16, v18
    v_fma_f32 v22, v22, v16, v18
    v_fma_f32 v23, v23, v16, v18
    v_cvt_pk_bf16_f32 v184, v20, v21
    v_cvt_pk_bf16_f32 v185, v22, v23
    s_add_u32 s3, s30, 21504
    buffer_load_dwordx4 v[212:215], v9, s[8:11], s3 offen sc1
    s_waitcnt lgkmcnt(4)
    v_mfma_f32_32x32x16_bf16 v[64:79], a[32:35], v[180:183], v[64:79]
    ds_read_b64_tr_b16 a[8:9], v10 offset:6208
    ds_read_b64_tr_b16 a[10:11], v10 offset:6976
    v_lshlrev_b32 v24, 16, v186
    v_and_b32 v25, 0xffff0000, v186
    v_lshlrev_b32 v26, 16, v187
    v_and_b32 v27, 0xffff0000, v187
    v_fma_f32 v24, v24, v16, v18
    buffer_load_dwordx4 v4, s[16:19], s71 offen offset:2048 lds
    v_mfma_f32_32x32x16_bf16 v[80:95], a[36:39], v[180:183], v[80:95]
    ds_read_b64_tr_b16 a[12:13], v10 offset:6240
    ds_read_b64_tr_b16 a[14:15], v10 offset:7008
    v_fma_f32 v25, v25, v16, v18
    v_fma_f32 v26, v26, v16, v18
    v_fma_f32 v27, v27, v16, v18
    v_cvt_pk_bf16_f32 v186, v24, v25
    v_cvt_pk_bf16_f32 v187, v26, v27
    s_add_u32 m0, s69, 36864
    s_nop 0
    buffer_load_dwordx4 v5, s[20:23], s71 offen offset:0 lds
    s_waitcnt vmcnt(15)
    s_barrier
    s_waitcnt vmcnt(20)
    s_waitcnt lgkmcnt(4)
    v_mfma_f32_32x32x16_bf16 v[32:47], a[0:3], v[184:187], v[32:47]
    ds_read_b64_tr_b16 a[24:25], v10 offset:9216
    ds_read_b64_tr_b16 a[26:27], v10 offset:9984
    v_lshlrev_b32 v20, 16, v188
    v_and_b32 v21, 0xffff0000, v188
    v_lshlrev_b32 v22, 16, v189
    v_and_b32 v23, 0xffff0000, v189
    v_fma_f32 v20, v20, v16, v18
    v_mfma_f32_32x32x16_bf16 v[48:63], a[4:7], v[184:187], v[48:63]
    ds_read_b64_tr_b16 a[28:29], v10 offset:9248
    ds_read_b64_tr_b16 a[30:31], v10 offset:10016
    v_fma_f32 v21, v21, v16, v18
    v_fma_f32 v22, v22, v16, v18
    v_fma_f32 v23, v23, v16, v18
    v_cvt_pk_bf16_f32 v188, v20, v21
    v_cvt_pk_bf16_f32 v189, v22, v23
    s_add_u32 s3, s30, 22528
    buffer_load_dwordx4 v[216:219], v9, s[8:11], s3 offen sc1
    s_waitcnt lgkmcnt(4)
    v_mfma_f32_32x32x16_bf16 v[64:79], a[8:11], v[184:187], v[64:79]
    ds_read_b64_tr_b16 a[32:33], v10 offset:9280
    ds_read_b64_tr_b16 a[34:35], v10 offset:10048
    v_lshlrev_b32 v24, 16, v190
    v_and_b32 v25, 0xffff0000, v190
    v_lshlrev_b32 v26, 16, v191
    v_and_b32 v27, 0xffff0000, v191
    v_fma_f32 v24, v24, v16, v18
    buffer_load_dwordx4 v6, s[20:23], s71 offen offset:1024 lds
    v_mfma_f32_32x32x16_bf16 v[80:95], a[12:15], v[184:187], v[80:95]
    ds_read_b64_tr_b16 a[36:37], v10 offset:9312
    ds_read_b64_tr_b16 a[38:39], v10 offset:10080
    v_fma_f32 v25, v25, v16, v18
    v_fma_f32 v26, v26, v16, v18
    v_fma_f32 v27, v27, v16, v18
    v_cvt_pk_bf16_f32 v190, v24, v25
    v_cvt_pk_bf16_f32 v191, v26, v27
    buffer_load_dwordx4 v7, s[20:23], s71 offen offset:2048 lds
    v_add_u32 v10, 98304, v28
    v_add_u32 v11, 98304, v29
    s_waitcnt vmcnt(20)
    s_waitcnt lgkmcnt(4)
    v_mfma_f32_32x32x16_bf16 v[32:47], a[24:27], v[188:191], v[32:47]
    ds_read_b64_tr_b16 a[0:1], v10 offset:0
    ds_read_b64_tr_b16 a[2:3], v10 offset:768
    v_lshlrev_b32 v20, 16, v192
    v_and_b32 v21, 0xffff0000, v192
    v_lshlrev_b32 v22, 16, v193
    v_and_b32 v23, 0xffff0000, v193
    v_fma_f32 v20, v20, v16, v18
    v_mfma_f32_32x32x16_bf16 v[48:63], a[28:31], v[188:191], v[48:63]
    ds_read_b64_tr_b16 a[4:5], v10 offset:32
    ds_read_b64_tr_b16 a[6:7], v10 offset:800
    v_fma_f32 v21, v21, v16, v18
    v_fma_f32 v22, v22, v16, v18
    v_fma_f32 v23, v23, v16, v18
    v_cvt_pk_bf16_f32 v192, v20, v21
    v_cvt_pk_bf16_f32 v193, v22, v23
    s_add_u32 s3, s30, 23552
    buffer_load_dwordx4 v[220:223], v9, s[8:11], s3 offen sc1
    s_waitcnt lgkmcnt(4)
    v_mfma_f32_32x32x16_bf16 v[64:79], a[32:35], v[188:191], v[64:79]
    ds_read_b64_tr_b16 a[8:9], v10 offset:64
    ds_read_b64_tr_b16 a[10:11], v10 offset:832
    v_lshlrev_b32 v24, 16, v194
    v_and_b32 v25, 0xffff0000, v194
    v_lshlrev_b32 v26, 16, v195
    v_and_b32 v27, 0xffff0000, v195
    v_fma_f32 v24, v24, v16, v18
    v_mfma_f32_32x32x16_bf16 v[80:95], a[36:39], v[188:191], v[80:95]
    ds_read_b64_tr_b16 a[12:13], v10 offset:96
    ds_read_b64_tr_b16 a[14:15], v10 offset:864
    v_fma_f32 v25, v25, v16, v18
    v_fma_f32 v26, v26, v16, v18
    v_fma_f32 v27, v27, v16, v18
    v_cvt_pk_bf16_f32 v194, v24, v25
    v_cvt_pk_bf16_f32 v195, v26, v27
    v_mov_b32 v4, v1
    v_add_u32 v5, 7168, v1
    v_add_u32 v6, 14336, v1
    v_add_u32 v7, 21504, v1
    s_waitcnt vmcnt(18)
    s_waitcnt lgkmcnt(4)
    v_mfma_f32_32x32x16_bf16 v[32:47], a[0:3], v[192:195], v[32:47]
    ds_read_b64_tr_b16 a[24:25], v10 offset:3072
    ds_read_b64_tr_b16 a[26:27], v10 offset:3840
    v_lshlrev_b32 v20, 16, v196
    v_and_b32 v21, 0xffff0000, v196
    v_lshlrev_b32 v22, 16, v197
    v_and_b32 v23, 0xffff0000, v197
    v_fma_f32 v20, v20, v16, v18
    v_mfma_f32_32x32x16_bf16 v[48:63], a[4:7], v[192:195], v[48:63]
    ds_read_b64_tr_b16 a[28:29], v10 offset:3104
    ds_read_b64_tr_b16 a[30:31], v10 offset:3872
    v_fma_f32 v21, v21, v16, v18
    v_fma_f32 v22, v22, v16, v18
    v_fma_f32 v23, v23, v16, v18
    v_cvt_pk_bf16_f32 v196, v20, v21
    v_cvt_pk_bf16_f32 v197, v22, v23
    s_add_u32 s3, s30, 24576
    buffer_load_dwordx4 v[224:227], v9, s[8:11], s3 offen sc1
    s_waitcnt lgkmcnt(4)
    v_mfma_f32_32x32x16_bf16 v[64:79], a[8:11], v[192:195], v[64:79]
    ds_read_b64_tr_b16 a[32:33], v10 offset:3136
    ds_read_b64_tr_b16 a[34:35], v10 offset:3904
    v_lshlrev_b32 v24, 16, v198
    v_and_b32 v25, 0xffff0000, v198
    v_lshlrev_b32 v26, 16, v199
    v_and_b32 v27, 0xffff0000, v199
    v_fma_f32 v24, v24, v16, v18
    s_add_u32 m0, s74, 147456
    s_add_u32 s76, s77, 1228800
    buffer_load_dwordx4 v4, s[24:27], s76 offen offset:0 lds
    v_mfma_f32_32x32x16_bf16 v[80:95], a[12:15], v[192:195], v[80:95]
    ds_read_b64_tr_b16 a[36:37], v10 offset:3168
    ds_read_b64_tr_b16 a[38:39], v10 offset:3936
    v_fma_f32 v25, v25, v16, v18
    v_fma_f32 v26, v26, v16, v18
    v_fma_f32 v27, v27, v16, v18
    v_cvt_pk_bf16_f32 v198, v24, v25
    v_cvt_pk_bf16_f32 v199, v26, v27
    s_waitcnt vmcnt(17)
    s_waitcnt lgkmcnt(4)
    v_mfma_f32_32x32x16_bf16 v[32:47], a[24:27], v[196:199], v[32:47]
    ds_read_b64_tr_b16 a[0:1], v10 offset:6144
    ds_read_b64_tr_b16 a[2:3], v10 offset:6912
    v_lshlrev_b32 v20, 16, v200
    v_and_b32 v21, 0xffff0000, v200
    v_lshlrev_b32 v22, 16, v201
    v_and_b32 v23, 0xffff0000, v201
    v_fma_f32 v20, v20, v16, v18
    v_mfma_f32_32x32x16_bf16 v[48:63], a[28:31], v[196:199], v[48:63]
    ds_read_b64_tr_b16 a[4:5], v10 offset:6176
    ds_read_b64_tr_b16 a[6:7], v10 offset:6944
    v_fma_f32 v21, v21, v16, v18
    v_fma_f32 v22, v22, v16, v18
    v_fma_f32 v23, v23, v16, v18
    v_cvt_pk_bf16_f32 v200, v20, v21
    v_cvt_pk_bf16_f32 v201, v22, v23
    s_add_u32 s3, s30, 25600
    buffer_load_dwordx4 v[228:231], v9, s[8:11], s3 offen sc1
    s_waitcnt lgkmcnt(4)
    v_mfma_f32_32x32x16_bf16 v[64:79], a[32:35], v[196:199], v[64:79]
    ds_read_b64_tr_b16 a[8:9], v10 offset:6208
    ds_read_b64_tr_b16 a[10:11], v10 offset:6976
    v_lshlrev_b32 v24, 16, v202
    v_and_b32 v25, 0xffff0000, v202
    v_lshlrev_b32 v26, 16, v203
    v_and_b32 v27, 0xffff0000, v203
    v_fma_f32 v24, v24, v16, v18
    buffer_load_dwordx4 v5, s[24:27], s76 offen offset:1024 lds
    v_mfma_f32_32x32x16_bf16 v[80:95], a[36:39], v[196:199], v[80:95]
    ds_read_b64_tr_b16 a[12:13], v10 offset:6240
    ds_read_b64_tr_b16 a[14:15], v10 offset:7008
    v_fma_f32 v25, v25, v16, v18
    v_fma_f32 v26, v26, v16, v18
    v_fma_f32 v27, v27, v16, v18
    v_cvt_pk_bf16_f32 v202, v24, v25
    v_cvt_pk_bf16_f32 v203, v26, v27
    s_waitcnt vmcnt(16)
    s_waitcnt lgkmcnt(4)
    v_mfma_f32_32x32x16_bf16 v[32:47], a[0:3], v[200:203], v[32:47]
    ds_read_b64_tr_b16 a[24:25], v10 offset:9216
    ds_read_b64_tr_b16 a[26:27], v10 offset:9984
    v_lshlrev_b32 v20, 16, v204
    v_and_b32 v21, 0xffff0000, v204
    v_lshlrev_b32 v22, 16, v205
    v_and_b32 v23, 0xffff0000, v205
    v_fma_f32 v20, v20, v16, v18
    v_mfma_f32_32x32x16_bf16 v[48:63], a[4:7], v[200:203], v[48:63]
    ds_read_b64_tr_b16 a[28:29], v10 offset:9248
    ds_read_b64_tr_b16 a[30:31], v10 offset:10016
    v_fma_f32 v21, v21, v16, v18
    v_fma_f32 v22, v22, v16, v18
    v_fma_f32 v23, v23, v16, v18
    v_cvt_pk_bf16_f32 v204, v20, v21
    v_cvt_pk_bf16_f32 v205, v22, v23
    s_add_u32 s3, s30, 26624
    buffer_load_dwordx4 v[232:235], v9, s[8:11], s3 offen sc1
    s_waitcnt lgkmcnt(4)
    v_mfma_f32_32x32x16_bf16 v[64:79], a[8:11], v[200:203], v[64:79]
    ds_read_b64_tr_b16 a[32:33], v10 offset:9280
    ds_read_b64_tr_b16 a[34:35], v10 offset:10048
    v_lshlrev_b32 v24, 16, v206
    v_and_b32 v25, 0xffff0000, v206
    v_lshlrev_b32 v26, 16, v207
    v_and_b32 v27, 0xffff0000, v207
    v_fma_f32 v24, v24, v16, v18
    buffer_load_dwordx4 v6, s[24:27], s76 offen offset:2048 lds
    v_mfma_f32_32x32x16_bf16 v[80:95], a[12:15], v[200:203], v[80:95]
    ds_read_b64_tr_b16 a[36:37], v10 offset:9312
    ds_read_b64_tr_b16 a[38:39], v10 offset:10080
    v_fma_f32 v25, v25, v16, v18
    v_fma_f32 v26, v26, v16, v18
    v_fma_f32 v27, v27, v16, v18
    v_cvt_pk_bf16_f32 v206, v24, v25
    v_cvt_pk_bf16_f32 v207, v26, v27
    v_add_u32 v10, 122880, v28
    v_add_u32 v11, 122880, v29
    s_waitcnt vmcnt(15)
    s_waitcnt lgkmcnt(4)
    v_mfma_f32_32x32x16_bf16 v[32:47], a[24:27], v[204:207], v[32:47]
    ds_read_b64_tr_b16 a[0:1], v10 offset:0
    ds_read_b64_tr_b16 a[2:3], v10 offset:768
    v_lshlrev_b32 v20, 16, v208
    v_and_b32 v21, 0xffff0000, v208
    v_lshlrev_b32 v22, 16, v209
    v_and_b32 v23, 0xffff0000, v209
    v_fma_f32 v20, v20, v16, v18
    v_mfma_f32_32x32x16_bf16 v[48:63], a[28:31], v[204:207], v[48:63]
    ds_read_b64_tr_b16 a[4:5], v10 offset:32
    ds_read_b64_tr_b16 a[6:7], v10 offset:800
    v_fma_f32 v21, v21, v16, v18
    v_fma_f32 v22, v22, v16, v18
    v_fma_f32 v23, v23, v16, v18
    v_cvt_pk_bf16_f32 v208, v20, v21
    v_cvt_pk_bf16_f32 v209, v22, v23
    s_add_u32 s3, s30, 27648
    buffer_load_dwordx4 v[236:239], v9, s[8:11], s3 offen sc1
    s_waitcnt lgkmcnt(4)
    v_mfma_f32_32x32x16_bf16 v[64:79], a[32:35], v[204:207], v[64:79]
    ds_read_b64_tr_b16 a[8:9], v10 offset:64
    ds_read_b64_tr_b16 a[10:11], v10 offset:832
    v_lshlrev_b32 v24, 16, v210
    v_and_b32 v25, 0xffff0000, v210
    v_lshlrev_b32 v26, 16, v211
    v_and_b32 v27, 0xffff0000, v211
    v_fma_f32 v24, v24, v16, v18
    buffer_load_dwordx4 v7, s[24:27], s76 offen offset:3072 lds
    v_mfma_f32_32x32x16_bf16 v[80:95], a[36:39], v[204:207], v[80:95]
    ds_read_b64_tr_b16 a[12:13], v10 offset:96
    ds_read_b64_tr_b16 a[14:15], v10 offset:864
    v_fma_f32 v25, v25, v16, v18
    v_fma_f32 v26, v26, v16, v18
    v_fma_f32 v27, v27, v16, v18
    v_cvt_pk_bf16_f32 v210, v24, v25
    v_cvt_pk_bf16_f32 v211, v26, v27
    s_waitcnt vmcnt(9)
    s_barrier
    s_waitcnt vmcnt(14)
    s_waitcnt lgkmcnt(4)
    v_mfma_f32_32x32x16_bf16 v[32:47], a[0:3], v[208:211], v[32:47]
    ds_read_b64_tr_b16 a[24:25], v10 offset:3072
    ds_read_b64_tr_b16 a[26:27], v10 offset:3840
    v_lshlrev_b32 v20, 16, v212
    v_and_b32 v21, 0xffff0000, v212
    v_lshlrev_b32 v22, 16, v213
    v_and_b32 v23, 0xffff0000, v213
    v_fma_f32 v20, v20, v16, v18
    v_mfma_f32_32x32x16_bf16 v[48:63], a[4:7], v[208:211], v[48:63]
    ds_read_b64_tr_b16 a[28:29], v10 offset:3104
    ds_read_b64_tr_b16 a[30:31], v10 offset:3872
    v_fma_f32 v21, v21, v16, v18
    v_fma_f32 v22, v22, v16, v18
    v_fma_f32 v23, v23, v16, v18
    v_cvt_pk_bf16_f32 v212, v20, v21
    v_cvt_pk_bf16_f32 v213, v22, v23
    s_add_u32 s3, s30, 28672
    buffer_load_dwordx4 v[240:243], v9, s[8:11], s3 offen sc1
    s_waitcnt lgkmcnt(4)
    v_mfma_f32_32x32x16_bf16 v[64:79], a[8:11], v[208:211], v[64:79]
    ds_read_b64_tr_b16 a[32:33], v10 offset:3136
    ds_read_b64_tr_b16 a[34:35], v10 offset:3904
    v_lshlrev_b32 v24, 16, v214
    v_and_b32 v25, 0xffff0000, v214
    v_lshlrev_b32 v26, 16, v215
    v_and_b32 v27, 0xffff0000, v215
    v_fma_f32 v24, v24, v16, v18
    s_add_u32 m0, s74, 49152
    s_add_u32 s76, s77, 393216
    buffer_load_dwordx4 v4, s[24:27], s76 offen offset:0 lds
    v_mfma_f32_32x32x16_bf16 v[80:95], a[12:15], v[208:211], v[80:95]
    ds_read_b64_tr_b16 a[36:37], v10 offset:3168
    ds_read_b64_tr_b16 a[38:39], v10 offset:3936
    v_fma_f32 v25, v25, v16, v18
    v_fma_f32 v26, v26, v16, v18
    v_fma_f32 v27, v27, v16, v18
    v_cvt_pk_bf16_f32 v214, v24, v25
    v_cvt_pk_bf16_f32 v215, v26, v27
    buffer_load_dwordx4 v5, s[24:27], s76 offen offset:1024 lds
    s_waitcnt vmcnt(14)
    s_waitcnt lgkmcnt(4)
    v_mfma_f32_32x32x16_bf16 v[32:47], a[24:27], v[212:215], v[32:47]
    ds_read_b64_tr_b16 a[0:1], v10 offset:6144
    ds_read_b64_tr_b16 a[2:3], v10 offset:6912
    v_lshlrev_b32 v20, 16, v216
    v_and_b32 v21, 0xffff0000, v216
    v_lshlrev_b32 v22, 16, v217
    v_and_b32 v23, 0xffff0000, v217
    v_fma_f32 v20, v20, v16, v18
    v_mfma_f32_32x32x16_bf16 v[48:63], a[28:31], v[212:215], v[48:63]
    ds_read_b64_tr_b16 a[4:5], v10 offset:6176
    ds_read_b64_tr_b16 a[6:7], v10 offset:6944
    v_fma_f32 v21, v21, v16, v18
    v_fma_f32 v22, v22, v16, v18
    v_fma_f32 v23, v23, v16, v18
    v_cvt_pk_bf16_f32 v216, v20, v21
    v_cvt_pk_bf16_f32 v217, v22, v23
    s_add_u32 s3, s30, 29696
    buffer_load_dwordx4 v[244:247], v9, s[8:11], s3 offen sc1
    s_waitcnt lgkmcnt(4)
    v_mfma_f32_32x32x16_bf16 v[64:79], a[32:35], v[212:215], v[64:79]
    ds_read_b64_tr_b16 a[8:9], v10 offset:6208
    ds_read_b64_tr_b16 a[10:11], v10 offset:6976
    v_lshlrev_b32 v24, 16, v218
    v_and_b32 v25, 0xffff0000, v218
    v_lshlrev_b32 v26, 16, v219
    v_and_b32 v27, 0xffff0000, v219
    v_fma_f32 v24, v24, v16, v18
    buffer_load_dwordx4 v6, s[24:27], s76 offen offset:2048 lds
    v_mfma_f32_32x32x16_bf16 v[80:95], a[36:39], v[212:215], v[80:95]
    ds_read_b64_tr_b16 a[12:13], v10 offset:6240
    ds_read_b64_tr_b16 a[14:15], v10 offset:7008
    v_fma_f32 v25, v25, v16, v18
    v_fma_f32 v26, v26, v16, v18
    v_fma_f32 v27, v27, v16, v18
    v_cvt_pk_bf16_f32 v218, v24, v25
    v_cvt_pk_bf16_f32 v219, v26, v27
    buffer_load_dwordx4 v7, s[24:27], s76 offen offset:3072 lds
    s_waitcnt vmcnt(14)
    s_waitcnt lgkmcnt(4)
    v_mfma_f32_32x32x16_bf16 v[32:47], a[0:3], v[216:219], v[32:47]
    ds_read_b64_tr_b16 a[24:25], v10 offset:9216
    ds_read_b64_tr_b16 a[26:27], v10 offset:9984
    v_lshlrev_b32 v20, 16, v220
    v_and_b32 v21, 0xffff0000, v220
    v_lshlrev_b32 v22, 16, v221
    v_and_b32 v23, 0xffff0000, v221
    v_fma_f32 v20, v20, v16, v18
    v_mfma_f32_32x32x16_bf16 v[48:63], a[4:7], v[216:219], v[48:63]
    ds_read_b64_tr_b16 a[28:29], v10 offset:9248
    ds_read_b64_tr_b16 a[30:31], v10 offset:10016
    v_fma_f32 v21, v21, v16, v18
    v_fma_f32 v22, v22, v16, v18
    v_fma_f32 v23, v23, v16, v18
    v_cvt_pk_bf16_f32 v220, v20, v21
    v_cvt_pk_bf16_f32 v221, v22, v23
    s_add_u32 s3, s30, 30720
    buffer_load_dwordx4 v[248:251], v9, s[8:11], s3 offen sc1
    s_waitcnt lgkmcnt(4)
    v_mfma_f32_32x32x16_bf16 v[64:79], a[8:11], v[216:219], v[64:79]
    ds_read_b64_tr_b16 a[32:33], v10 offset:9280
    ds_read_b64_tr_b16 a[34:35], v10 offset:10048
    v_lshlrev_b32 v24, 16, v222
    v_and_b32 v25, 0xffff0000, v222
    v_lshlrev_b32 v26, 16, v223
    v_and_b32 v27, 0xffff0000, v223
    v_fma_f32 v24, v24, v16, v18
    s_add_u32 m0, s74, 65536
    s_add_u32 s76, s77, 524288
    buffer_load_dwordx4 v4, s[24:27], s76 offen offset:0 lds
    v_mfma_f32_32x32x16_bf16 v[80:95], a[12:15], v[216:219], v[80:95]
    ds_read_b64_tr_b16 a[36:37], v10 offset:9312
    ds_read_b64_tr_b16 a[38:39], v10 offset:10080
    v_fma_f32 v25, v25, v16, v18
    v_fma_f32 v26, v26, v16, v18
    v_fma_f32 v27, v27, v16, v18
    v_cvt_pk_bf16_f32 v222, v24, v25
    v_cvt_pk_bf16_f32 v223, v26, v27
    buffer_load_dwordx4 v5, s[24:27], s76 offen offset:1024 lds
    v_add_u32 v10, 0, v28
    v_add_u32 v11, 0, v29
    s_waitcnt vmcnt(16)
    s_waitcnt lgkmcnt(4)
    v_mfma_f32_32x32x16_bf16 v[32:47], a[24:27], v[220:223], v[32:47]
    ds_read_b64_tr_b16 a[0:1], v10 offset:0
    ds_read_b64_tr_b16 a[2:3], v10 offset:768
    v_lshlrev_b32 v20, 16, v224
    v_and_b32 v21, 0xffff0000, v224
    v_lshlrev_b32 v22, 16, v225
    v_and_b32 v23, 0xffff0000, v225
    v_fma_f32 v20, v20, v16, v18
    v_mfma_f32_32x32x16_bf16 v[48:63], a[28:31], v[220:223], v[48:63]
    ds_read_b64_tr_b16 a[4:5], v10 offset:32
    ds_read_b64_tr_b16 a[6:7], v10 offset:800
    v_fma_f32 v21, v21, v16, v18
    v_fma_f32 v22, v22, v16, v18
    v_fma_f32 v23, v23, v16, v18
    v_cvt_pk_bf16_f32 v224, v20, v21
    v_cvt_pk_bf16_f32 v225, v22, v23
    s_add_u32 s3, s30, 31744
    buffer_load_dwordx4 v[252:255], v9, s[8:11], s3 offen sc1
    s_waitcnt lgkmcnt(4)
    v_mfma_f32_32x32x16_bf16 v[64:79], a[32:35], v[220:223], v[64:79]
    ds_read_b64_tr_b16 a[8:9], v10 offset:64
    ds_read_b64_tr_b16 a[10:11], v10 offset:832
    v_lshlrev_b32 v24, 16, v226
    v_and_b32 v25, 0xffff0000, v226
    v_lshlrev_b32 v26, 16, v227
    v_and_b32 v27, 0xffff0000, v227
    v_fma_f32 v24, v24, v16, v18
    buffer_load_dwordx4 v6, s[24:27], s76 offen offset:2048 lds
    v_mfma_f32_32x32x16_bf16 v[80:95], a[36:39], v[220:223], v[80:95]
    ds_read_b64_tr_b16 a[12:13], v10 offset:96
    ds_read_b64_tr_b16 a[14:15], v10 offset:864
    v_fma_f32 v25, v25, v16, v18
    v_fma_f32 v26, v26, v16, v18
    v_fma_f32 v27, v27, v16, v18
    v_cvt_pk_bf16_f32 v226, v24, v25
    v_cvt_pk_bf16_f32 v227, v26, v27
    buffer_load_dwordx4 v7, s[24:27], s76 offen offset:3072 lds
    s_barrier
    s_waitcnt vmcnt(17)
    s_waitcnt lgkmcnt(4)
    v_mfma_f32_32x32x16_bf16 v[32:47], a[0:3], v[224:227], v[32:47]
    ds_read_b64_tr_b16 a[24:25], v10 offset:3072
    ds_read_b64_tr_b16 a[26:27], v10 offset:3840
    v_lshlrev_b32 v20, 16, v228
    v_and_b32 v21, 0xffff0000, v228
    v_lshlrev_b32 v22, 16, v229
    v_and_b32 v23, 0xffff0000, v229
    v_fma_f32 v20, v20, v16, v18
    v_mfma_f32_32x32x16_bf16 v[48:63], a[4:7], v[224:227], v[48:63]
    ds_read_b64_tr_b16 a[28:29], v10 offset:3104
    ds_read_b64_tr_b16 a[30:31], v10 offset:3872
    v_fma_f32 v21, v21, v16, v18
    v_fma_f32 v22, v22, v16, v18
    v_fma_f32 v23, v23, v16, v18
    v_cvt_pk_bf16_f32 v228, v20, v21
    v_cvt_pk_bf16_f32 v229, v22, v23
    s_waitcnt lgkmcnt(4)
    v_mfma_f32_32x32x16_bf16 v[64:79], a[8:11], v[224:227], v[64:79]
    ds_read_b64_tr_b16 a[32:33], v10 offset:3136
    ds_read_b64_tr_b16 a[34:35], v10 offset:3904
    v_lshlrev_b32 v24, 16, v230
    v_and_b32 v25, 0xffff0000, v230
    v_lshlrev_b32 v26, 16, v231
    v_and_b32 v27, 0xffff0000, v231
    v_fma_f32 v24, v24, v16, v18
    s_add_u32 m0, s74, 81920
    s_add_u32 s76, s77, 704512
    buffer_load_dwordx4 v4, s[24:27], s76 offen offset:0 lds
    v_mfma_f32_32x32x16_bf16 v[80:95], a[12:15], v[224:227], v[80:95]
    ds_read_b64_tr_b16 a[36:37], v10 offset:3168
    ds_read_b64_tr_b16 a[38:39], v10 offset:3936
    v_fma_f32 v25, v25, v16, v18
    v_fma_f32 v26, v26, v16, v18
    v_fma_f32 v27, v27, v16, v18
    v_cvt_pk_bf16_f32 v230, v24, v25
    v_cvt_pk_bf16_f32 v231, v26, v27
    buffer_load_dwordx4 v5, s[24:27], s76 offen offset:1024 lds
    s_mul_i32 s3, s70, 86
    s_add_u32 s3, s3, s66
    s_lshl_b32 s3, s3, 10
    s_add_u32 s3, s3, 8388608
    v_lshlrev_b32 v13, 7, v0
    s_lshl_b32 s7, s67, 3
    s_bfm_b64 exec, s7, 0
    buffer_load_dword v15, v13, s[8:11], s3 offen
    s_mov_b64 exec, -1
    s_waitcnt vmcnt(18)
    s_waitcnt lgkmcnt(4)
    v_mfma_f32_32x32x16_bf16 v[32:47], a[24:27], v[228:231], v[32:47]
    ds_read_b64_tr_b16 a[0:1], v10 offset:6144
    ds_read_b64_tr_b16 a[2:3], v10 offset:6912
    v_lshlrev_b32 v20, 16, v232
    v_and_b32 v21, 0xffff0000, v232
    v_lshlrev_b32 v22, 16, v233
    v_and_b32 v23, 0xffff0000, v233
    v_fma_f32 v20, v20, v16, v18
    v_mfma_f32_32x32x16_bf16 v[48:63], a[28:31], v[228:231], v[48:63]
    ds_read_b64_tr_b16 a[4:5], v10 offset:6176
    ds_read_b64_tr_b16 a[6:7], v10 offset:6944
    v_fma_f32 v21, v21, v16, v18
    v_fma_f32 v22, v22, v16, v18
    v_fma_f32 v23, v23, v16, v18
    v_cvt_pk_bf16_f32 v232, v20, v21
    v_cvt_pk_bf16_f32 v233, v22, v23
    s_waitcnt lgkmcnt(4)
    v_mfma_f32_32x32x16_bf16 v[64:79], a[32:35], v[228:231], v[64:79]
    ds_read_b64_tr_b16 a[8:9], v10 offset:6208
    ds_read_b64_tr_b16 a[10:11], v10 offset:6976
    v_lshlrev_b32 v24, 16, v234
    v_and_b32 v25, 0xffff0000, v234
    v_lshlrev_b32 v26, 16, v235
    v_and_b32 v27, 0xffff0000, v235
    v_fma_f32 v24, v24, v16, v18
    buffer_load_dwordx4 v6, s[24:27], s76 offen offset:2048 lds
    v_mfma_f32_32x32x16_bf16 v[80:95], a[36:39], v[228:231], v[80:95]
    ds_read_b64_tr_b16 a[12:13], v10 offset:6240
    ds_read_b64_tr_b16 a[14:15], v10 offset:7008
    v_fma_f32 v25, v25, v16, v18
    v_fma_f32 v26, v26, v16, v18
    v_fma_f32 v27, v27, v16, v18
    v_cvt_pk_bf16_f32 v234, v24, v25
    v_cvt_pk_bf16_f32 v235, v26, v27
    buffer_load_dwordx4 v7, s[24:27], s76 offen offset:3072 lds
    s_waitcnt vmcnt(18)
    s_waitcnt lgkmcnt(4)
    v_mfma_f32_32x32x16_bf16 v[32:47], a[0:3], v[232:235], v[32:47]
    ds_read_b64_tr_b16 a[24:25], v10 offset:9216
    ds_read_b64_tr_b16 a[26:27], v10 offset:9984
    v_lshlrev_b32 v20, 16, v236
    v_and_b32 v21, 0xffff0000, v236
    v_lshlrev_b32 v22, 16, v237
    v_and_b32 v23, 0xffff0000, v237
    v_fma_f32 v20, v20, v16, v18
    v_mfma_f32_32x32x16_bf16 v[48:63], a[4:7], v[232:235], v[48:63]
    ds_read_b64_tr_b16 a[28:29], v10 offset:9248
    ds_read_b64_tr_b16 a[30:31], v10 offset:10016
    v_fma_f32 v21, v21, v16, v18
    v_fma_f32 v22, v22, v16, v18
    v_fma_f32 v23, v23, v16, v18
    v_cvt_pk_bf16_f32 v236, v20, v21
    v_cvt_pk_bf16_f32 v237, v22, v23
    s_waitcnt lgkmcnt(4)
    v_mfma_f32_32x32x16_bf16 v[64:79], a[8:11], v[232:235], v[64:79]
    ds_read_b64_tr_b16 a[32:33], v10 offset:9280
    ds_read_b64_tr_b16 a[34:35], v10 offset:10048
    v_lshlrev_b32 v24, 16, v238
    v_and_b32 v25, 0xffff0000, v238
    v_lshlrev_b32 v26, 16, v239
    v_and_b32 v27, 0xffff0000, v239
    v_fma_f32 v24, v24, v16, v18
    s_add_u32 m0, s74, 98304
    s_add_u32 s76, s77, 835584
    buffer_load_dwordx4 v4, s[24:27], s76 offen offset:0 lds
    v_mfma_f32_32x32x16_bf16 v[80:95], a[12:15], v[232:235], v[80:95]
    ds_read_b64_tr_b16 a[36:37], v10 offset:9312
    ds_read_b64_tr_b16 a[38:39], v10 offset:10080
    v_fma_f32 v25, v25, v16, v18
    v_fma_f32 v26, v26, v16, v18
    v_fma_f32 v27, v27, v16, v18
    v_cvt_pk_bf16_f32 v238, v24, v25
    v_cvt_pk_bf16_f32 v239, v26, v27
    buffer_load_dwordx4 v5, s[24:27], s76 offen offset:1024 lds
    v_add_u32 v10, 24576, v28
    v_add_u32 v11, 24576, v29
    s_waitcnt vmcnt(18)
    s_waitcnt lgkmcnt(4)
    v_mfma_f32_32x32x16_bf16 v[32:47], a[24:27], v[236:239], v[32:47]
    ds_read_b64_tr_b16 a[0:1], v10 offset:0
    ds_read_b64_tr_b16 a[2:3], v10 offset:768
    v_lshlrev_b32 v20, 16, v240
    v_and_b32 v21, 0xffff0000, v240
    v_lshlrev_b32 v22, 16, v241
    v_and_b32 v23, 0xffff0000, v241
    v_fma_f32 v20, v20, v16, v18
    v_mfma_f32_32x32x16_bf16 v[48:63], a[28:31], v[236:239], v[48:63]
    ds_read_b64_tr_b16 a[4:5], v10 offset:32
    ds_read_b64_tr_b16 a[6:7], v10 offset:800
    v_fma_f32 v21, v21, v16, v18
    v_fma_f32 v22, v22, v16, v18
    v_fma_f32 v23, v23, v16, v18
    v_cvt_pk_bf16_f32 v240, v20, v21
    v_cvt_pk_bf16_f32 v241, v22, v23
    s_waitcnt lgkmcnt(4)
    v_mfma_f32_32x32x16_bf16 v[64:79], a[32:35], v[236:239], v[64:79]
    ds_read_b64_tr_b16 a[8:9], v10 offset:64
    ds_read_b64_tr_b16 a[10:11], v10 offset:832
    v_lshlrev_b32 v24, 16, v242
    v_and_b32 v25, 0xffff0000, v242
    v_lshlrev_b32 v26, 16, v243
    v_and_b32 v27, 0xffff0000, v243
    v_fma_f32 v24, v24, v16, v18
    buffer_load_dwordx4 v6, s[24:27], s76 offen offset:2048 lds
    v_mfma_f32_32x32x16_bf16 v[80:95], a[36:39], v[236:239], v[80:95]
    ds_read_b64_tr_b16 a[12:13], v10 offset:96
    ds_read_b64_tr_b16 a[14:15], v10 offset:864
    v_fma_f32 v25, v25, v16, v18
    v_fma_f32 v26, v26, v16, v18
    v_fma_f32 v27, v27, v16, v18
    v_cvt_pk_bf16_f32 v242, v24, v25
    v_cvt_pk_bf16_f32 v243, v26, v27
    buffer_load_dwordx4 v7, s[24:27], s76 offen offset:3072 lds
    s_waitcnt vmcnt(17)
    s_waitcnt lgkmcnt(4)
    v_mfma_f32_32x32x16_bf16 v[32:47], a[0:3], v[240:243], v[32:47]
    ds_read_b64_tr_b16 a[24:25], v10 offset:3072
    ds_read_b64_tr_b16 a[26:27], v10 offset:3840
    v_lshlrev_b32 v20, 16, v244
    v_and_b32 v21, 0xffff0000, v244
    v_lshlrev_b32 v22, 16, v245
    v_and_b32 v23, 0xffff0000, v245
    v_fma_f32 v20, v20, v16, v18
    v_mfma_f32_32x32x16_bf16 v[48:63], a[4:7], v[240:243], v[48:63]
    ds_read_b64_tr_b16 a[28:29], v10 offset:3104
    ds_read_b64_tr_b16 a[30:31], v10 offset:3872
    v_fma_f32 v21, v21, v16, v18
    v_fma_f32 v22, v22, v16, v18
    v_fma_f32 v23, v23, v16, v18
    v_cvt_pk_bf16_f32 v244, v20, v21
    v_cvt_pk_bf16_f32 v245, v22, v23
    s_waitcnt lgkmcnt(4)
    v_mfma_f32_32x32x16_bf16 v[64:79], a[8:11], v[240:243], v[64:79]
    ds_read_b64_tr_b16 a[32:33], v10 offset:3136
    ds_read_b64_tr_b16 a[34:35], v10 offset:3904
    v_lshlrev_b32 v24, 16, v246
    v_and_b32 v25, 0xffff0000, v246
    v_lshlrev_b32 v26, 16, v247
    v_and_b32 v27, 0xffff0000, v247
    v_fma_f32 v24, v24, v16, v18
    s_add_u32 m0, s74, 114688
    s_add_u32 s76, s77, 966656
    buffer_load_dwordx4 v4, s[24:27], s76 offen offset:0 lds
    v_mfma_f32_32x32x16_bf16 v[80:95], a[12:15], v[240:243], v[80:95]
    ds_read_b64_tr_b16 a[36:37], v10 offset:3168
    ds_read_b64_tr_b16 a[38:39], v10 offset:3936
    v_fma_f32 v25, v25, v16, v18
    v_fma_f32 v26, v26, v16, v18
    v_fma_f32 v27, v27, v16, v18
    v_cvt_pk_bf16_f32 v246, v24, v25
    v_cvt_pk_bf16_f32 v247, v26, v27
    buffer_load_dwordx4 v5, s[24:27], s76 offen offset:1024 lds
    s_waitcnt vmcnt(16)
    s_waitcnt lgkmcnt(4)
    v_mfma_f32_32x32x16_bf16 v[32:47], a[24:27], v[244:247], v[32:47]
    ds_read_b64_tr_b16 a[0:1], v10 offset:6144
    ds_read_b64_tr_b16 a[2:3], v10 offset:6912
    v_lshlrev_b32 v20, 16, v248
    v_and_b32 v21, 0xffff0000, v248
    v_lshlrev_b32 v22, 16, v249
    v_and_b32 v23, 0xffff0000, v249
    v_fma_f32 v20, v20, v16, v18
    v_mfma_f32_32x32x16_bf16 v[48:63], a[28:31], v[244:247], v[48:63]
    ds_read_b64_tr_b16 a[4:5], v10 offset:6176
    ds_read_b64_tr_b16 a[6:7], v10 offset:6944
    v_fma_f32 v21, v21, v16, v18
    v_fma_f32 v22, v22, v16, v18
    v_fma_f32 v23, v23, v16, v18
    v_cvt_pk_bf16_f32 v248, v20, v21
    v_cvt_pk_bf16_f32 v249, v22, v23
    s_waitcnt lgkmcnt(4)
    v_mfma_f32_32x32x16_bf16 v[64:79], a[32:35], v[244:247], v[64:79]
    ds_read_b64_tr_b16 a[8:9], v10 offset:6208
    ds_read_b64_tr_b16 a[10:11], v10 offset:6976
    v_lshlrev_b32 v24, 16, v250
    v_and_b32 v25, 0xffff0000, v250
    v_lshlrev_b32 v26, 16, v251
    v_and_b32 v27, 0xffff0000, v251
    v_fma_f32 v24, v24, v16, v18
    buffer_load_dwordx4 v6, s[24:27], s76 offen offset:2048 lds
    v_mfma_f32_32x32x16_bf16 v[80:95], a[36:39], v[244:247], v[80:95]
    ds_read_b64_tr_b16 a[12:13], v10 offset:6240
    ds_read_b64_tr_b16 a[14:15], v10 offset:7008
    v_fma_f32 v25, v25, v16, v18
    v_fma_f32 v26, v26, v16, v18
    v_fma_f32 v27, v27, v16, v18
    v_cvt_pk_bf16_f32 v250, v24, v25
    v_cvt_pk_bf16_f32 v251, v26, v27
    buffer_load_dwordx4 v7, s[24:27], s76 offen offset:3072 lds
    s_waitcnt vmcnt(15)
    s_waitcnt lgkmcnt(4)
    v_mfma_f32_32x32x16_bf16 v[32:47], a[0:3], v[248:251], v[32:47]
    ds_read_b64_tr_b16 a[24:25], v10 offset:9216
    ds_read_b64_tr_b16 a[26:27], v10 offset:9984
    v_lshlrev_b32 v20, 16, v252
    v_and_b32 v21, 0xffff0000, v252
    v_lshlrev_b32 v22, 16, v253
    v_and_b32 v23, 0xffff0000, v253
    v_fma_f32 v20, v20, v16, v18
    v_mfma_f32_32x32x16_bf16 v[48:63], a[4:7], v[248:251], v[48:63]
    ds_read_b64_tr_b16 a[28:29], v10 offset:9248
    ds_read_b64_tr_b16 a[30:31], v10 offset:10016
    v_fma_f32 v21, v21, v16, v18
    v_fma_f32 v22, v22, v16, v18
    v_fma_f32 v23, v23, v16, v18
    v_cvt_pk_bf16_f32 v252, v20, v21
    v_cvt_pk_bf16_f32 v253, v22, v23
    s_waitcnt lgkmcnt(4)
    v_mfma_f32_32x32x16_bf16 v[64:79], a[8:11], v[248:251], v[64:79]
    ds_read_b64_tr_b16 a[32:33], v10 offset:9280
    ds_read_b64_tr_b16 a[34:35], v10 offset:10048
    v_lshlrev_b32 v24, 16, v254
    v_and_b32 v25, 0xffff0000, v254
    v_lshlrev_b32 v26, 16, v255
    v_and_b32 v27, 0xffff0000, v255
    v_fma_f32 v24, v24, v16, v18
    s_add_u32 m0, s74, 131072
    s_add_u32 s76, s77, 1097728
    buffer_load_dwordx4 v4, s[24:27], s76 offen offset:0 lds
    v_mfma_f32_32x32x16_bf16 v[80:95], a[12:15], v[248:251], v[80:95]
    ds_read_b64_tr_b16 a[36:37], v10 offset:9312
    ds_read_b64_tr_b16 a[38:39], v10 offset:10080
    v_fma_f32 v25, v25, v16, v18
    v_fma_f32 v26, v26, v16, v18
    v_fma_f32 v27, v27, v16, v18
    v_cvt_pk_bf16_f32 v254, v24, v25
    v_cvt_pk_bf16_f32 v255, v26, v27
    buffer_load_dwordx4 v5, s[24:27], s76 offen offset:1024 lds
    s_waitcnt lgkmcnt(4)
    v_mfma_f32_32x32x16_bf16 v[32:47], a[24:27], v[252:255], v[32:47]
    v_mfma_f32_32x32x16_bf16 v[48:63], a[28:31], v[252:255], v[48:63]
    s_waitcnt lgkmcnt(0)
    v_mfma_f32_32x32x16_bf16 v[64:79], a[32:35], v[252:255], v[64:79]
    buffer_load_dwordx4 v6, s[24:27], s76 offen offset:2048 lds
    v_mfma_f32_32x32x16_bf16 v[80:95], a[36:39], v[252:255], v[80:95]
    buffer_load_dwordx4 v7, s[24:27], s76 offen offset:3072 lds
F1L_end:
    s_mov_b32 s72, 0xbdd2d3e8
    s_mov_b32 s73, s72
    v_mov_b32 v28, 0xc0135761
    v_mov_b32 v29, v28
    v_mov_b32 v30, 1.0
    v_mov_b32 v31, 1.0
    s_mul_i32 s30, s70, 86
    s_add_u32 s30, s30, s66
    s_lshl_b32 s30, s30, 10
    s_add_u32 s30, s30, 8388608
    s_barrier
    v_pk_mul_f32 v[16:17], v[32:33], v[32:33]
    v_pk_mul_f32 v[18:19], v[34:35], v[34:35]
    v_pk_mul_f32 v[20:21], v[36:37], v[36:37]
    v_pk_mul_f32 v[22:23], v[38:39], v[38:39]
    v_pk_fma_f32 v[16:17], v[16:17], s[72:73], v[28:29]
    v_pk_fma_f32 v[18:19], v[18:19], s[72:73], v[28:29]
    v_pk_fma_f32 v[20:21], v[20:21], s[72:73], v[28:29]
    v_pk_fma_f32 v[22:23], v[22:23], s[72:73], v[28:29]
    v_pk_mul_f32 v[16:17], v[16:17], v[32:33]
    v_pk_mul_f32 v[18:19], v[18:19], v[34:35]
    v_pk_mul_f32 v[20:21], v[20:21], v[36:37]
    v_pk_mul_f32 v[22:23], v[22:23], v[38:39]
    v_exp_f32 v16, v16
    v_exp_f32 v17, v17
    s_add_u32 m0, s74, 0
    s_add_u32 s76, s77, 0
    buffer_load_dwordx4 v4, s[24:27], s76 offen offset:0 lds
    v_exp_f32 v18, v18
    v_exp_f32 v19, v19
    v_exp_f32 v20, v20
    v_exp_f32 v21, v21
    v_exp_f32 v22, v22
    v_exp_f32 v23, v23
    v_pk_mul_f32 v[32:33], v[32:33], v[40:41]
    v_pk_mul_f32 v[34:35], v[34:35], v[42:43]
    v_pk_mul_f32 v[36:37], v[36:37], v[44:45]
    v_pk_mul_f32 v[38:39], v[38:39], v[46:47]
    v_pk_add_f32 v[16:17], v[16:17], v[30:31]
    v_pk_add_f32 v[18:19], v[18:19], v[30:31]
    v_pk_add_f32 v[20:21], v[20:21], v[30:31]
    v_pk_add_f32 v[22:23], v[22:23], v[30:31]
    buffer_load_dwordx4 v5, s[24:27], s76 offen offset:1024 lds
    v_rcp_f32 v16, v16
    v_rcp_f32 v17, v17
    v_rcp_f32 v18, v18
    v_rcp_f32 v19, v19
    v_rcp_f32 v20, v20
    v_rcp_f32 v21, v21
    v_rcp_f32 v22, v22
    v_rcp_f32 v23, v23
    v_pk_mul_f32 v[16:17], v[16:17], v[32:33]
    v_pk_mul_f32 v[18:19], v[18:19], v[34:35]
    v_pk_mul_f32 v[20:21], v[20:21], v[36:37]
    v_pk_mul_f32 v[22:23], v[22:23], v[38:39]
    v_cvt_pk_bf16_f32 v24, v16, v17
    v_cvt_pk_bf16_f32 v25, v18, v19
    buffer_load_dwordx4 v6, s[24:27], s76 offen offset:2048 lds
    v_cvt_pk_bf16_f32 v26, v20, v21
    v_cvt_pk_bf16_f32 v27, v22, v23
    s_cmp_lg_u32 s43, 0
    s_cbranch_scc1 HST_5
    buffer_store_dwordx4 v[24:27], v9, s[8:11], s30 offen offset:0
HSB_5:
    v_pk_mul_f32 v[16:17], v[48:49], v[48:49]
    v_pk_mul_f32 v[18:19], v[50:51], v[50:51]
    v_pk_mul_f32 v[20:21], v[52:53], v[52:53]
    v_pk_mul_f32 v[22:23], v[54:55], v[54:55]
    v_pk_fma_f32 v[16:17], v[16:17], s[72:73], v[28:29]
    v_pk_fma_f32 v[18:19], v[18:19], s[72:73], v[28:29]
    v_pk_fma_f32 v[20:21], v[20:21], s[72:73], v[28:29]
    v_pk_fma_f32 v[22:23], v[22:23], s[72:73], v[28:29]
    v_pk_mul_f32 v[16:17], v[16:17], v[48:49]
    v_pk_mul_f32 v[18:19], v[18:19], v[50:51]
    v_pk_mul_f32 v[20:21], v[20:21], v[52:53]
    v_pk_mul_f32 v[22:23], v[22:23], v[54:55]
    v_exp_f32 v16, v16
    v_exp_f32 v17, v17
    buffer_load_dwordx4 v7, s[24:27], s76 offen offset:3072 lds
    v_exp_f32 v18, v18
    v_exp_f32 v19, v19
    v_exp_f32 v20, v20
    v_exp_f32 v21, v21
    v_exp_f32 v22, v22
    v_exp_f32 v23, v23
    v_pk_mul_f32 v[48:49], v[48:49], v[56:57]
    v_pk_mul_f32 v[50:51], v[50:51], v[58:59]
    v_pk_mul_f32 v[52:53], v[52:53], v[60:61]
    v_pk_mul_f32 v[54:55], v[54:55], v[62:63]
    v_pk_add_f32 v[16:17], v[16:17], v[30:31]
    v_pk_add_f32 v[18:19], v[18:19], v[30:31]
    v_pk_add_f32 v[20:21], v[20:21], v[30:31]
    v_pk_add_f32 v[22:23], v[22:23], v[30:31]
    s_add_u32 m0, s74, 16384
    s_add_u32 s76, s77, 131072
    buffer_load_dwordx4 v4, s[24:27], s76 offen offset:0 lds
    v_rcp_f32 v16, v16
    v_rcp_f32 v17, v17
    v_rcp_f32 v18, v18
    v_rcp_f32 v19, v19
    v_rcp_f32 v20, v20
    v_rcp_f32 v21, v21
    v_rcp_f32 v22, v22
    v_rcp_f32 v23, v23
    v_pk_mul_f32 v[16:17], v[16:17], v[48:49]
    v_pk_mul_f32 v[18:19], v[18:19], v[50:51]
    v_pk_mul_f32 v[20:21], v[20:21], v[52:53]
    v_pk_mul_f32 v[22:23], v[22:23], v[54:55]
    v_cvt_pk_bf16_f32 v24, v16, v17
    v_cvt_pk_bf16_f32 v25, v18, v19
    buffer_load_dwordx4 v5, s[24:27], s76 offen offset:1024 lds
    v_cvt_pk_bf16_f32 v26, v20, v21
    v_cvt_pk_bf16_f32 v27, v22, v23
    s_cmp_lg_u32 s43, 0
    s_cbranch_scc1 HST_6
    buffer_store_dwordx4 v[24:27], v9, s[8:11], s30 offen offset:1024
HSB_6:
    v_pk_mul_f32 v[16:17], v[64:65], v[64:65]
    v_pk_mul_f32 v[18:19], v[66:67], v[66:67]
    v_pk_mul_f32 v[20:21], v[68:69], v[68:69]
    v_pk_mul_f32 v[22:23], v[70:71], v[70:71]
    v_pk_fma_f32 v[16:17], v[16:17], s[72:73], v[28:29]
    v_pk_fma_f32 v[18:19], v[18:19], s[72:73], v[28:29]
    v_pk_fma_f32 v[20:21], v[20:21], s[72:73], v[28:29]
    v_pk_fma_f32 v[22:23], v[22:23], s[72:73], v[28:29]
    v_pk_mul_f32 v[16:17], v[16:17], v[64:65]
    v_pk_mul_f32 v[18:19], v[18:19], v[66:67]
    v_pk_mul_f32 v[20:21], v[20:21], v[68:69]
    v_pk_mul_f32 v[22:23], v[22:23], v[70:71]
    v_exp_f32 v16, v16
    v_exp_f32 v17, v17
    buffer_load_dwordx4 v6, s[24:27], s76 offen offset:2048 lds
    v_exp_f32 v18, v18
    v_exp_f32 v19, v19
    v_exp_f32 v20, v20
    v_exp_f32 v21, v21
    v_exp_f32 v22, v22
    v_exp_f32 v23, v23
    v_pk_mul_f32 v[64:65], v[64:65], v[72:73]
    v_pk_mul_f32 v[66:67], v[66:67], v[74:75]
    v_pk_mul_f32 v[68:69], v[68:69], v[76:77]
    v_pk_mul_f32 v[70:71], v[70:71], v[78:79]
    v_pk_add_f32 v[16:17], v[16:17], v[30:31]
    v_pk_add_f32 v[18:19], v[18:19], v[30:31]
    v_pk_add_f32 v[20:21], v[20:21], v[30:31]
    v_pk_add_f32 v[22:23], v[22:23], v[30:31]
    buffer_load_dwordx4 v7, s[24:27], s76 offen offset:3072 lds
    v_rcp_f32 v16, v16
    v_rcp_f32 v17, v17
    v_rcp_f32 v18, v18
    v_rcp_f32 v19, v19
    v_rcp_f32 v20, v20
    v_rcp_f32 v21, v21
    v_rcp_f32 v22, v22
    v_rcp_f32 v23, v23
    v_pk_mul_f32 v[16:17], v[16:17], v[64:65]
    v_pk_mul_f32 v[18:19], v[18:19], v[66:67]
    v_pk_mul_f32 v[20:21], v[20:21], v[68:69]
    v_pk_mul_f32 v[22:23], v[22:23], v[70:71]
    v_cvt_pk_bf16_f32 v24, v16, v17
    v_cvt_pk_bf16_f32 v25, v18, v19
    s_add_u32 m0, s74, 32768
    s_add_u32 s76, s77, 262144
    buffer_load_dwordx4 v4, s[24:27], s76 offen offset:0 lds
    v_cvt_pk_bf16_f32 v26, v20, v21
    v_cvt_pk_bf16_f32 v27, v22, v23
    s_cmp_lg_u32 s43, 0
    s_cbranch_scc1 HST_7
    buffer_store_dwordx4 v[24:27], v9, s[8:11], s30 offen offset:2048
HSB_7:
    v_pk_mul_f32 v[16:17], v[80:81], v[80:81]
    v_pk_mul_f32 v[18:19], v[82:83], v[82:83]
    v_pk_mul_f32 v[20:21], v[84:85], v[84:85]
    v_pk_mul_f32 v[22:23], v[86:87], v[86:87]
    v_pk_fma_f32 v[16:17], v[16:17], s[72:73], v[28:29]
    v_pk_fma_f32 v[18:19], v[18:19], s[72:73], v[28:29]
    v_pk_fma_f32 v[20:21], v[20:21], s[72:73], v[28:29]
    v_pk_fma_f32 v[22:23], v[22:23], s[72:73], v[28:29]
    v_pk_mul_f32 v[16:17], v[16:17], v[80:81]
    v_pk_mul_f32 v[18:19], v[18:19], v[82:83]
    v_pk_mul_f32 v[20:21], v[20:21], v[84:85]
    v_pk_mul_f32 v[22:23], v[22:23], v[86:87]
    v_exp_f32 v16, v16
    v_exp_f32 v17, v17
    buffer_load_dwordx4 v5, s[24:27], s76 offen offset:1024 lds
    v_exp_f32 v18, v18
    v_exp_f32 v19, v19
    v_exp_f32 v20, v20
    v_exp_f32 v21, v21
    v_exp_f32 v22, v22
    v_exp_f32 v23, v23
    v_pk_mul_f32 v[80:81], v[80:81], v[88:89]
    v_pk_mul_f32 v[82:83], v[82:83], v[90:91]
    v_pk_mul_f32 v[84:85], v[84:85], v[92:93]
    v_pk_mul_f32 v[86:87], v[86:87], v[94:95]
    v_pk_add_f32 v[16:17], v[16:17], v[30:31]
    v_pk_add_f32 v[18:19], v[18:19], v[30:31]
    v_pk_add_f32 v[20:21], v[20:21], v[30:31]
    v_pk_add_f32 v[22:23], v[22:23], v[30:31]
    buffer_load_dwordx4 v6, s[24:27], s76 offen offset:2048 lds
    v_rcp_f32 v16, v16
    v_rcp_f32 v17, v17
    v_rcp_f32 v18, v18
    v_rcp_f32 v19, v19
    v_rcp_f32 v20, v20
    v_rcp_f32 v21, v21
    v_rcp_f32 v22, v22
    v_rcp_f32 v23, v23
    v_pk_mul_f32 v[16:17], v[16:17], v[80:81]
    v_pk_mul_f32 v[18:19], v[18:19], v[82:83]
    v_pk_mul_f32 v[20:21], v[20:21], v[84:85]
    v_pk_mul_f32 v[22:23], v[22:23], v[86:87]
    v_cvt_pk_bf16_f32 v24, v16, v17
    v_cvt_pk_bf16_f32 v25, v18, v19
    buffer_load_dwordx4 v7, s[24:27], s76 offen offset:3072 lds
    v_cvt_pk_bf16_f32 v26, v20, v21
    v_cvt_pk_bf16_f32 v27, v22, v23
    s_cmp_lg_u32 s43, 0
    s_cbranch_scc1 HST_8
    buffer_store_dwordx4 v[24:27], v9, s[8:11], s30 offen offset:3072
HSB_8:
    s_add_u32 s30, s30, 4096
    s_cmp_eq_u32 s67, 4
    s_cbranch_scc1 F1_four
    v_pk_mul_f32 v[16:17], v[96:97], v[96:97]
    v_pk_mul_f32 v[18:19], v[98:99], v[98:99]
    v_pk_mul_f32 v[20:21], v[100:101], v[100:101]
    v_pk_mul_f32 v[22:23], v[102:103], v[102:103]
    v_pk_fma_f32 v[16:17], v[16:17], s[72:73], v[28:29]
    v_pk_fma_f32 v[18:19], v[18:19], s[72:73], v[28:29]
    v_pk_fma_f32 v[20:21], v[20:21], s[72:73], v[28:29]
    v_pk_fma_f32 v[22:23], v[22:23], s[72:73], v[28:29]
    v_pk_mul_f32 v[16:17], v[16:17], v[96:97]
    v_pk_mul_f32 v[18:19], v[18:19], v[98:99]
    v_pk_mul_f32 v[20:21], v[20:21], v[100:101]
    v_pk_mul_f32 v[22:23], v[22:23], v[102:103]
    v_exp_f32 v16, v16
    v_exp_f32 v17, v17
    v_exp_f32 v18, v18
    v_exp_f32 v19, v19
    v_exp_f32 v20, v20
    v_exp_f32 v21, v21
    v_exp_f32 v22, v22
    v_exp_f32 v23, v23
    v_pk_mul_f32 v[96:97], v[96:97], v[104:105]
    v_pk_mul_f32 v[98:99], v[98:99], v[106:107]
    v_pk_mul_f32 v[100:101], v[100:101], v[108:109]
    v_pk_mul_f32 v[102:103], v[102:103], v[110:111]
    v_pk_add_f32 v[16:17], v[16:17], v[30:31]
    v_pk_add_f32 v[18:19], v[18:19], v[30:31]
    v_pk_add_f32 v[20:21], v[20:21], v[30:31]
    v_pk_add_f32 v[22:23], v[22:23], v[30:31]
    v_rcp_f32 v16, v16
    v_rcp_f32 v17, v17
    v_rcp_f32 v18, v18
    v_rcp_f32 v19, v19
    v_rcp_f32 v20, v20
    v_rcp_f32 v21, v21
    v_rcp_f32 v22, v22
    v_rcp_f32 v23, v23
    v_pk_mul_f32 v[16:17], v[16:17], v[96:97]
    v_pk_mul_f32 v[18:19], v[18:19], v[98:99]
    v_pk_mul_f32 v[20:21], v[20:21], v[100:101]
    v_pk_mul_f32 v[22:23], v[22:23], v[102:103]
    v_cvt_pk_bf16_f32 v24, v16, v17
    v_cvt_pk_bf16_f32 v25, v18, v19
    v_cvt_pk_bf16_f32 v26, v20, v21
    v_cvt_pk_bf16_f32 v27, v22, v23
    s_cmp_lg_u32 s43, 0
    s_cbranch_scc1 HST_9
    buffer_store_dwordx4 v[24:27], v9, s[8:11], s30 offen offset:0
HSB_9:
    v_pk_mul_f32 v[16:17], v[112:113], v[112:113]
    v_pk_mul_f32 v[18:19], v[114:115], v[114:115]
    v_pk_mul_f32 v[20:21], v[116:117], v[116:117]
    v_pk_mul_f32 v[22:23], v[118:119], v[118:119]
    v_pk_fma_f32 v[16:17], v[16:17], s[72:73], v[28:29]
    v_pk_fma_f32 v[18:19], v[18:19], s[72:73], v[28:29]
    v_pk_fma_f32 v[20:21], v[20:21], s[72:73], v[28:29]
    v_pk_fma_f32 v[22:23], v[22:23], s[72:73], v[28:29]
    v_pk_mul_f32 v[16:17], v[16:17], v[112:113]
    v_pk_mul_f32 v[18:19], v[18:19], v[114:115]
    v_pk_mul_f32 v[20:21], v[20:21], v[116:117]
    v_pk_mul_f32 v[22:23], v[22:23], v[118:119]
    v_exp_f32 v16, v16
    v_exp_f32 v17, v17
    v_exp_f32 v18, v18
    v_exp_f32 v19, v19
    v_exp_f32 v20, v20
    v_exp_f32 v21, v21
    v_exp_f32 v22, v22
    v_exp_f32 v23, v23
    v_pk_mul_f32 v[112:113], v[112:113], v[120:121]
    v_pk_mul_f32 v[114:115], v[114:115], v[122:123]
    v_pk_mul_f32 v[116:117], v[116:117], v[124:125]
    v_pk_mul_f32 v[118:119], v[118:119], v[126:127]
    v_pk_add_f32 v[16:17], v[16:17], v[30:31]
    v_pk_add_f32 v[18:19], v[18:19], v[30:31]
    v_pk_add_f32 v[20:21], v[20:21], v[30:31]
    v_pk_add_f32 v[22:23], v[22:23], v[30:31]
    v_rcp_f32 v16, v16
    v_rcp_f32 v17, v17
    v_rcp_f32 v18, v18
    v_rcp_f32 v19, v19
    v_rcp_f32 v20, v20
    v_rcp_f32 v21, v21
    v_rcp_f32 v22, v22
    v_rcp_f32 v23, v23
    v_pk_mul_f32 v[16:17], v[16:17], v[112:113]
    v_pk_mul_f32 v[18:19], v[18:19], v[114:115]
    v_pk_mul_f32 v[20:21], v[20:21], v[116:117]
    v_pk_mul_f32 v[22:23], v[22:23], v[118:119]
    v_cvt_pk_bf16_f32 v24, v16, v17
    v_cvt_pk_bf16_f32 v25, v18, v19
    v_cvt_pk_bf16_f32 v26, v20, v21
    v_cvt_pk_bf16_f32 v27, v22, v23
    s_cmp_lg_u32 s43, 0
    s_cbranch_scc1 HST_10
    buffer_store_dwordx4 v[24:27], v9, s[8:11], s30 offen offset:1024
HSB_10:
    s_branch F1_done
F1_four:
F1_done:
    s_lshl_b32 s3, s4, 7
    s_lshl_b32 s7, s5, 4
    s_add_u32 s3, s3, s7
    s_lshl_b32 s7, s6, 2
    s_add_u32 s3, s3, s7
    s_add_u32 s3, s3, 2334720
    s_waitcnt vmcnt(0)
    v_mov_b32 v12, 1
    v_mov_b32 v13, 0
    s_mov_b64 exec, 1
    s_cmp_lg_u32 s43, 0
    s_cbranch_scc1 HST_11
    buffer_store_dword v12, v13, s[8:11], s3 offen
HSB_11:
    s_mov_b64 exec, -1
    s_mov_b32 s16, s48
    s_mov_b32 s17, s49
    s_mov_b32 s18, 0x00158000
    s_mov_b32 s19, 0x20000
    s_mov_b32 s24, s50
    s_mov_b32 s25, s51
    s_mov_b32 s26, 0x00200000
    s_mov_b32 s27, 0x20000
    v_lshrrev_b32 v11, 4, v0
    v_bfe_u32 v12, v0, 2, 2
    v_and_b32 v13, 3, v0
    v_lshrrev_b32 v14, 1, v11
    v_lshl_add_u32 v14, v14, 3, v12
    v_and_b32 v15, 1, v11
    v_and_b32 v96, 1, v13
    v_lshlrev_b32 v96, 4, v96
    v_lshrrev_b32 v97, 1, v13
    v_lshl_add_u32 v96, v97, 3, v96
    s_and_b32 s3, s6, 1
    s_lshl_b32 s3, s3, 2
    v_and_b32 v97, 1, v13
    v_lshl_add_u32 v97, v15, 1, v97
    v_add_u32 v97, s3, v97
    v_lshrrev_b32 v98, 1, v12
    v_lshlrev_b32 v98, 2, v98
    v_xor_b32 v97, v97, v98
    v_lshlrev_b32 v97, 4, v97
    v_lshrrev_b32 v98, 1, v13
    v_lshl_add_u32 v97, v98, 3, v97
    v_lshl_add_u32 v97, v14, 7, v97
    v_add_u32 v10, 0, v97
    s_and_b32 s3, s6, 1
    s_mul_i32 s3, s3, 81920
    v_add_u32 v10, s3, v10
    v_xor_b32 v11, 64, v10
    v_add_u32 v14, 49152, v10
    v_add_u32 v15, 49152, v11
    v_accvgpr_read_b32 v52, a248
    v_accvgpr_read_b32 v53, a249
    v_accvgpr_read_b32 v54, a250
    v_accvgpr_read_b32 v55, a251
    v_accvgpr_read_b32 v56, a252
    v_accvgpr_read_b32 v57, a253
    v_accvgpr_read_b32 v58, a254
    v_accvgpr_read_b32 v59, a255
    v_lshlrev_b32 v64, 16, v52
    v_and_b32 v65, 0xffff0000, v52
    v_lshlrev_b32 v66, 16, v53
    v_and_b32 v67, 0xffff0000, v53
    v_lshlrev_b32 v68, 16, v54
    v_and_b32 v69, 0xffff0000, v54
    v_lshlrev_b32 v70, 16, v55
    v_and_b32 v71, 0xffff0000, v55
    v_lshlrev_b32 v72, 16, v56
    v_and_b32 v73, 0xffff0000, v56
    v_lshlrev_b32 v74, 16, v57
    v_and_b32 v75, 0xffff0000, v57
    v_lshlrev_b32 v76, 16, v58
    v_and_b32 v77, 0xffff0000, v58
    v_lshlrev_b32 v78, 16, v59
    v_and_b32 v79, 0xffff0000, v59
    s_barrier
    ds_read_b64_tr_b16 v[16:17], v10 offset:0
    ds_read_b64_tr_b16 v[18:19], v10 offset:512
    ds_read_b64_tr_b16 v[20:21], v11 offset:0
    ds_read_b64_tr_b16 v[22:23], v11 offset:512
    ds_read_b64_tr_b16 v[24:25], v10 offset:2048
    ds_read_b64_tr_b16 v[26:27], v10 offset:2560
    ds_read_b64_tr_b16 v[28:29], v11 offset:2048
    ds_read_b64_tr_b16 v[30:31], v11 offset:2560
    ds_read_b64_tr_b16 v[32:33], v10 offset:4096
    ds_read_b64_tr_b16 v[34:35], v10 offset:4608
    ds_read_b64_tr_b16 v[36:37], v11 offset:4096
    ds_read_b64_tr_b16 v[38:39], v11 offset:4608
    s_and_b32 s7, s6, 1
    s_mul_i32 s3, s7, 3
    s_lshl_b32 s76, s3, 13
    s_add_u32 s76, s76, s75
    s_add_u32 s76, s76, 655360
    s_lshl_b32 s77, s3, 10
    s_lshr_b32 s3, s6, 1
    s_mul_i32 s3, s3, 81920
    s_add_u32 s77, s77, s3
    s_mul_i32 s31, s61, 86
    s_and_b32 s3, s6, 1
    s_mul_i32 s3, s3, 43
    s_add_u32 s31, s31, s3
    s_lshl_b32 s31, s31, 10
    s_add_u32 s31, s31, 8388608
    v_lshlrev_b32 v12, 2, v0
    s_lshr_b32 s30, s4, 1
    s_lshl_b32 s30, s30, 8
    s_add_u32 s30, s30, 2334720
    s_mov_b32 s29, 131072
POLL_s4:
    buffer_load_dword v13, v12, s[8:11], s30 offen sc1
    s_waitcnt vmcnt(0)
    v_cmp_ne_u32 vcc, 1, v13
    s_nop 0
    s_cmp_eq_u64 vcc, 0
    s_cbranch_scc1 POLLD_s4
    s_sub_u32 s29, s29, 1
    s_cmp_lg_u32 s29, 0
    s_cbranch_scc1 POLL_s4
POLLD_s4:
    buffer_load_dwordx4 a[0:3], v9, s[8:11], s31 offen offset:0 sc1
    buffer_load_dwordx4 a[4:7], v9, s[8:11], s31 offen offset:1024 sc1
    buffer_load_dwordx4 a[8:11], v9, s[8:11], s31 offen offset:2048 sc1
    buffer_load_dwordx4 a[12:15], v9, s[8:11], s31 offen offset:3072 sc1
    s_add_u32 s31, s31, 4096
    buffer_load_dwordx4 a[16:19], v9, s[8:11], s31 offen offset:0 sc1
    buffer_load_dwordx4 a[20:23], v9, s[8:11], s31 offen offset:1024 sc1
    buffer_load_dwordx4 a[24:27], v9, s[8:11], s31 offen offset:2048 sc1
    buffer_load_dwordx4 a[28:31], v9, s[8:11], s31 offen offset:3072 sc1
    s_waitcnt vmcnt(7) lgkmcnt(8)
    v_mfma_f32_32x32x16_bf16 v[80:95], v[20:23], a[0:3], 0
    s_add_u32 s31, s31, 4096
    buffer_load_dwordx4 a[32:35], v9, s[8:11], s31 offen offset:0 sc1
    ds_read_b64_tr_b16 v[44:45], v11 offset:6144
    ds_read_b64_tr_b16 v[46:47], v11 offset:6656
    v_mfma_f32_32x32x16_bf16 v[64:79], v[16:19], a[0:3], v[64:79]
    ds_read_b64_tr_b16 v[40:41], v10 offset:6144
    ds_read_b64_tr_b16 v[42:43], v10 offset:6656
    s_waitcnt vmcnt(7) lgkmcnt(8)
    v_mfma_f32_32x32x16_bf16 v[80:95], v[28:31], a[4:7], v[80:95]
    buffer_load_dwordx4 a[36:39], v9, s[8:11], s31 offen offset:1024 sc1
    ds_read_b64_tr_b16 v[20:21], v11 offset:8192
    ds_read_b64_tr_b16 v[22:23], v11 offset:8704
    v_mfma_f32_32x32x16_bf16 v[64:79], v[24:27], a[4:7], v[64:79]
    ds_read_b64_tr_b16 v[16:17], v10 offset:8192
    ds_read_b64_tr_b16 v[18:19], v10 offset:8704
    s_waitcnt vmcnt(7) lgkmcnt(8)
    v_mfma_f32_32x32x16_bf16 v[80:95], v[36:39], a[8:11], v[80:95]
    buffer_load_dwordx4 a[40:43], v9, s[8:11], s31 offen offset:2048 sc1
    ds_read_b64_tr_b16 v[28:29], v11 offset:10240
    ds_read_b64_tr_b16 v[30:31], v11 offset:10752
    v_mfma_f32_32x32x16_bf16 v[64:79], v[32:35], a[8:11], v[64:79]
    ds_read_b64_tr_b16 v[24:25], v10 offset:10240
    ds_read_b64_tr_b16 v[26:27], v10 offset:10752
    s_waitcnt vmcnt(7) lgkmcnt(8)
    v_mfma_f32_32x32x16_bf16 v[80:95], v[44:47], a[12:15], v[80:95]
    buffer_load_dwordx4 a[44:47], v9, s[8:11], s31 offen offset:3072 sc1
    ds_read_b64_tr_b16 v[36:37], v11 offset:12288
    ds_read_b64_tr_b16 v[38:39], v11 offset:12800
    v_mfma_f32_32x32x16_bf16 v[64:79], v[40:43], a[12:15], v[64:79]
    ds_read_b64_tr_b16 v[32:33], v10 offset:12288
    ds_read_b64_tr_b16 v[34:35], v10 offset:12800
    s_barrier
    s_add_u32 m0, s77, 0
    s_add_u32 s3, s76, 0
    buffer_load_dwordx4 v4, s[16:19], s3 offen lds
    s_add_u32 m0, s77, 1024
    s_add_u32 s3, s76, 8192
    buffer_load_dwordx4 v4, s[16:19], s3 offen lds
    s_add_u32 m0, s77, 2048
    s_add_u32 s3, s76, 16384
    buffer_load_dwordx4 v4, s[16:19], s3 offen lds
    s_waitcnt vmcnt(10) lgkmcnt(8)
    v_mfma_f32_32x32x16_bf16 v[80:95], v[20:23], a[16:19], v[80:95]
    s_add_u32 s31, s31, 4096
    buffer_load_dwordx4 a[48:51], v9, s[8:11], s31 offen offset:0 sc1
    ds_read_b64_tr_b16 v[44:45], v11 offset:14336
    ds_read_b64_tr_b16 v[46:47], v11 offset:14848
    v_mfma_f32_32x32x16_bf16 v[64:79], v[16:19], a[16:19], v[64:79]
    ds_read_b64_tr_b16 v[40:41], v10 offset:14336
    ds_read_b64_tr_b16 v[42:43], v10 offset:14848
    s_waitcnt vmcnt(10) lgkmcnt(8)
    v_mfma_f32_32x32x16_bf16 v[80:95], v[28:31], a[20:23], v[80:95]
    buffer_load_dwordx4 a[52:55], v9, s[8:11], s31 offen offset:1024 sc1
    ds_read_b64_tr_b16 v[20:21], v11 offset:16384
    ds_read_b64_tr_b16 v[22:23], v11 offset:16896
    v_mfma_f32_32x32x16_bf16 v[64:79], v[24:27], a[20:23], v[64:79]
    ds_read_b64_tr_b16 v[16:17], v10 offset:16384
    ds_read_b64_tr_b16 v[18:19], v10 offset:16896
    s_waitcnt vmcnt(10) lgkmcnt(8)
    v_mfma_f32_32x32x16_bf16 v[80:95], v[36:39], a[24:27], v[80:95]
    buffer_load_dwordx4 a[56:59], v9, s[8:11], s31 offen offset:2048 sc1
    ds_read_b64_tr_b16 v[28:29], v11 offset:18432
    ds_read_b64_tr_b16 v[30:31], v11 offset:18944
    v_mfma_f32_32x32x16_bf16 v[64:79], v[32:35], a[24:27], v[64:79]
    ds_read_b64_tr_b16 v[24:25], v10 offset:18432
    ds_read_b64_tr_b16 v[26:27], v10 offset:18944
    s_waitcnt vmcnt(10) lgkmcnt(8)
    v_mfma_f32_32x32x16_bf16 v[80:95], v[44:47], a[28:31], v[80:95]
    buffer_load_dwordx4 a[60:63], v9, s[8:11], s31 offen offset:3072 sc1
    ds_read_b64_tr_b16 v[36:37], v11 offset:20480
    ds_read_b64_tr_b16 v[38:39], v11 offset:20992
    v_mfma_f32_32x32x16_bf16 v[64:79], v[40:43], a[28:31], v[64:79]
    ds_read_b64_tr_b16 v[32:33], v10 offset:20480
    ds_read_b64_tr_b16 v[34:35], v10 offset:20992
    s_waitcnt vmcnt(10) lgkmcnt(8)
    v_mfma_f32_32x32x16_bf16 v[80:95], v[20:23], a[32:35], v[80:95]
    s_add_u32 s31, s31, 4096
    buffer_load_dwordx4 a[64:67], v9, s[8:11], s31 offen offset:0 sc1
    ds_read_b64_tr_b16 v[44:45], v11 offset:22528
    ds_read_b64_tr_b16 v[46:47], v11 offset:23040
    v_mfma_f32_32x32x16_bf16 v[64:79], v[16:19], a[32:35], v[64:79]
    ds_read_b64_tr_b16 v[40:41], v10 offset:22528
    ds_read_b64_tr_b16 v[42:43], v10 offset:23040
    s_waitcnt vmcnt(10) lgkmcnt(8)
    v_mfma_f32_32x32x16_bf16 v[80:95], v[28:31], a[36:39], v[80:95]
    buffer_load_dwordx4 a[68:71], v9, s[8:11], s31 offen offset:1024 sc1
    ds_read_b64_tr_b16 v[20:21], v11 offset:24576
    ds_read_b64_tr_b16 v[22:23], v11 offset:25088
    v_mfma_f32_32x32x16_bf16 v[64:79], v[24:27], a[36:39], v[64:79]
    ds_read_b64_tr_b16 v[16:17], v10 offset:24576
    ds_read_b64_tr_b16 v[18:19], v10 offset:25088
    s_waitcnt vmcnt(10) lgkmcnt(8)
    v_mfma_f32_32x32x16_bf16 v[80:95], v[36:39], a[40:43], v[80:95]
    buffer_load_dwordx4 a[72:75], v9, s[8:11], s31 offen offset:2048 sc1
    ds_read_b64_tr_b16 v[28:29], v11 offset:26624
    ds_read_b64_tr_b16 v[30:31], v11 offset:27136
    v_mfma_f32_32x32x16_bf16 v[64:79], v[32:35], a[40:43], v[64:79]
    ds_read_b64_tr_b16 v[24:25], v10 offset:26624
    ds_read_b64_tr_b16 v[26:27], v10 offset:27136
    s_waitcnt vmcnt(10) lgkmcnt(8)
    v_mfma_f32_32x32x16_bf16 v[80:95], v[44:47], a[44:47], v[80:95]
    buffer_load_dwordx4 a[76:79], v9, s[8:11], s31 offen offset:3072 sc1
    ds_read_b64_tr_b16 v[36:37], v11 offset:28672
    ds_read_b64_tr_b16 v[38:39], v11 offset:29184
    v_mfma_f32_32x32x16_bf16 v[64:79], v[40:43], a[44:47], v[64:79]
    ds_read_b64_tr_b16 v[32:33], v10 offset:28672
    ds_read_b64_tr_b16 v[34:35], v10 offset:29184
    s_waitcnt vmcnt(7) lgkmcnt(8)
    v_mfma_f32_32x32x16_bf16 v[80:95], v[20:23], a[48:51], v[80:95]
    s_add_u32 s31, s31, 4096
    buffer_load_dwordx4 a[80:83], v9, s[8:11], s31 offen offset:0 sc1
    ds_read_b64_tr_b16 v[44:45], v11 offset:30720
    ds_read_b64_tr_b16 v[46:47], v11 offset:31232
    v_mfma_f32_32x32x16_bf16 v[64:79], v[16:19], a[48:51], v[64:79]
    ds_read_b64_tr_b16 v[40:41], v10 offset:30720
    ds_read_b64_tr_b16 v[42:43], v10 offset:31232
    s_waitcnt vmcnt(7) lgkmcnt(8)
    v_mfma_f32_32x32x16_bf16 v[80:95], v[28:31], a[52:55], v[80:95]
    buffer_load_dwordx4 a[84:87], v9, s[8:11], s31 offen offset:1024 sc1
    ds_read_b64_tr_b16 v[20:21], v11 offset:32768
    ds_read_b64_tr_b16 v[22:23], v11 offset:33280
    v_mfma_f32_32x32x16_bf16 v[64:79], v[24:27], a[52:55], v[64:79]
    ds_read_b64_tr_b16 v[16:17], v10 offset:32768
    ds_read_b64_tr_b16 v[18:19], v10 offset:33280
    s_waitcnt vmcnt(7) lgkmcnt(8)
    v_mfma_f32_32x32x16_bf16 v[80:95], v[36:39], a[56:59], v[80:95]
    buffer_load_dwordx4 a[88:91], v9, s[8:11], s31 offen offset:2048 sc1
    ds_read_b64_tr_b16 v[28:29], v11 offset:34816
    ds_read_b64_tr_b16 v[30:31], v11 offset:35328
    v_mfma_f32_32x32x16_bf16 v[64:79], v[32:35], a[56:59], v[64:79]
    ds_read_b64_tr_b16 v[24:25], v10 offset:34816
    ds_read_b64_tr_b16 v[26:27], v10 offset:35328
    s_waitcnt vmcnt(7) lgkmcnt(8)
    v_mfma_f32_32x32x16_bf16 v[80:95], v[44:47], a[60:63], v[80:95]
    buffer_load_dwordx4 a[92:95], v9, s[8:11], s31 offen offset:3072 sc1
    ds_read_b64_tr_b16 v[36:37], v11 offset:36864
    ds_read_b64_tr_b16 v[38:39], v11 offset:37376
    v_mfma_f32_32x32x16_bf16 v[64:79], v[40:43], a[60:63], v[64:79]
    ds_read_b64_tr_b16 v[32:33], v10 offset:36864
    ds_read_b64_tr_b16 v[34:35], v10 offset:37376
    s_waitcnt vmcnt(7) lgkmcnt(8)
    v_mfma_f32_32x32x16_bf16 v[80:95], v[20:23], a[64:67], v[80:95]
    s_add_u32 s31, s31, 4096
    buffer_load_dwordx4 a[96:99], v9, s[8:11], s31 offen offset:0 sc1
    ds_read_b64_tr_b16 v[44:45], v11 offset:38912
    ds_read_b64_tr_b16 v[46:47], v11 offset:39424
    v_mfma_f32_32x32x16_bf16 v[64:79], v[16:19], a[64:67], v[64:79]
    ds_read_b64_tr_b16 v[40:41], v10 offset:38912
    ds_read_b64_tr_b16 v[42:43], v10 offset:39424
    s_waitcnt vmcnt(7) lgkmcnt(8)
    v_mfma_f32_32x32x16_bf16 v[80:95], v[28:31], a[68:71], v[80:95]
    buffer_load_dwordx4 a[100:103], v9, s[8:11], s31 offen offset:1024 sc1
    ds_read_b64_tr_b16 v[20:21], v11 offset:40960
    ds_read_b64_tr_b16 v[22:23], v11 offset:41472
    v_mfma_f32_32x32x16_bf16 v[64:79], v[24:27], a[68:71], v[64:79]
    ds_read_b64_tr_b16 v[16:17], v10 offset:40960
    ds_read_b64_tr_b16 v[18:19], v10 offset:41472
    s_waitcnt vmcnt(7) lgkmcnt(8)
    v_mfma_f32_32x32x16_bf16 v[80:95], v[36:39], a[72:75], v[80:95]
    buffer_load_dwordx4 a[104:107], v9, s[8:11], s31 offen offset:2048 sc1
    ds_read_b64_tr_b16 v[28:29], v11 offset:43008
    ds_read_b64_tr_b16 v[30:31], v11 offset:43520
    v_mfma_f32_32x32x16_bf16 v[64:79], v[32:35], a[72:75], v[64:79]
    ds_read_b64_tr_b16 v[24:25], v10 offset:43008
    ds_read_b64_tr_b16 v[26:27], v10 offset:43520
    s_waitcnt vmcnt(7) lgkmcnt(8)
    v_mfma_f32_32x32x16_bf16 v[80:95], v[44:47], a[76:79], v[80:95]
    buffer_load_dwordx4 a[108:111], v9, s[8:11], s31 offen offset:3072 sc1
    ds_read_b64_tr_b16 v[36:37], v11 offset:45056
    ds_read_b64_tr_b16 v[38:39], v11 offset:45568
    v_mfma_f32_32x32x16_bf16 v[64:79], v[40:43], a[76:79], v[64:79]
    ds_read_b64_tr_b16 v[32:33], v10 offset:45056
    ds_read_b64_tr_b16 v[34:35], v10 offset:45568
    s_waitcnt vmcnt(7) lgkmcnt(8)
    v_mfma_f32_32x32x16_bf16 v[80:95], v[20:23], a[80:83], v[80:95]
    s_add_u32 s31, s31, 4096
    buffer_load_dwordx4 a[112:115], v9, s[8:11], s31 offen offset:0 sc1
    ds_read_b64_tr_b16 v[44:45], v11 offset:47104
    ds_read_b64_tr_b16 v[46:47], v11 offset:47616
    v_mfma_f32_32x32x16_bf16 v[64:79], v[16:19], a[80:83], v[64:79]
    ds_read_b64_tr_b16 v[40:41], v10 offset:47104
    ds_read_b64_tr_b16 v[42:43], v10 offset:47616
    s_waitcnt vmcnt(7) lgkmcnt(8)
    v_mfma_f32_32x32x16_bf16 v[80:95], v[28:31], a[84:87], v[80:95]
    buffer_load_dwordx4 a[116:119], v9, s[8:11], s31 offen offset:1024 sc1
    ds_read_b64_tr_b16 v[20:21], v15 offset:0
    ds_read_b64_tr_b16 v[22:23], v15 offset:512
    v_mfma_f32_32x32x16_bf16 v[64:79], v[24:27], a[84:87], v[64:79]
    ds_read_b64_tr_b16 v[16:17], v14 offset:0
    ds_read_b64_tr_b16 v[18:19], v14 offset:512
    s_waitcnt vmcnt(7) lgkmcnt(8)
    v_mfma_f32_32x32x16_bf16 v[80:95], v[36:39], a[88:91], v[80:95]
    buffer_load_dwordx4 a[120:123], v9, s[8:11], s31 offen offset:2048 sc1
    ds_read_b64_tr_b16 v[28:29], v15 offset:2048
    ds_read_b64_tr_b16 v[30:31], v15 offset:2560
    v_mfma_f32_32x32x16_bf16 v[64:79], v[32:35], a[88:91], v[64:79]
    ds_read_b64_tr_b16 v[24:25], v14 offset:2048
    ds_read_b64_tr_b16 v[26:27], v14 offset:2560
    s_waitcnt vmcnt(7) lgkmcnt(8)
    v_mfma_f32_32x32x16_bf16 v[80:95], v[44:47], a[92:95], v[80:95]
    buffer_load_dwordx4 a[124:127], v9, s[8:11], s31 offen offset:3072 sc1
    ds_read_b64_tr_b16 v[36:37], v15 offset:4096
    ds_read_b64_tr_b16 v[38:39], v15 offset:4608
    v_mfma_f32_32x32x16_bf16 v[64:79], v[40:43], a[92:95], v[64:79]
    ds_read_b64_tr_b16 v[32:33], v14 offset:4096
    ds_read_b64_tr_b16 v[34:35], v14 offset:4608
    s_waitcnt vmcnt(7) lgkmcnt(8)
    v_mfma_f32_32x32x16_bf16 v[80:95], v[20:23], a[96:99], v[80:95]
    s_add_u32 s31, s31, 4096
    buffer_load_dwordx4 a[128:131], v9, s[8:11], s31 offen offset:0 sc1
    ds_read_b64_tr_b16 v[44:45], v15 offset:6144
    ds_read_b64_tr_b16 v[46:47], v15 offset:6656
    v_mfma_f32_32x32x16_bf16 v[64:79], v[16:19], a[96:99], v[64:79]
    ds_read_b64_tr_b16 v[40:41], v14 offset:6144
    ds_read_b64_tr_b16 v[42:43], v14 offset:6656
    s_waitcnt vmcnt(7) lgkmcnt(8)
    v_mfma_f32_32x32x16_bf16 v[80:95], v[28:31], a[100:103], v[80:95]
    buffer_load_dwordx4 a[132:135], v9, s[8:11], s31 offen offset:1024 sc1
    ds_read_b64_tr_b16 v[20:21], v15 offset:8192
    ds_read_b64_tr_b16 v[22:23], v15 offset:8704
    v_mfma_f32_32x32x16_bf16 v[64:79], v[24:27], a[100:103], v[64:79]
    ds_read_b64_tr_b16 v[16:17], v14 offset:8192
    ds_read_b64_tr_b16 v[18:19], v14 offset:8704
    s_waitcnt vmcnt(7) lgkmcnt(8)
    v_mfma_f32_32x32x16_bf16 v[80:95], v[36:39], a[104:107], v[80:95]
    buffer_load_dwordx4 a[136:139], v9, s[8:11], s31 offen offset:2048 sc1
    ds_read_b64_tr_b16 v[28:29], v15 offset:10240
    ds_read_b64_tr_b16 v[30:31], v15 offset:10752
    v_mfma_f32_32x32x16_bf16 v[64:79], v[32:35], a[104:107], v[64:79]
    ds_read_b64_tr_b16 v[24:25], v14 offset:10240
    ds_read_b64_tr_b16 v[26:27], v14 offset:10752
    s_waitcnt vmcnt(7) lgkmcnt(8)
    v_mfma_f32_32x32x16_bf16 v[80:95], v[44:47], a[108:111], v[80:95]
    buffer_load_dwordx4 a[140:143], v9, s[8:11], s31 offen offset:3072 sc1
    ds_read_b64_tr_b16 v[36:37], v15 offset:12288
    ds_read_b64_tr_b16 v[38:39], v15 offset:12800
    v_mfma_f32_32x32x16_bf16 v[64:79], v[40:43], a[108:111], v[64:79]
    ds_read_b64_tr_b16 v[32:33], v14 offset:12288
    ds_read_b64_tr_b16 v[34:35], v14 offset:12800
    s_waitcnt vmcnt(7) lgkmcnt(8)
    v_mfma_f32_32x32x16_bf16 v[80:95], v[20:23], a[112:115], v[80:95]
    s_add_u32 s31, s31, 4096
    buffer_load_dwordx4 a[144:147], v9, s[8:11], s31 offen offset:0 sc1
    ds_read_b64_tr_b16 v[44:45], v15 offset:14336
    ds_read_b64_tr_b16 v[46:47], v15 offset:14848
    v_mfma_f32_32x32x16_bf16 v[64:79], v[16:19], a[112:115], v[64:79]
    ds_read_b64_tr_b16 v[40:41], v14 offset:14336
    ds_read_b64_tr_b16 v[42:43], v14 offset:14848
    s_waitcnt vmcnt(7) lgkmcnt(8)
    v_mfma_f32_32x32x16_bf16 v[80:95], v[28:31], a[116:119], v[80:95]
    buffer_load_dwordx4 a[148:151], v9, s[8:11], s31 offen offset:1024 sc1
    ds_read_b64_tr_b16 v[20:21], v15 offset:16384
    ds_read_b64_tr_b16 v[22:23], v15 offset:16896
    v_mfma_f32_32x32x16_bf16 v[64:79], v[24:27], a[116:119], v[64:79]
    ds_read_b64_tr_b16 v[16:17], v14 offset:16384
    ds_read_b64_tr_b16 v[18:19], v14 offset:16896
    s_waitcnt vmcnt(7) lgkmcnt(8)
    v_mfma_f32_32x32x16_bf16 v[80:95], v[36:39], a[120:123], v[80:95]
    buffer_load_dwordx4 a[152:155], v9, s[8:11], s31 offen offset:2048 sc1
    ds_read_b64_tr_b16 v[28:29], v15 offset:18432
    ds_read_b64_tr_b16 v[30:31], v15 offset:18944
    v_mfma_f32_32x32x16_bf16 v[64:79], v[32:35], a[120:123], v[64:79]
    ds_read_b64_tr_b16 v[24:25], v14 offset:18432
    ds_read_b64_tr_b16 v[26:27], v14 offset:18944
    s_waitcnt vmcnt(7) lgkmcnt(8)
    v_mfma_f32_32x32x16_bf16 v[80:95], v[44:47], a[124:127], v[80:95]
    buffer_load_dwordx4 a[156:159], v9, s[8:11], s31 offen offset:3072 sc1
    ds_read_b64_tr_b16 v[36:37], v15 offset:20480
    ds_read_b64_tr_b16 v[38:39], v15 offset:20992
    v_mfma_f32_32x32x16_bf16 v[64:79], v[40:43], a[124:127], v[64:79]
    ds_read_b64_tr_b16 v[32:33], v14 offset:20480
    ds_read_b64_tr_b16 v[34:35], v14 offset:20992
    s_waitcnt vmcnt(7) lgkmcnt(8)
    v_mfma_f32_32x32x16_bf16 v[80:95], v[20:23], a[128:131], v[80:95]
    s_add_u32 s31, s31, 4096
    buffer_load_dwordx4 a[160:163], v9, s[8:11], s31 offen offset:0 sc1
    ds_read_b64_tr_b16 v[44:45], v15 offset:22528
    ds_read_b64_tr_b16 v[46:47], v15 offset:23040
    v_mfma_f32_32x32x16_bf16 v[64:79], v[16:19], a[128:131], v[64:79]
    ds_read_b64_tr_b16 v[40:41], v14 offset:22528
    ds_read_b64_tr_b16 v[42:43], v14 offset:23040
    s_waitcnt vmcnt(7) lgkmcnt(8)
    v_mfma_f32_32x32x16_bf16 v[80:95], v[28:31], a[132:135], v[80:95]
    buffer_load_dwordx4 a[164:167], v9, s[8:11], s31 offen offset:1024 sc1
    ds_read_b64_tr_b16 v[20:21], v15 offset:24576
    ds_read_b64_tr_b16 v[22:23], v15 offset:25088
    v_mfma_f32_32x32x16_bf16 v[64:79], v[24:27], a[132:135], v[64:79]
    ds_read_b64_tr_b16 v[16:17], v14 offset:24576
    ds_read_b64_tr_b16 v[18:19], v14 offset:25088
    s_waitcnt vmcnt(7) lgkmcnt(8)
    v_mfma_f32_32x32x16_bf16 v[80:95], v[36:39], a[136:139], v[80:95]
    buffer_load_dwordx4 a[168:171], v9, s[8:11], s31 offen offset:2048 sc1
    ds_read_b64_tr_b16 v[28:29], v15 offset:26624
    ds_read_b64_tr_b16 v[30:31], v15 offset:27136
    v_mfma_f32_32x32x16_bf16 v[64:79], v[32:35], a[136:139], v[64:79]
    ds_read_b64_tr_b16 v[24:25], v14 offset:26624
    ds_read_b64_tr_b16 v[26:27], v14 offset:27136
    s_waitcnt vmcnt(7) lgkmcnt(8)
    v_mfma_f32_32x32x16_bf16 v[80:95], v[44:47], a[140:143], v[80:95]
    ds_read_b64_tr_b16 v[36:37], v15 offset:28672
    ds_read_b64_tr_b16 v[38:39], v15 offset:29184
    v_mfma_f32_32x32x16_bf16 v[64:79], v[40:43], a[140:143], v[64:79]
    ds_read_b64_tr_b16 v[32:33], v14 offset:28672
    ds_read_b64_tr_b16 v[34:35], v14 offset:29184
    s_waitcnt vmcnt(31)
    s_barrier
    s_waitcnt vmcnt(6) lgkmcnt(8)
    v_mfma_f32_32x32x16_bf16 v[80:95], v[20:23], a[144:147], v[80:95]
    ds_read_b64_tr_b16 v[44:45], v15 offset:30720
    ds_read_b64_tr_b16 v[46:47], v15 offset:31232
    v_mfma_f32_32x32x16_bf16 v[64:79], v[16:19], a[144:147], v[64:79]
    ds_read_b64_tr_b16 v[40:41], v14 offset:30720
    ds_read_b64_tr_b16 v[42:43], v14 offset:31232
    s_waitcnt vmcnt(5) lgkmcnt(8)
    v_mfma_f32_32x32x16_bf16 v[80:95], v[28:31], a[148:151], v[80:95]
    ds_read_b64_tr_b16 v[20:21], v11 offset:0
    ds_read_b64_tr_b16 v[22:23], v11 offset:512
    v_mfma_f32_32x32x16_bf16 v[64:79], v[24:27], a[148:151], v[64:79]
    ds_read_b64_tr_b16 v[16:17], v10 offset:0
    ds_read_b64_tr_b16 v[18:19], v10 offset:512
    s_waitcnt vmcnt(4) lgkmcnt(8)
    v_mfma_f32_32x32x16_bf16 v[80:95], v[36:39], a[152:155], v[80:95]
    ds_read_b64_tr_b16 v[28:29], v11 offset:2048
    ds_read_b64_tr_b16 v[30:31], v11 offset:2560
    v_mfma_f32_32x32x16_bf16 v[64:79], v[32:35], a[152:155], v[64:79]
    ds_read_b64_tr_b16 v[24:25], v10 offset:2048
    ds_read_b64_tr_b16 v[26:27], v10 offset:2560
    s_waitcnt vmcnt(3) lgkmcnt(8)
    v_mfma_f32_32x32x16_bf16 v[80:95], v[44:47], a[156:159], v[80:95]
    ds_read_b64_tr_b16 v[36:37], v11 offset:4096
    ds_read_b64_tr_b16 v[38:39], v11 offset:4608
    v_mfma_f32_32x32x16_bf16 v[64:79], v[40:43], a[156:159], v[64:79]
    ds_read_b64_tr_b16 v[32:33], v10 offset:4096
    ds_read_b64_tr_b16 v[34:35], v10 offset:4608
    s_waitcnt vmcnt(2) lgkmcnt(8)
    v_mfma_f32_32x32x16_bf16 v[80:95], v[20:23], a[160:163], v[80:95]
    v_mfma_f32_32x32x16_bf16 v[64:79], v[16:19], a[160:163], v[64:79]
    s_waitcnt vmcnt(1) lgkmcnt(4)
    v_mfma_f32_32x32x16_bf16 v[80:95], v[28:31], a[164:167], v[80:95]
    v_mfma_f32_32x32x16_bf16 v[64:79], v[24:27], a[164:167], v[64:79]
    s_waitcnt vmcnt(0) lgkmcnt(0)
    v_mfma_f32_32x32x16_bf16 v[80:95], v[36:39], a[168:171], v[80:95]
    v_mfma_f32_32x32x16_bf16 v[64:79], v[32:35], a[168:171], v[64:79]
    s_lshl_b32 s3, s6, 12
    s_add_u32 s3, s3, 8192
    v_add_u32 v12, s3, v9
    s_nop 7
    ds_write_b128 v12, v[80:83] offset:0
    ds_write_b128 v12, v[84:87] offset:1024
    ds_write_b128 v12, v[88:91] offset:2048
    ds_write_b128 v12, v[92:95] offset:3072
    v_xor_b32 v12, 4096, v12
    s_waitcnt lgkmcnt(0)
    s_barrier
    ds_read_b128 v[80:83], v12 offset:0
    ds_read_b128 v[84:87], v12 offset:1024
    ds_read_b128 v[88:91], v12 offset:2048
    ds_read_b128 v[92:95], v12 offset:3072
    s_waitcnt lgkmcnt(3)
    v_pk_add_f32 v[64:65], v[64:65], v[80:81]
    v_pk_add_f32 v[66:67], v[66:67], v[82:83]
    s_waitcnt lgkmcnt(2)
    v_pk_add_f32 v[68:69], v[68:69], v[84:85]
    v_pk_add_f32 v[70:71], v[70:71], v[86:87]
    s_waitcnt lgkmcnt(1)
    v_pk_add_f32 v[72:73], v[72:73], v[88:89]
    v_pk_add_f32 v[74:75], v[74:75], v[90:91]
    s_waitcnt lgkmcnt(0)
    v_pk_add_f32 v[76:77], v[76:77], v[92:93]
    v_pk_add_f32 v[78:79], v[78:79], v[94:95]
    v_cvt_pk_bf16_f32 v32, v64, v65
    v_cvt_pk_bf16_f32 v33, v66, v67
    v_cvt_pk_bf16_f32 v34, v68, v69
    v_cvt_pk_bf16_f32 v35, v70, v71
    v_cvt_pk_bf16_f32 v36, v72, v73
    v_cvt_pk_bf16_f32 v37, v74, v75
    v_cvt_pk_bf16_f32 v38, v76, v77
    v_cvt_pk_bf16_f32 v39, v78, v79
    s_lshl_b32 s3, s62, 6
    buffer_store_dwordx4 v[32:35], v8, s[24:27], s3 offen
    buffer_store_dwordx4 v[36:39], v8, s[24:27], s3 offen offset:32
END_K:
    s_endpgm
L_slow:
    s_getreg_b32 s43, hwreg(HW_REG_XCC_ID, 0, 4)
    s_add_u32 s43, s43, 1
    s_lshr_b32 s86, s4, 1
    s_lshl_b32 s86, s86, 6
    s_add_u32 s86, s86, 2338816
    s_cmp_lg_u32 s6, 0
    s_cbranch_scc1 XP_8443
    s_and_b32 s3, s4, 1
    s_lshl_b32 s3, s3, 3
    s_add_u32 s3, s3, s5
    s_lshl_b32 s3, s3, 2
    v_mov_b32 v12, s43
    v_mov_b32 v14, s3
    s_mov_b64 exec, 1
    buffer_store_dword v12, v14, s[8:11], s86 offen sc1
    s_mov_b64 exec, -1
XP_8443:
    s_add_u32 s3, s30, 4096
    buffer_load_dwordx4 a[16:19], v9, s[8:11], s3 offen sc1
    s_add_u32 s3, s30, 5120
    buffer_load_dwordx4 a[20:23], v9, s[8:11], s3 offen sc1
    s_add_u32 s3, s30, 6144
    buffer_load_dwordx4 a[24:27], v9, s[8:11], s3 offen sc1
    s_add_u32 s3, s30, 7168
    buffer_load_dwordx4 a[28:31], v9, s[8:11], s3 offen sc1
    s_add_u32 s3, s30, 8192
    buffer_load_dwordx4 a[32:35], v9, s[8:11], s3 offen sc1
    s_add_u32 s3, s30, 9216
    buffer_load_dwordx4 a[36:39], v9, s[8:11], s3 offen sc1
    s_add_u32 s3, s30, 10240
    buffer_load_dwordx4 a[40:43], v9, s[8:11], s3 offen sc1
    s_add_u32 s3, s30, 11264
    buffer_load_dwordx4 a[44:47], v9, s[8:11], s3 offen sc1
    s_add_u32 s3, s30, 12288
    buffer_load_dwordx4 a[48:51], v9, s[8:11], s3 offen sc1
    s_add_u32 s3, s30, 13312
    buffer_load_dwordx4 a[52:55], v9, s[8:11], s3 offen sc1
    s_add_u32 s3, s30, 14336
    buffer_load_dwordx4 a[56:59], v9, s[8:11], s3 offen sc1
    s_add_u32 s3, s30, 15360
    buffer_load_dwordx4 a[60:63], v9, s[8:11], s3 offen sc1
    s_add_u32 s3, s31, 6144
    s_mov_b64 exec, s[80:81]
    buffer_load_dwordx4 a[88:91], v9, s[8:11], s3 offen sc1
    buffer_load_dwordx4 a[92:95], v9, s[8:11], s3 offen offset:1024 sc1
    s_mov_b64 exec, -1
    s_add_u32 s3, s31, 8192
    s_mov_b64 exec, s[80:81]
    buffer_load_dwordx4 a[96:99], v9, s[8:11], s3 offen sc1
    buffer_load_dwordx4 a[100:103], v9, s[8:11], s3 offen offset:1024 sc1
    s_mov_b64 exec, -1
    s_add_u32 s3, s31, 10240
    s_mov_b64 exec, s[80:81]
    buffer_load_dwordx4 a[104:107], v9, s[8:11], s3 offen sc1
    buffer_load_dwordx4 a[108:111], v9, s[8:11], s3 offen offset:1024 sc1
    s_mov_b64 exec, -1
    s_add_u32 s3, s31, 12288
    s_mov_b64 exec, s[80:81]
    buffer_load_dwordx4 a[112:115], v9, s[8:11], s3 offen sc1
    buffer_load_dwordx4 a[116:119], v9, s[8:11], s3 offen offset:1024 sc1
    s_mov_b64 exec, -1
    s_add_u32 s3, s31, 14336
    s_mov_b64 exec, s[80:81]
    buffer_load_dwordx4 a[120:123], v9, s[8:11], s3 offen sc1
    buffer_load_dwordx4 a[124:127], v9, s[8:11], s3 offen offset:1024 sc1
    s_mov_b64 exec, -1
    s_add_u32 s3, s31, 16384
    s_mov_b64 exec, s[80:81]
    buffer_load_dwordx4 a[128:131], v9, s[8:11], s3 offen sc1
    buffer_load_dwordx4 a[132:135], v9, s[8:11], s3 offen offset:1024 sc1
    s_mov_b64 exec, -1
    s_add_u32 s3, s31, 18432
    s_mov_b64 exec, s[80:81]
    buffer_load_dwordx4 a[136:139], v9, s[8:11], s3 offen sc1
    buffer_load_dwordx4 a[140:143], v9, s[8:11], s3 offen offset:1024 sc1
    s_mov_b64 exec, -1
    s_add_u32 s3, s31, 20480
    s_mov_b64 exec, s[80:81]
    buffer_load_dwordx4 a[144:147], v9, s[8:11], s3 offen sc1
    buffer_load_dwordx4 a[148:151], v9, s[8:11], s3 offen offset:1024 sc1
    s_mov_b64 exec, -1
    s_add_u32 s3, s31, 22528
    s_mov_b64 exec, s[80:81]
    buffer_load_dwordx4 a[152:155], v9, s[8:11], s3 offen sc1
    buffer_load_dwordx4 a[156:159], v9, s[8:11], s3 offen offset:1024 sc1
    s_mov_b64 exec, -1
    s_add_u32 s3, s31, 24576
    s_mov_b64 exec, s[80:81]
    buffer_load_dwordx4 a[160:163], v9, s[8:11], s3 offen sc1
    buffer_load_dwordx4 a[164:167], v9, s[8:11], s3 offen offset:1024 sc1
    s_mov_b64 exec, -1
    s_add_u32 s3, s31, 26624
    s_mov_b64 exec, s[80:81]
    buffer_load_dwordx4 a[168:171], v9, s[8:11], s3 offen sc1
    buffer_load_dwordx4 a[172:175], v9, s[8:11], s3 offen offset:1024 sc1
    s_mov_b64 exec, -1
    s_add_u32 s3, s31, 28672
    s_mov_b64 exec, s[80:81]
    buffer_load_dwordx4 a[176:179], v9, s[8:11], s3 offen sc1
    buffer_load_dwordx4 a[180:183], v9, s[8:11], s3 offen offset:1024 sc1
    s_mov_b64 exec, -1
    s_add_u32 s3, s31, 30720
    s_mov_b64 exec, s[80:81]
    buffer_load_dwordx4 a[184:187], v9, s[8:11], s3 offen sc1
    buffer_load_dwordx4 a[188:191], v9, s[8:11], s3 offen offset:1024 sc1
    s_mov_b64 exec, -1
    s_add_u32 m0, s74, 0
    s_add_u32 s76, s75, 0
    buffer_load_dwordx4 v4, s[24:27], s76 offen offset:0 lds
    buffer_load_dwordx4 v5, s[24:27], s76 offen offset:1024 lds
    buffer_load_dwordx4 v6, s[24:27], s76 offen offset:2048 lds
    buffer_load_dwordx4 v7, s[24:27], s76 offen offset:3072 lds
    s_add_u32 m0, s74, 4096
    s_add_u32 s76, s75, 32768
    buffer_load_dwordx4 v4, s[24:27], s76 offen offset:0 lds
    buffer_load_dwordx4 v5, s[24:27], s76 offen offset:1024 lds
    buffer_load_dwordx4 v6, s[24:27], s76 offen offset:2048 lds
    buffer_load_dwordx4 v7, s[24:27], s76 offen offset:3072 lds
    s_add_u32 m0, s74, 8192
    s_add_u32 s76, s75, 65536
    buffer_load_dwordx4 v4, s[24:27], s76 offen offset:0 lds
    buffer_load_dwordx4 v5, s[24:27], s76 offen offset:1024 lds
    buffer_load_dwordx4 v6, s[24:27], s76 offen offset:2048 lds
    buffer_load_dwordx4 v7, s[24:27], s76 offen offset:3072 lds
    s_add_u32 m0, s74, 12288
    s_add_u32 s76, s75, 98304
    buffer_load_dwordx4 v4, s[24:27], s76 offen offset:0 lds
    buffer_load_dwordx4 v5, s[24:27], s76 offen offset:1024 lds
    buffer_load_dwordx4 v6, s[24:27], s76 offen offset:2048 lds
    buffer_load_dwordx4 v7, s[24:27], s76 offen offset:3072 lds
    s_lshl_b32 s76, s62, 6
    buffer_load_dwordx4 a[192:195], v8, s[12:15], s76 offen
    buffer_load_dwordx4 a[196:199], v8, s[12:15], s76 offen offset:32
    s_waitcnt vmcnt(0)
    s_barrier
    ds_read_b64_tr_b16 v[128:129], v10 offset:0
    ds_read_b64_tr_b16 v[130:131], v10 offset:512
    ds_read_b64_tr_b16 v[132:133], v1 offset:0
    ds_read_b64_tr_b16 v[134:135], v1 offset:512
    ds_read_b64_tr_b16 v[136:137], v10 offset:2048
    ds_read_b64_tr_b16 v[138:139], v10 offset:2560
    ds_read_b64_tr_b16 v[140:141], v1 offset:2048
    ds_read_b64_tr_b16 v[142:143], v1 offset:2560
    ds_read_b64_tr_b16 v[144:145], v10 offset:4096
    ds_read_b64_tr_b16 v[146:147], v10 offset:4608
    ds_read_b64_tr_b16 v[148:149], v1 offset:4096
    ds_read_b64_tr_b16 v[150:151], v1 offset:4608
    ds_read_b64_tr_b16 v[152:153], v10 offset:6144
    ds_read_b64_tr_b16 v[154:155], v10 offset:6656
    ds_read_b64_tr_b16 v[156:157], v1 offset:6144
    ds_read_b64_tr_b16 v[158:159], v1 offset:6656
    ds_read_b64_tr_b16 v[160:161], v10 offset:8192
    ds_read_b64_tr_b16 v[162:163], v10 offset:8704
    ds_read_b64_tr_b16 v[164:165], v1 offset:8192
    ds_read_b64_tr_b16 v[166:167], v1 offset:8704
    ds_read_b64_tr_b16 v[168:169], v10 offset:10240
    ds_read_b64_tr_b16 v[170:171], v10 offset:10752
    ds_read_b64_tr_b16 v[172:173], v1 offset:10240
    ds_read_b64_tr_b16 v[174:175], v1 offset:10752
    ds_read_b64_tr_b16 v[176:177], v10 offset:12288
    ds_read_b64_tr_b16 v[178:179], v10 offset:12800
    ds_read_b64_tr_b16 v[180:181], v1 offset:12288
    ds_read_b64_tr_b16 v[182:183], v1 offset:12800
    ds_read_b64_tr_b16 v[184:185], v10 offset:14336
    ds_read_b64_tr_b16 v[186:187], v10 offset:14848
    ds_read_b64_tr_b16 v[188:189], v1 offset:14336
    ds_read_b64_tr_b16 v[190:191], v1 offset:14848
    ds_read_b64_tr_b16 v[192:193], v10 offset:16384
    ds_read_b64_tr_b16 v[194:195], v10 offset:16896
    ds_read_b64_tr_b16 v[196:197], v1 offset:16384
    ds_read_b64_tr_b16 v[198:199], v1 offset:16896
    ds_read_b64_tr_b16 v[200:201], v10 offset:18432
    ds_read_b64_tr_b16 v[202:203], v10 offset:18944
    ds_read_b64_tr_b16 v[204:205], v1 offset:18432
    ds_read_b64_tr_b16 v[206:207], v1 offset:18944
    ds_read_b64_tr_b16 v[208:209], v10 offset:20480
    ds_read_b64_tr_b16 v[210:211], v10 offset:20992
    ds_read_b64_tr_b16 v[212:213], v1 offset:20480
    ds_read_b64_tr_b16 v[214:215], v1 offset:20992
    ds_read_b64_tr_b16 v[216:217], v10 offset:22528
    ds_read_b64_tr_b16 v[218:219], v10 offset:23040
    ds_read_b64_tr_b16 v[220:221], v1 offset:22528
    ds_read_b64_tr_b16 v[222:223], v1 offset:23040
    ds_read_b64_tr_b16 v[224:225], v10 offset:24576
    ds_read_b64_tr_b16 v[226:227], v10 offset:25088
    ds_read_b64_tr_b16 v[228:229], v1 offset:24576
    ds_read_b64_tr_b16 v[230:231], v1 offset:25088
    ds_read_b64_tr_b16 v[232:233], v10 offset:26624
    ds_read_b64_tr_b16 v[234:235], v10 offset:27136
    ds_read_b64_tr_b16 v[236:237], v1 offset:26624
    ds_read_b64_tr_b16 v[238:239], v1 offset:27136
    ds_read_b64_tr_b16 v[240:241], v10 offset:28672
    ds_read_b64_tr_b16 v[242:243], v10 offset:29184
    ds_read_b64_tr_b16 v[244:245], v1 offset:28672
    ds_read_b64_tr_b16 v[246:247], v1 offset:29184
    ds_read_b64_tr_b16 v[248:249], v10 offset:30720
    ds_read_b64_tr_b16 v[250:251], v10 offset:31232
    ds_read_b64_tr_b16 v[252:253], v1 offset:30720
    ds_read_b64_tr_b16 v[254:255], v1 offset:31232
    s_and_b32 s3, s4, 1
    s_lshl_b32 s3, s3, 3
    s_add_u32 s3, s3, s5
    s_min_u32 s7, s3, 11
    s_lshl_b32 s7, s7, 1
    s_lshl_b32 s66, s3, 2
    s_add_u32 s66, s66, s7
    s_cmp_lt_u32 s3, 11
    s_cselect_b32 s67, 6, 4
    v_add_u32 v11, 0, v0
    v_mul_u32_u24 v12, 5462, v11
    v_lshrrev_b32 v12, 16, v12
    v_mul_u32_u24 v13, 12, v12
    v_sub_u32 v13, v11, v13
    v_mul_u32_u24 v12, 2752, v12
    v_lshl_add_u32 v2, v13, 4, v12
    v_add_u32 v13, 10, v13
    v_subrev_u32 v14, 12, v13
    v_min_u32 v13, v13, v14
    v_lshl_add_u32 v5, v13, 4, v12
    v_add_u32 v11, 64, v0
    v_mul_u32_u24 v12, 5462, v11
    v_lshrrev_b32 v12, 16, v12
    v_mul_u32_u24 v13, 12, v12
    v_sub_u32 v13, v11, v13
    v_mul_u32_u24 v12, 2752, v12
    v_subrev_u32 v12, 1024, v12
    v_lshl_add_u32 v3, v13, 4, v12
    v_add_u32 v13, 10, v13
    v_subrev_u32 v14, 12, v13
    v_min_u32 v13, v13, v14
    v_lshl_add_u32 v6, v13, 4, v12
    v_add_u32 v11, 128, v0
    v_mul_u32_u24 v12, 5462, v11
    v_lshrrev_b32 v12, 16, v12
    v_mul_u32_u24 v13, 12, v12
    v_sub_u32 v13, v11, v13
    v_mul_u32_u24 v12, 2752, v12
    v_subrev_u32 v12, 2048, v12
    v_lshl_add_u32 v4, v13, 4, v12
    v_add_u32 v13, 10, v13
    v_subrev_u32 v14, 12, v13
    v_min_u32 v13, v13, v14
    v_lshl_add_u32 v7, v13, 4, v12
    s_mul_i32 s68, s6, 44032
    s_lshl_b32 s3, s66, 5
    s_add_u32 s68, s68, s3
    s_mul_i32 s69, s6, 3072
    s_waitcnt lgkmcnt(0)
    s_barrier
    s_add_u32 m0, s69, 0
    s_add_u32 s71, s68, 0
    buffer_load_dwordx4 v2, s[16:19], s71 offen offset:0 lds
    buffer_load_dwordx4 v3, s[16:19], s71 offen offset:1024 lds
    buffer_load_dwordx4 v4, s[16:19], s71 offen offset:2048 lds
    s_add_u32 m0, s69, 12288
    s_nop 0
    buffer_load_dwordx4 v5, s[20:23], s71 offen offset:0 lds
    buffer_load_dwordx4 v6, s[20:23], s71 offen offset:1024 lds
    buffer_load_dwordx4 v7, s[20:23], s71 offen offset:2048 lds
    s_add_u32 m0, s69, 24576
    s_add_u32 s71, s68, 176128
    buffer_load_dwordx4 v2, s[16:19], s71 offen offset:0 lds
    buffer_load_dwordx4 v3, s[16:19], s71 offen offset:1024 lds
    buffer_load_dwordx4 v4, s[16:19], s71 offen offset:2048 lds
    s_add_u32 m0, s69, 36864
    s_nop 0
    buffer_load_dwordx4 v5, s[20:23], s71 offen offset:0 lds
    buffer_load_dwordx4 v6, s[20:23], s71 offen offset:1024 lds
    buffer_load_dwordx4 v7, s[20:23], s71 offen offset:2048 lds
    s_add_u32 m0, s69, 49152
    s_add_u32 s71, s68, 352256
    buffer_load_dwordx4 v2, s[16:19], s71 offen offset:0 lds
    buffer_load_dwordx4 v3, s[16:19], s71 offen offset:1024 lds
    buffer_load_dwordx4 v4, s[16:19], s71 offen offset:2048 lds
    s_add_u32 m0, s69, 61440
    s_nop 0
    buffer_load_dwordx4 v5, s[20:23], s71 offen offset:0 lds
    buffer_load_dwordx4 v6, s[20:23], s71 offen offset:1024 lds
    buffer_load_dwordx4 v7, s[20:23], s71 offen offset:2048 lds
    s_mov_b32 s64, 0
L_mx:
    s_lshl_b32 s3, s64, 10
    v_add_u32 v120, s3, v59
    ds_read_b128 v[100:103], v120
    v_mov_b32 v121, 0xff800000
    s_waitcnt lgkmcnt(0)
    v_mfma_f32_32x32x16_bf16 v[16:31], a[0:3], v[100:103], 0
    v_mfma_f32_32x32x16_bf16 v[32:47], a[4:7], v[100:103], 0
    s_nop 10
    v_max3_f32 v121, v16, v17, v121
    v_max3_f32 v121, v18, v19, v121
    v_max3_f32 v121, v20, v21, v121
    v_max3_f32 v121, v22, v23, v121
    v_max3_f32 v121, v24, v25, v121
    v_max3_f32 v121, v26, v27, v121
    v_max3_f32 v121, v28, v29, v121
    v_max3_f32 v121, v30, v31, v121
    v_mfma_f32_32x32x16_bf16 v[16:31], a[8:11], v[100:103], 0
    v_max3_f32 v121, v32, v33, v121
    v_max3_f32 v121, v34, v35, v121
    v_max3_f32 v121, v36, v37, v121
    v_max3_f32 v121, v38, v39, v121
    v_max3_f32 v121, v40, v41, v121
    v_max3_f32 v121, v42, v43, v121
    v_max3_f32 v121, v44, v45, v121
    v_max3_f32 v121, v46, v47, v121
    v_mfma_f32_32x32x16_bf16 v[32:47], a[12:15], v[100:103], 0
    s_nop 2
    v_max3_f32 v121, v16, v17, v121
    v_max3_f32 v121, v18, v19, v121
    v_max3_f32 v121, v20, v21, v121
    v_max3_f32 v121, v22, v23, v121
    v_max3_f32 v121, v24, v25, v121
    v_max3_f32 v121, v26, v27, v121
    v_max3_f32 v121, v28, v29, v121
    v_max3_f32 v121, v30, v31, v121
    v_mfma_f32_32x32x16_bf16 v[16:31], a[16:19], v[100:103], 0
    v_max3_f32 v121, v32, v33, v121
    v_max3_f32 v121, v34, v35, v121
    v_max3_f32 v121, v36, v37, v121
    v_max3_f32 v121, v38, v39, v121
    v_max3_f32 v121, v40, v41, v121
    v_max3_f32 v121, v42, v43, v121
    v_max3_f32 v121, v44, v45, v121
    v_max3_f32 v121, v46, v47, v121
    v_mfma_f32_32x32x16_bf16 v[32:47], a[20:23], v[100:103], 0
    s_nop 2
    v_max3_f32 v121, v16, v17, v121
    v_max3_f32 v121, v18, v19, v121
    v_max3_f32 v121, v20, v21, v121
    v_max3_f32 v121, v22, v23, v121
    v_max3_f32 v121, v24, v25, v121
    v_max3_f32 v121, v26, v27, v121
    v_max3_f32 v121, v28, v29, v121
    v_max3_f32 v121, v30, v31, v121
    v_mfma_f32_32x32x16_bf16 v[16:31], a[24:27], v[100:103], 0
    v_max3_f32 v121, v32, v33, v121
    v_max3_f32 v121, v34, v35, v121
    v_max3_f32 v121, v36, v37, v121
    v_max3_f32 v121, v38, v39, v121
    v_max3_f32 v121, v40, v41, v121
    v_max3_f32 v121, v42, v43, v121
    v_max3_f32 v121, v44, v45, v121
    v_max3_f32 v121, v46, v47, v121
    v_mfma_f32_32x32x16_bf16 v[32:47], a[28:31], v[100:103], 0
    s_nop 2
    v_max3_f32 v121, v16, v17, v121
    v_max3_f32 v121, v18, v19, v121
    v_max3_f32 v121, v20, v21, v121
    v_max3_f32 v121, v22, v23, v121
    v_max3_f32 v121, v24, v25, v121
    v_max3_f32 v121, v26, v27, v121
    v_max3_f32 v121, v28, v29, v121
    v_max3_f32 v121, v30, v31, v121
    v_mfma_f32_32x32x16_bf16 v[16:31], a[32:35], v[100:103], 0
    v_max3_f32 v121, v32, v33, v121
    v_max3_f32 v121, v34, v35, v121
    v_max3_f32 v121, v36, v37, v121
    v_max3_f32 v121, v38, v39, v121
    v_max3_f32 v121, v40, v41, v121
    v_max3_f32 v121, v42, v43, v121
    v_max3_f32 v121, v44, v45, v121
    v_max3_f32 v121, v46, v47, v121
    v_mfma_f32_32x32x16_bf16 v[32:47], a[36:39], v[100:103], 0
    s_nop 2
    v_max3_f32 v121, v16, v17, v121
    v_max3_f32 v121, v18, v19, v121
    v_max3_f32 v121, v20, v21, v121
    v_max3_f32 v121, v22, v23, v121
    v_max3_f32 v121, v24, v25, v121
    v_max3_f32 v121, v26, v27, v121
    v_max3_f32 v121, v28, v29, v121
    v_max3_f32 v121, v30, v31, v121
    v_mfma_f32_32x32x16_bf16 v[16:31], a[40:43], v[100:103], 0
    v_max3_f32 v121, v32, v33, v121
    v_max3_f32 v121, v34, v35, v121
    v_max3_f32 v121, v36, v37, v121
    v_max3_f32 v121, v38, v39, v121
    v_max3_f32 v121, v40, v41, v121
    v_max3_f32 v121, v42, v43, v121
    v_max3_f32 v121, v44, v45, v121
    v_max3_f32 v121, v46, v47, v121
    v_mfma_f32_32x32x16_bf16 v[32:47], a[44:47], v[100:103], 0
    s_nop 2
    v_max3_f32 v121, v16, v17, v121
    v_max3_f32 v121, v18, v19, v121
    v_max3_f32 v121, v20, v21, v121
    v_max3_f32 v121, v22, v23, v121
    v_max3_f32 v121, v24, v25, v121
    v_max3_f32 v121, v26, v27, v121
    v_max3_f32 v121, v28, v29, v121
    v_max3_f32 v121, v30, v31, v121
    v_mfma_f32_32x32x16_bf16 v[16:31], a[48:51], v[100:103], 0
    v_max3_f32 v121, v32, v33, v121
    v_max3_f32 v121, v34, v35, v121
    v_max3_f32 v121, v36, v37, v121
    v_max3_f32 v121, v38, v39, v121
    v_max3_f32 v121, v40, v41, v121
    v_max3_f32 v121, v42, v43, v121
    v_max3_f32 v121, v44, v45, v121
    v_max3_f32 v121, v46, v47, v121
    v_mfma_f32_32x32x16_bf16 v[32:47], a[52:55], v[100:103], 0
    s_nop 2
    v_max3_f32 v121, v16, v17, v121
    v_max3_f32 v121, v18, v19, v121
    v_max3_f32 v121, v20, v21, v121
    v_max3_f32 v121, v22, v23, v121
    v_max3_f32 v121, v24, v25, v121
    v_max3_f32 v121, v26, v27, v121
    v_max3_f32 v121, v28, v29, v121
    v_max3_f32 v121, v30, v31, v121
    v_mfma_f32_32x32x16_bf16 v[16:31], a[56:59], v[100:103], 0
    v_max3_f32 v121, v32, v33, v121
    v_max3_f32 v121, v34, v35, v121
    v_max3_f32 v121, v36, v37, v121
    v_max3_f32 v121, v38, v39, v121
    v_max3_f32 v121, v40, v41, v121
    v_max3_f32 v121, v42, v43, v121
    v_max3_f32 v121, v44, v45, v121
    v_max3_f32 v121, v46, v47, v121
    v_mfma_f32_32x32x16_bf16 v[32:47], a[60:63], v[100:103], 0
    s_nop 2
    v_max3_f32 v121, v16, v17, v121
    v_max3_f32 v121, v18, v19, v121
    v_max3_f32 v121, v20, v21, v121
    v_max3_f32 v121, v22, v23, v121
    v_max3_f32 v121, v24, v25, v121
    v_max3_f32 v121, v26, v27, v121
    v_max3_f32 v121, v28, v29, v121
    v_max3_f32 v121, v30, v31, v121
    s_nop 0
    v_max3_f32 v121, v32, v33, v121
    v_max3_f32 v121, v34, v35, v121
    v_max3_f32 v121, v36, v37, v121
    v_max3_f32 v121, v38, v39, v121
    v_max3_f32 v121, v40, v41, v121
    v_max3_f32 v121, v42, v43, v121
    v_max3_f32 v121, v44, v45, v121
    v_max3_f32 v121, v46, v47, v121
    v_mov_b32 v122, v121
    s_nop 1
    v_permlane32_swap_b32 v121, v122
    v_max_f32 v121, v121, v122
    s_lshl_b32 s3, s64, 9
    s_lshl_b32 s7, s6, 7
    s_add_u32 s3, s3, s7
    v_and_b32 v122, 31, v0
    v_lshl_add_u32 v122, v122, 2, s3
    v_add_u32 v122, 155648, v122
    ds_write_b32 v122, v121
    s_add_u32 s64, s64, 1
    s_cmp_lt_u32 s64, 8
    s_cbranch_scc1 L_mx
    s_waitcnt lgkmcnt(0)
    s_barrier
    v_and_b32 v122, 31, v0
    v_lshlrev_b32 v122, 2, v122
    s_lshl_b32 s3, s6, 10
    s_add_u32 s3, s3, 155648
    v_add_u32 v122, s3, v122
    ds_read_b32 v16, v122 offset:0
    ds_read_b32 v17, v122 offset:128
    ds_read_b32 v18, v122 offset:256
    ds_read_b32 v19, v122 offset:384
    ds_read_b32 v20, v122 offset:512
    ds_read_b32 v21, v122 offset:640
    ds_read_b32 v22, v122 offset:768
    ds_read_b32 v23, v122 offset:896
    s_waitcnt lgkmcnt(0)
    s_lshl_b32 s3, s6, 9
    s_add_u32 s3, s3, 159744
    v_lshl_add_u32 v122, v0, 2, s3
    v_max3_f32 v16, v16, v17, v18
    v_max_f32 v16, v16, v19
    v_sub_f32 v16, 0, v16
    ds_write_b32 v122, v16 offset:0
    v_max3_f32 v20, v20, v21, v22
    v_max_f32 v20, v20, v23
    v_sub_f32 v20, 0, v20
    ds_write_b32 v122, v20 offset:256
    s_waitcnt lgkmcnt(0)
    s_barrier
    v_lshlrev_b32 v120, 2, v0
    v_add_u32 v120, 159744, v120
    ds_read_b32 v121, v120
    v_add_u32 v120, 256, v120
    s_waitcnt lgkmcnt(0)
    v_mov_b32 v104, v121
    v_mov_b32 v105, v121
    v_mov_b32 v106, v121
    v_mov_b32 v107, v121
    v_mov_b32 v108, v121
    v_mov_b32 v109, v121
    v_mov_b32 v110, v121
    v_mov_b32 v111, v121
    v_mov_b32 v112, v121
    v_mov_b32 v113, v121
    v_mov_b32 v114, v121
    v_mov_b32 v115, v121
    v_mov_b32 v116, v121
    v_mov_b32 v117, v121
    v_mov_b32 v118, v121
    v_mov_b32 v119, v121
    s_nop 1
    v_mfma_f32_32x32x16_bf16 v[16:31], a[0:3], v[96:99], v[104:119]
    s_nop 11
    v_exp_f32 v16, v16
    v_exp_f32 v17, v17
    v_exp_f32 v18, v18
    v_exp_f32 v19, v19
    v_exp_f32 v20, v20
    v_mfma_f32_32x32x16_bf16 v[32:47], a[4:7], v[96:99], v[104:119]
    v_exp_f32 v21, v21
    v_exp_f32 v22, v22
    v_exp_f32 v23, v23
    v_exp_f32 v24, v24
    v_exp_f32 v25, v25
    v_smfmac_f32_32x32x32_bf16 v[64:79], a[64:67], v[16:23], v48
    v_exp_f32 v26, v26
    v_exp_f32 v27, v27
    v_exp_f32 v28, v28
    v_exp_f32 v29, v29
    v_exp_f32 v30, v30
    v_exp_f32 v31, v31
    v_exp_f32 v32, v32
    v_exp_f32 v33, v33
    v_smfmac_f32_32x32x32_bf16 v[64:79], a[68:71], v[24:31], v48
    v_exp_f32 v34, v34
    v_exp_f32 v35, v35
    v_exp_f32 v36, v36
    v_mfma_f32_32x32x16_bf16 v[16:31], a[8:11], v[96:99], v[104:119]
    v_exp_f32 v37, v37
    v_exp_f32 v38, v38
    v_exp_f32 v39, v39
    v_exp_f32 v40, v40
    v_exp_f32 v41, v41
    v_smfmac_f32_32x32x32_bf16 v[64:79], a[72:75], v[32:39], v48
    v_exp_f32 v42, v42
    v_exp_f32 v43, v43
    v_exp_f32 v44, v44
    v_exp_f32 v45, v45
    v_exp_f32 v46, v46
    v_exp_f32 v47, v47
    v_exp_f32 v16, v16
    v_exp_f32 v17, v17
    v_smfmac_f32_32x32x32_bf16 v[64:79], a[76:79], v[40:47], v48
    v_exp_f32 v18, v18
    v_exp_f32 v19, v19
    v_exp_f32 v20, v20
    v_mfma_f32_32x32x16_bf16 v[32:47], a[12:15], v[96:99], v[104:119]
    v_exp_f32 v21, v21
    v_exp_f32 v22, v22
    v_exp_f32 v23, v23
    v_exp_f32 v24, v24
    v_exp_f32 v25, v25
    v_smfmac_f32_32x32x32_bf16 v[64:79], a[80:83], v[16:23], v48
    v_exp_f32 v26, v26
    v_exp_f32 v27, v27
    v_exp_f32 v28, v28
    v_exp_f32 v29, v29
    v_exp_f32 v30, v30
    v_exp_f32 v31, v31
    v_exp_f32 v32, v32
    v_exp_f32 v33, v33
    v_smfmac_f32_32x32x32_bf16 v[64:79], a[84:87], v[24:31], v48
    v_exp_f32 v34, v34
    v_exp_f32 v35, v35
    v_exp_f32 v36, v36
    v_mfma_f32_32x32x16_bf16 v[16:31], a[16:19], v[96:99], v[104:119]
    v_exp_f32 v37, v37
    v_exp_f32 v38, v38
    v_exp_f32 v39, v39
    v_exp_f32 v40, v40
    v_exp_f32 v41, v41
    v_smfmac_f32_32x32x32_bf16 v[64:79], a[88:91], v[32:39], v48
    v_exp_f32 v42, v42
    v_exp_f32 v43, v43
    v_exp_f32 v44, v44
    v_exp_f32 v45, v45
    v_exp_f32 v46, v46
    v_exp_f32 v47, v47
    v_exp_f32 v16, v16
    v_exp_f32 v17, v17
    v_smfmac_f32_32x32x32_bf16 v[64:79], a[92:95], v[40:47], v48
    v_exp_f32 v18, v18
    ds_read_b128 v[100:103], v58
    v_exp_f32 v19, v19
    ds_read_b32 v121, v120
    v_exp_f32 v20, v20
    v_mfma_f32_32x32x16_bf16 v[32:47], a[20:23], v[96:99], v[104:119]
    v_exp_f32 v21, v21
    v_exp_f32 v22, v22
    v_exp_f32 v23, v23
    v_exp_f32 v24, v24
    v_exp_f32 v25, v25
    v_smfmac_f32_32x32x32_bf16 v[64:79], a[96:99], v[16:23], v48
    v_exp_f32 v26, v26
    v_exp_f32 v27, v27
    v_exp_f32 v28, v28
    v_exp_f32 v29, v29
    v_exp_f32 v30, v30
    v_exp_f32 v31, v31
    v_exp_f32 v32, v32
    v_exp_f32 v33, v33
    v_smfmac_f32_32x32x32_bf16 v[64:79], a[100:103], v[24:31], v48
    v_exp_f32 v34, v34
    v_add_u32 v58, 1024, v58
    v_exp_f32 v35, v35
    v_exp_f32 v36, v36
    v_mfma_f32_32x32x16_bf16 v[16:31], a[24:27], v[96:99], v[104:119]
    v_exp_f32 v37, v37
    v_add_u32 v120, 256, v120
    v_exp_f32 v38, v38
    v_exp_f32 v39, v39
    v_exp_f32 v40, v40
    v_exp_f32 v41, v41
    v_smfmac_f32_32x32x32_bf16 v[64:79], a[104:107], v[32:39], v48
    v_exp_f32 v42, v42
    v_exp_f32 v43, v43
    v_exp_f32 v44, v44
    v_exp_f32 v45, v45
    v_exp_f32 v46, v46
    v_exp_f32 v47, v47
    v_exp_f32 v16, v16
    v_exp_f32 v17, v17
    v_smfmac_f32_32x32x32_bf16 v[64:79], a[108:111], v[40:47], v48
    v_exp_f32 v18, v18
    v_exp_f32 v19, v19
    v_exp_f32 v20, v20
    v_mfma_f32_32x32x16_bf16 v[32:47], a[28:31], v[96:99], v[104:119]
    v_exp_f32 v21, v21
    v_exp_f32 v22, v22
    v_exp_f32 v23, v23
    v_exp_f32 v24, v24
    v_exp_f32 v25, v25
    v_smfmac_f32_32x32x32_bf16 v[64:79], a[112:115], v[16:23], v48
    v_exp_f32 v26, v26
    v_exp_f32 v27, v27
    v_exp_f32 v28, v28
    v_exp_f32 v29, v29
    v_exp_f32 v30, v30
    v_exp_f32 v31, v31
    v_exp_f32 v32, v32
    v_exp_f32 v33, v33
    v_smfmac_f32_32x32x32_bf16 v[64:79], a[116:119], v[24:31], v48
    v_exp_f32 v34, v34
    v_exp_f32 v35, v35
    v_exp_f32 v36, v36
    v_mfma_f32_32x32x16_bf16 v[16:31], a[32:35], v[96:99], v[104:119]
    v_exp_f32 v37, v37
    v_exp_f32 v38, v38
    v_exp_f32 v39, v39
    v_exp_f32 v40, v40
    v_exp_f32 v41, v41
    v_smfmac_f32_32x32x32_bf16 v[64:79], a[120:123], v[32:39], v48
    v_exp_f32 v42, v42
    v_exp_f32 v43, v43
    v_exp_f32 v44, v44
    v_exp_f32 v45, v45
    v_exp_f32 v46, v46
    v_exp_f32 v47, v47
    v_exp_f32 v16, v16
    v_exp_f32 v17, v17
    v_smfmac_f32_32x32x32_bf16 v[64:79], a[124:127], v[40:47], v48
    v_exp_f32 v18, v18
    v_exp_f32 v19, v19
    v_exp_f32 v20, v20
    v_mfma_f32_32x32x16_bf16 v[32:47], a[36:39], v[96:99], v[104:119]
    v_exp_f32 v21, v21
    v_exp_f32 v22, v22
    v_exp_f32 v23, v23
    v_exp_f32 v24, v24
    v_exp_f32 v25, v25
    v_smfmac_f32_32x32x32_bf16 v[64:79], a[128:131], v[16:23], v48
    v_exp_f32 v26, v26
    v_exp_f32 v27, v27
    v_exp_f32 v28, v28
    v_exp_f32 v29, v29
    v_exp_f32 v30, v30
    v_exp_f32 v31, v31
    v_exp_f32 v32, v32
    v_exp_f32 v33, v33
    v_smfmac_f32_32x32x32_bf16 v[64:79], a[132:135], v[24:31], v48
    v_exp_f32 v34, v34
    v_exp_f32 v35, v35
    v_exp_f32 v36, v36
    v_mfma_f32_32x32x16_bf16 v[16:31], a[40:43], v[96:99], v[104:119]
    v_exp_f32 v37, v37
    v_exp_f32 v38, v38
    v_exp_f32 v39, v39
    v_exp_f32 v40, v40
    v_exp_f32 v41, v41
    v_smfmac_f32_32x32x32_bf16 v[64:79], a[136:139], v[32:39], v48
    v_exp_f32 v42, v42
    v_exp_f32 v43, v43
    v_exp_f32 v44, v44
    v_exp_f32 v45, v45
    v_exp_f32 v46, v46
    v_exp_f32 v47, v47
    v_exp_f32 v16, v16
    v_exp_f32 v17, v17
    v_smfmac_f32_32x32x32_bf16 v[64:79], a[140:143], v[40:47], v48
    v_exp_f32 v18, v18
    v_exp_f32 v19, v19
    v_exp_f32 v20, v20
    v_mfma_f32_32x32x16_bf16 v[32:47], a[44:47], v[96:99], v[104:119]
    v_exp_f32 v21, v21
    v_exp_f32 v22, v22
    v_exp_f32 v23, v23
    v_exp_f32 v24, v24
    v_exp_f32 v25, v25
    v_smfmac_f32_32x32x32_bf16 v[64:79], a[144:147], v[16:23], v48
    v_exp_f32 v26, v26
    v_exp_f32 v27, v27
    v_exp_f32 v28, v28
    v_exp_f32 v29, v29
    v_exp_f32 v30, v30
    v_exp_f32 v31, v31
    v_exp_f32 v32, v32
    v_exp_f32 v33, v33
    v_smfmac_f32_32x32x32_bf16 v[64:79], a[148:151], v[24:31], v48
    v_exp_f32 v34, v34
    v_exp_f32 v35, v35
    v_exp_f32 v36, v36
    v_mfma_f32_32x32x16_bf16 v[16:31], a[48:51], v[96:99], v[104:119]
    v_exp_f32 v37, v37
    v_exp_f32 v38, v38
    v_exp_f32 v39, v39
    v_exp_f32 v40, v40
    v_exp_f32 v41, v41
    v_smfmac_f32_32x32x32_bf16 v[64:79], a[152:155], v[32:39], v48
    v_exp_f32 v42, v42
    v_exp_f32 v43, v43
    v_exp_f32 v44, v44
    v_exp_f32 v45, v45
    v_exp_f32 v46, v46
    v_exp_f32 v47, v47
    v_exp_f32 v16, v16
    v_exp_f32 v17, v17
    v_smfmac_f32_32x32x32_bf16 v[64:79], a[156:159], v[40:47], v48
    v_exp_f32 v18, v18
    v_exp_f32 v19, v19
    v_exp_f32 v20, v20
    v_mfma_f32_32x32x16_bf16 v[32:47], a[52:55], v[96:99], v[104:119]
    v_exp_f32 v21, v21
    v_exp_f32 v22, v22
    v_exp_f32 v23, v23
    v_exp_f32 v24, v24
    v_exp_f32 v25, v25
    v_smfmac_f32_32x32x32_bf16 v[64:79], a[160:163], v[16:23], v48
    v_exp_f32 v26, v26
    v_exp_f32 v27, v27
    v_exp_f32 v28, v28
    v_exp_f32 v29, v29
    v_exp_f32 v30, v30
    v_exp_f32 v31, v31
    v_exp_f32 v32, v32
    v_exp_f32 v33, v33
    v_smfmac_f32_32x32x32_bf16 v[64:79], a[164:167], v[24:31], v48
    v_exp_f32 v34, v34
    v_exp_f32 v35, v35
    v_exp_f32 v36, v36
    v_mfma_f32_32x32x16_bf16 v[16:31], a[56:59], v[96:99], v[104:119]
    v_exp_f32 v37, v37
    v_exp_f32 v38, v38
    v_exp_f32 v39, v39
    v_exp_f32 v40, v40
    v_exp_f32 v41, v41
    v_smfmac_f32_32x32x32_bf16 v[64:79], a[168:171], v[32:39], v48
    v_exp_f32 v42, v42
    v_exp_f32 v43, v43
    v_exp_f32 v44, v44
    v_exp_f32 v45, v45
    v_exp_f32 v46, v46
    v_exp_f32 v47, v47
    s_waitcnt lgkmcnt(0)
    v_exp_f32 v16, v16
    v_exp_f32 v17, v17
    v_smfmac_f32_32x32x32_bf16 v[64:79], a[172:175], v[40:47], v48
    v_exp_f32 v18, v18
    v_exp_f32 v19, v19
    v_exp_f32 v20, v20
    v_mfma_f32_32x32x16_bf16 v[32:47], a[60:63], v[96:99], v[104:119]
    v_exp_f32 v21, v21
    v_exp_f32 v22, v22
    v_exp_f32 v23, v23
    v_exp_f32 v24, v24
    v_exp_f32 v25, v25
    v_smfmac_f32_32x32x32_bf16 v[64:79], a[176:179], v[16:23], v48
    v_exp_f32 v26, v26
    v_exp_f32 v27, v27
    v_exp_f32 v28, v28
    v_exp_f32 v29, v29
    v_exp_f32 v30, v30
    v_exp_f32 v31, v31
    v_exp_f32 v32, v32
    v_mov_b32 v104, v121
    v_mov_b32 v105, v121
    v_mov_b32 v106, v121
    v_mov_b32 v107, v121
    v_mov_b32 v108, v121
    v_mov_b32 v109, v121
    v_mov_b32 v110, v121
    v_mov_b32 v111, v121
    v_mov_b32 v112, v121
    v_mov_b32 v113, v121
    v_mov_b32 v114, v121
    v_mov_b32 v115, v121
    v_mov_b32 v116, v121
    v_mov_b32 v117, v121
    v_mov_b32 v118, v121
    v_mov_b32 v119, v121
    v_exp_f32 v33, v33
    v_smfmac_f32_32x32x32_bf16 v[64:79], a[180:183], v[24:31], v48
    v_exp_f32 v34, v34
    v_exp_f32 v35, v35
    v_exp_f32 v36, v36
    v_mfma_f32_32x32x16_bf16 v[16:31], a[0:3], v[100:103], v[104:119]
    v_exp_f32 v37, v37
    v_exp_f32 v38, v38
    v_exp_f32 v39, v39
    v_exp_f32 v40, v40
    v_exp_f32 v41, v41
    v_smfmac_f32_32x32x32_bf16 v[64:79], a[184:187], v[32:39], v48
    v_exp_f32 v42, v42
    v_exp_f32 v43, v43
    v_exp_f32 v44, v44
    v_exp_f32 v45, v45
    v_exp_f32 v46, v46
    v_exp_f32 v47, v47
    s_mov_b32 s64, 4
    s_branch L_sttY
L_sttX:
    v_exp_f32 v16, v16
    v_exp_f32 v17, v17
    v_exp_f32 v18, v18
    v_smfmac_f32_32x32x32_bf16 v[80:95], a[188:191], v[40:47], v48
    v_exp_f32 v19, v19
    v_exp_f32 v20, v20
    v_mfma_f32_32x32x16_bf16 v[32:47], a[4:7], v[96:99], v[104:119]
    v_exp_f32 v21, v21
    v_exp_f32 v22, v22
    v_exp_f32 v23, v23
    v_exp_f32 v24, v24
    v_exp_f32 v25, v25
    v_exp_f32 v26, v26
    v_smfmac_f32_32x32x32_bf16 v[64:79], a[64:67], v[16:23], v48
    v_exp_f32 v27, v27
    v_exp_f32 v28, v28
    v_exp_f32 v29, v29
    v_exp_f32 v30, v30
    v_exp_f32 v31, v31
    v_exp_f32 v32, v32
    v_exp_f32 v33, v33
    v_exp_f32 v34, v34
    v_smfmac_f32_32x32x32_bf16 v[64:79], a[68:71], v[24:31], v48
    v_exp_f32 v35, v35
    v_exp_f32 v36, v36
    v_mfma_f32_32x32x16_bf16 v[16:31], a[8:11], v[96:99], v[104:119]
    v_exp_f32 v37, v37
    v_exp_f32 v38, v38
    v_exp_f32 v39, v39
    v_exp_f32 v40, v40
    v_exp_f32 v41, v41
    v_exp_f32 v42, v42
    v_smfmac_f32_32x32x32_bf16 v[64:79], a[72:75], v[32:39], v48
    v_exp_f32 v43, v43
    v_exp_f32 v44, v44
    v_exp_f32 v45, v45
    v_exp_f32 v46, v46
    v_exp_f32 v47, v47
    v_exp_f32 v16, v16
    v_exp_f32 v17, v17
    v_exp_f32 v18, v18
    v_smfmac_f32_32x32x32_bf16 v[64:79], a[76:79], v[40:47], v48
    ds_write_b128 v56, v[80:83]
    v_exp_f32 v19, v19
    v_exp_f32 v20, v20
    v_mfma_f32_32x32x16_bf16 v[32:47], a[12:15], v[96:99], v[104:119]
    v_exp_f32 v21, v21
    ds_write_b128 v56, v[84:87] offset:1024
    v_exp_f32 v22, v22
    v_exp_f32 v23, v23
    ds_write_b32 v57, v88
    v_exp_f32 v24, v24
    v_exp_f32 v25, v25
    v_exp_f32 v26, v26
    v_smfmac_f32_32x32x32_bf16 v[64:79], a[80:83], v[16:23], v48
    v_exp_f32 v27, v27
    v_exp_f32 v28, v28
    v_exp_f32 v29, v29
    v_exp_f32 v30, v30
    v_exp_f32 v31, v31
    v_exp_f32 v32, v32
    v_exp_f32 v33, v33
    v_exp_f32 v34, v34
    v_smfmac_f32_32x32x32_bf16 v[64:79], a[84:87], v[24:31], v48
    v_add_u32 v56, 9216, v56
    v_exp_f32 v35, v35
    v_exp_f32 v36, v36
    v_mfma_f32_32x32x16_bf16 v[16:31], a[16:19], v[96:99], v[104:119]
    v_exp_f32 v37, v37
    v_add_u32 v57, 9216, v57
    v_exp_f32 v38, v38
    v_exp_f32 v39, v39
    v_exp_f32 v40, v40
    v_exp_f32 v41, v41
    v_exp_f32 v42, v42
    v_smfmac_f32_32x32x32_bf16 v[64:79], a[88:91], v[32:39], v48
    v_exp_f32 v43, v43
    v_exp_f32 v44, v44
    v_exp_f32 v45, v45
    v_exp_f32 v46, v46
    v_exp_f32 v47, v47
    v_exp_f32 v16, v16
    v_exp_f32 v17, v17
    v_exp_f32 v18, v18
    v_smfmac_f32_32x32x32_bf16 v[64:79], a[92:95], v[40:47], v48
    ds_read_b128 v[100:103], v58
    v_exp_f32 v19, v19
    ds_read_b32 v121, v120
    v_exp_f32 v20, v20
    v_mfma_f32_32x32x16_bf16 v[32:47], a[20:23], v[96:99], v[104:119]
    v_exp_f32 v21, v21
    v_exp_f32 v22, v22
    v_exp_f32 v23, v23
    v_exp_f32 v24, v24
    v_exp_f32 v25, v25
    v_exp_f32 v26, v26
    v_smfmac_f32_32x32x32_bf16 v[64:79], a[96:99], v[16:23], v48
    v_exp_f32 v27, v27
    v_exp_f32 v28, v28
    v_exp_f32 v29, v29
    v_exp_f32 v30, v30
    v_exp_f32 v31, v31
    v_exp_f32 v32, v32
    v_exp_f32 v33, v33
    v_exp_f32 v34, v34
    v_smfmac_f32_32x32x32_bf16 v[64:79], a[100:103], v[24:31], v48
    v_add_u32 v58, 1024, v58
    v_exp_f32 v35, v35
    v_exp_f32 v36, v36
    v_mfma_f32_32x32x16_bf16 v[16:31], a[24:27], v[96:99], v[104:119]
    v_exp_f32 v37, v37
    v_add_u32 v120, 256, v120
    v_exp_f32 v38, v38
    v_exp_f32 v39, v39
    v_exp_f32 v40, v40
    v_exp_f32 v41, v41
    v_exp_f32 v42, v42
    v_smfmac_f32_32x32x32_bf16 v[64:79], a[104:107], v[32:39], v48
    v_exp_f32 v43, v43
    v_exp_f32 v44, v44
    v_exp_f32 v45, v45
    v_exp_f32 v46, v46
    v_exp_f32 v47, v47
    v_exp_f32 v16, v16
    v_exp_f32 v17, v17
    v_exp_f32 v18, v18
    v_smfmac_f32_32x32x32_bf16 v[64:79], a[108:111], v[40:47], v48
    v_exp_f32 v19, v19
    v_exp_f32 v20, v20
    v_mfma_f32_32x32x16_bf16 v[32:47], a[28:31], v[96:99], v[104:119]
    v_exp_f32 v21, v21
    v_exp_f32 v22, v22
    v_exp_f32 v23, v23
    v_exp_f32 v24, v24
    v_exp_f32 v25, v25
    v_exp_f32 v26, v26
    v_smfmac_f32_32x32x32_bf16 v[64:79], a[112:115], v[16:23], v48
    v_exp_f32 v27, v27
    v_exp_f32 v28, v28
    v_exp_f32 v29, v29
    v_exp_f32 v30, v30
    v_exp_f32 v31, v31
    v_exp_f32 v32, v32
    v_exp_f32 v33, v33
    v_exp_f32 v34, v34
    v_smfmac_f32_32x32x32_bf16 v[64:79], a[116:119], v[24:31], v48
    v_exp_f32 v35, v35
    v_exp_f32 v36, v36
    v_mfma_f32_32x32x16_bf16 v[16:31], a[32:35], v[96:99], v[104:119]
    v_exp_f32 v37, v37
    v_exp_f32 v38, v38
    v_exp_f32 v39, v39
    v_exp_f32 v40, v40
    v_exp_f32 v41, v41
    v_exp_f32 v42, v42
    v_smfmac_f32_32x32x32_bf16 v[64:79], a[120:123], v[32:39], v48
    v_exp_f32 v43, v43
    v_exp_f32 v44, v44
    v_exp_f32 v45, v45
    v_exp_f32 v46, v46
    v_exp_f32 v47, v47
    v_exp_f32 v16, v16
    v_exp_f32 v17, v17
    v_exp_f32 v18, v18
    v_smfmac_f32_32x32x32_bf16 v[64:79], a[124:127], v[40:47], v48
    v_exp_f32 v19, v19
    v_exp_f32 v20, v20
    v_mfma_f32_32x32x16_bf16 v[32:47], a[36:39], v[96:99], v[104:119]
    v_exp_f32 v21, v21
    v_exp_f32 v22, v22
    v_exp_f32 v23, v23
    v_exp_f32 v24, v24
    v_exp_f32 v25, v25
    v_exp_f32 v26, v26
    v_smfmac_f32_32x32x32_bf16 v[64:79], a[128:131], v[16:23], v48
    v_exp_f32 v27, v27
    v_exp_f32 v28, v28
    v_mfma_f32_32x32x16_bf16 v[80:95], v[52:55], v[52:55], 0
    v_exp_f32 v29, v29
    v_exp_f32 v30, v30
    v_exp_f32 v31, v31
    v_exp_f32 v32, v32
    v_exp_f32 v33, v33
    v_exp_f32 v34, v34
    v_smfmac_f32_32x32x32_bf16 v[64:79], a[132:135], v[24:31], v48
    v_exp_f32 v35, v35
    v_exp_f32 v36, v36
    v_mfma_f32_32x32x16_bf16 v[16:31], a[40:43], v[96:99], v[104:119]
    v_exp_f32 v37, v37
    v_exp_f32 v38, v38
    v_exp_f32 v39, v39
    v_exp_f32 v40, v40
    v_exp_f32 v41, v41
    v_exp_f32 v42, v42
    v_smfmac_f32_32x32x32_bf16 v[64:79], a[136:139], v[32:39], v48
    v_exp_f32 v43, v43
    v_exp_f32 v44, v44
    v_exp_f32 v45, v45
    v_exp_f32 v46, v46
    v_exp_f32 v47, v47
    v_exp_f32 v16, v16
    v_exp_f32 v17, v17
    v_exp_f32 v18, v18
    v_smfmac_f32_32x32x32_bf16 v[64:79], a[140:143], v[40:47], v48
    v_exp_f32 v19, v19
    v_exp_f32 v20, v20
    v_mfma_f32_32x32x16_bf16 v[32:47], a[44:47], v[96:99], v[104:119]
    v_exp_f32 v21, v21
    v_exp_f32 v22, v22
    v_exp_f32 v23, v23
    v_exp_f32 v24, v24
    v_exp_f32 v25, v25
    v_exp_f32 v26, v26
    v_smfmac_f32_32x32x32_bf16 v[64:79], a[144:147], v[16:23], v48
    v_exp_f32 v27, v27
    v_exp_f32 v28, v28
    v_exp_f32 v29, v29
    v_exp_f32 v30, v30
    v_exp_f32 v31, v31
    v_exp_f32 v32, v32
    v_exp_f32 v33, v33
    v_exp_f32 v34, v34
    v_smfmac_f32_32x32x32_bf16 v[64:79], a[148:151], v[24:31], v48
    v_exp_f32 v35, v35
    v_exp_f32 v36, v36
    v_mfma_f32_32x32x16_bf16 v[16:31], a[48:51], v[96:99], v[104:119]
    v_exp_f32 v37, v37
    v_exp_f32 v38, v38
    v_exp_f32 v39, v39
    v_exp_f32 v40, v40
    v_exp_f32 v41, v41
    v_exp_f32 v42, v42
    v_smfmac_f32_32x32x32_bf16 v[64:79], a[152:155], v[32:39], v48
    v_exp_f32 v43, v43
    v_exp_f32 v44, v44
    v_exp_f32 v45, v45
    v_exp_f32 v46, v46
    v_exp_f32 v47, v47
    v_exp_f32 v16, v16
    v_exp_f32 v17, v17
    v_exp_f32 v18, v18
    v_smfmac_f32_32x32x32_bf16 v[64:79], a[156:159], v[40:47], v48
    v_exp_f32 v19, v19
    v_exp_f32 v20, v20
    v_mfma_f32_32x32x16_bf16 v[32:47], a[52:55], v[96:99], v[104:119]
    v_exp_f32 v21, v21
    v_exp_f32 v22, v22
    v_exp_f32 v23, v23
    v_exp_f32 v24, v24
    v_exp_f32 v25, v25
    v_exp_f32 v26, v26
    v_smfmac_f32_32x32x32_bf16 v[64:79], a[160:163], v[16:23], v48
    v_exp_f32 v27, v27
    v_exp_f32 v28, v28
    v_exp_f32 v29, v29
    v_exp_f32 v30, v30
    v_exp_f32 v31, v31
    v_exp_f32 v32, v32
    v_exp_f32 v33, v33
    v_exp_f32 v34, v34
    v_smfmac_f32_32x32x32_bf16 v[64:79], a[164:167], v[24:31], v48
    v_exp_f32 v35, v35
    v_exp_f32 v36, v36
    v_mfma_f32_32x32x16_bf16 v[16:31], a[56:59], v[96:99], v[104:119]
    v_exp_f32 v37, v37
    v_exp_f32 v38, v38
    v_exp_f32 v39, v39
    v_exp_f32 v40, v40
    v_exp_f32 v41, v41
    v_exp_f32 v42, v42
    v_smfmac_f32_32x32x32_bf16 v[64:79], a[168:171], v[32:39], v48
    v_exp_f32 v43, v43
    v_exp_f32 v44, v44
    v_exp_f32 v45, v45
    v_exp_f32 v46, v46
    v_exp_f32 v47, v47
    s_waitcnt lgkmcnt(0)
    v_exp_f32 v16, v16
    v_exp_f32 v17, v17
    v_exp_f32 v18, v18
    v_smfmac_f32_32x32x32_bf16 v[64:79], a[172:175], v[40:47], v48
    v_exp_f32 v19, v19
    v_exp_f32 v20, v20
    v_mfma_f32_32x32x16_bf16 v[32:47], a[60:63], v[96:99], v[104:119]
    v_exp_f32 v21, v21
    v_exp_f32 v22, v22
    v_exp_f32 v23, v23
    v_exp_f32 v24, v24
    v_exp_f32 v25, v25
    v_exp_f32 v26, v26
    v_smfmac_f32_32x32x32_bf16 v[64:79], a[176:179], v[16:23], v48
    v_exp_f32 v27, v27
    v_exp_f32 v28, v28
    v_exp_f32 v29, v29
    v_exp_f32 v30, v30
    v_exp_f32 v31, v31
    v_exp_f32 v32, v32
    v_mov_b32 v104, v121
    v_mov_b32 v105, v121
    v_mov_b32 v106, v121
    v_mov_b32 v107, v121
    v_mov_b32 v108, v121
    v_mov_b32 v109, v121
    v_mov_b32 v110, v121
    v_mov_b32 v111, v121
    v_mov_b32 v112, v121
    v_mov_b32 v113, v121
    v_mov_b32 v114, v121
    v_mov_b32 v115, v121
    v_mov_b32 v116, v121
    v_mov_b32 v117, v121
    v_mov_b32 v118, v121
    v_mov_b32 v119, v121
    v_exp_f32 v33, v33
    v_exp_f32 v34, v34
    v_smfmac_f32_32x32x32_bf16 v[64:79], a[180:183], v[24:31], v48
    v_exp_f32 v35, v35
    v_exp_f32 v36, v36
    v_mfma_f32_32x32x16_bf16 v[16:31], a[0:3], v[100:103], v[104:119]
    v_exp_f32 v37, v37
    v_exp_f32 v38, v38
    v_exp_f32 v39, v39
    v_exp_f32 v40, v40
    v_exp_f32 v41, v41
    v_exp_f32 v42, v42
    v_smfmac_f32_32x32x32_bf16 v[64:79], a[184:187], v[32:39], v48
    v_exp_f32 v43, v43
    v_exp_f32 v44, v44
    v_exp_f32 v45, v45
    v_exp_f32 v46, v46
    v_exp_f32 v47, v47
L_sttY:
    v_exp_f32 v16, v16
    v_exp_f32 v17, v17
    v_exp_f32 v18, v18
    v_smfmac_f32_32x32x32_bf16 v[64:79], a[188:191], v[40:47], v48
    v_exp_f32 v19, v19
    v_exp_f32 v20, v20
    v_mfma_f32_32x32x16_bf16 v[32:47], a[4:7], v[100:103], v[104:119]
    v_exp_f32 v21, v21
    v_exp_f32 v22, v22
    v_exp_f32 v23, v23
    v_exp_f32 v24, v24
    v_exp_f32 v25, v25
    v_exp_f32 v26, v26
    v_smfmac_f32_32x32x32_bf16 v[80:95], a[64:67], v[16:23], v48
    v_exp_f32 v27, v27
    v_exp_f32 v28, v28
    v_exp_f32 v29, v29
    v_exp_f32 v30, v30
    v_exp_f32 v31, v31
    v_exp_f32 v32, v32
    v_exp_f32 v33, v33
    v_exp_f32 v34, v34
    v_smfmac_f32_32x32x32_bf16 v[80:95], a[68:71], v[24:31], v48
    v_exp_f32 v35, v35
    v_exp_f32 v36, v36
    v_mfma_f32_32x32x16_bf16 v[16:31], a[8:11], v[100:103], v[104:119]
    v_exp_f32 v37, v37
    v_exp_f32 v38, v38
    v_exp_f32 v39, v39
    v_exp_f32 v40, v40
    v_exp_f32 v41, v41
    v_exp_f32 v42, v42
    v_smfmac_f32_32x32x32_bf16 v[80:95], a[72:75], v[32:39], v48
    v_exp_f32 v43, v43
    v_exp_f32 v44, v44
    v_exp_f32 v45, v45
    v_exp_f32 v46, v46
    v_exp_f32 v47, v47
    v_exp_f32 v16, v16
    v_exp_f32 v17, v17
    v_exp_f32 v18, v18
    v_smfmac_f32_32x32x32_bf16 v[80:95], a[76:79], v[40:47], v48
    ds_write_b128 v56, v[64:67]
    v_exp_f32 v19, v19
    v_exp_f32 v20, v20
    v_mfma_f32_32x32x16_bf16 v[32:47], a[12:15], v[100:103], v[104:119]
    v_exp_f32 v21, v21
    ds_write_b128 v56, v[68:71] offset:1024
    v_exp_f32 v22, v22
    v_exp_f32 v23, v23
    ds_write_b32 v57, v72
    v_exp_f32 v24, v24
    v_exp_f32 v25, v25
    v_exp_f32 v26, v26
    v_smfmac_f32_32x32x32_bf16 v[80:95], a[80:83], v[16:23], v48
    v_exp_f32 v27, v27
    v_exp_f32 v28, v28
    v_exp_f32 v29, v29
    v_exp_f32 v30, v30
    v_exp_f32 v31, v31
    v_exp_f32 v32, v32
    v_exp_f32 v33, v33
    v_exp_f32 v34, v34
    v_smfmac_f32_32x32x32_bf16 v[80:95], a[84:87], v[24:31], v48
    v_add_u32 v56, 9216, v56
    v_exp_f32 v35, v35
    v_exp_f32 v36, v36
    v_mfma_f32_32x32x16_bf16 v[16:31], a[16:19], v[100:103], v[104:119]
    v_exp_f32 v37, v37
    v_add_u32 v57, 9216, v57
    v_exp_f32 v38, v38
    v_exp_f32 v39, v39
    v_exp_f32 v40, v40
    v_exp_f32 v41, v41
    v_exp_f32 v42, v42
    v_smfmac_f32_32x32x32_bf16 v[80:95], a[88:91], v[32:39], v48
    v_exp_f32 v43, v43
    v_exp_f32 v44, v44
    v_exp_f32 v45, v45
    v_exp_f32 v46, v46
    v_exp_f32 v47, v47
    v_exp_f32 v16, v16
    v_exp_f32 v17, v17
    v_exp_f32 v18, v18
    v_smfmac_f32_32x32x32_bf16 v[80:95], a[92:95], v[40:47], v48
    ds_read_b128 v[96:99], v58
    v_exp_f32 v19, v19
    ds_read_b32 v121, v120
    v_exp_f32 v20, v20
    v_mfma_f32_32x32x16_bf16 v[32:47], a[20:23], v[100:103], v[104:119]
    v_exp_f32 v21, v21
    v_exp_f32 v22, v22
    v_exp_f32 v23, v23
    v_exp_f32 v24, v24
    v_exp_f32 v25, v25
    v_exp_f32 v26, v26
    v_smfmac_f32_32x32x32_bf16 v[80:95], a[96:99], v[16:23], v48
    v_exp_f32 v27, v27
    v_exp_f32 v28, v28
    v_exp_f32 v29, v29
    v_exp_f32 v30, v30
    v_exp_f32 v31, v31
    v_exp_f32 v32, v32
    v_exp_f32 v33, v33
    v_exp_f32 v34, v34
    v_smfmac_f32_32x32x32_bf16 v[80:95], a[100:103], v[24:31], v48
    v_add_u32 v58, 1024, v58
    v_exp_f32 v35, v35
    v_exp_f32 v36, v36
    v_mfma_f32_32x32x16_bf16 v[16:31], a[24:27], v[100:103], v[104:119]
    v_exp_f32 v37, v37
    v_add_u32 v120, 256, v120
    v_exp_f32 v38, v38
    v_exp_f32 v39, v39
    v_exp_f32 v40, v40
    v_exp_f32 v41, v41
    v_exp_f32 v42, v42
    v_smfmac_f32_32x32x32_bf16 v[80:95], a[104:107], v[32:39], v48
    v_exp_f32 v43, v43
    v_exp_f32 v44, v44
    v_exp_f32 v45, v45
    v_exp_f32 v46, v46
    v_exp_f32 v47, v47
    v_exp_f32 v16, v16
    v_exp_f32 v17, v17
    v_exp_f32 v18, v18
    v_smfmac_f32_32x32x32_bf16 v[80:95], a[108:111], v[40:47], v48
    v_exp_f32 v19, v19
    v_exp_f32 v20, v20
    v_mfma_f32_32x32x16_bf16 v[32:47], a[28:31], v[100:103], v[104:119]
    v_exp_f32 v21, v21
    v_exp_f32 v22, v22
    v_exp_f32 v23, v23
    v_exp_f32 v24, v24
    v_exp_f32 v25, v25
    v_exp_f32 v26, v26
    v_smfmac_f32_32x32x32_bf16 v[80:95], a[112:115], v[16:23], v48
    v_exp_f32 v27, v27
    v_exp_f32 v28, v28
    v_exp_f32 v29, v29
    v_exp_f32 v30, v30
    v_exp_f32 v31, v31
    v_exp_f32 v32, v32
    v_exp_f32 v33, v33
    v_exp_f32 v34, v34
    v_smfmac_f32_32x32x32_bf16 v[80:95], a[116:119], v[24:31], v48
    v_exp_f32 v35, v35
    v_exp_f32 v36, v36
    v_mfma_f32_32x32x16_bf16 v[16:31], a[32:35], v[100:103], v[104:119]
    v_exp_f32 v37, v37
    v_exp_f32 v38, v38
    v_exp_f32 v39, v39
    v_exp_f32 v40, v40
    v_exp_f32 v41, v41
    v_exp_f32 v42, v42
    v_smfmac_f32_32x32x32_bf16 v[80:95], a[120:123], v[32:39], v48
    v_exp_f32 v43, v43
    v_exp_f32 v44, v44
    v_exp_f32 v45, v45
    v_exp_f32 v46, v46
    v_exp_f32 v47, v47
    v_exp_f32 v16, v16
    v_exp_f32 v17, v17
    v_exp_f32 v18, v18
    v_smfmac_f32_32x32x32_bf16 v[80:95], a[124:127], v[40:47], v48
    v_exp_f32 v19, v19
    v_exp_f32 v20, v20
    v_mfma_f32_32x32x16_bf16 v[32:47], a[36:39], v[100:103], v[104:119]
    v_exp_f32 v21, v21
    v_exp_f32 v22, v22
    v_exp_f32 v23, v23
    v_exp_f32 v24, v24
    v_exp_f32 v25, v25
    v_exp_f32 v26, v26
    v_smfmac_f32_32x32x32_bf16 v[80:95], a[128:131], v[16:23], v48
    v_exp_f32 v27, v27
    v_exp_f32 v28, v28
    v_mfma_f32_32x32x16_bf16 v[64:79], v[52:55], v[52:55], 0
    v_exp_f32 v29, v29
    v_exp_f32 v30, v30
    v_exp_f32 v31, v31
    v_exp_f32 v32, v32
    v_exp_f32 v33, v33
    v_exp_f32 v34, v34
    v_smfmac_f32_32x32x32_bf16 v[80:95], a[132:135], v[24:31], v48
    v_exp_f32 v35, v35
    v_exp_f32 v36, v36
    v_mfma_f32_32x32x16_bf16 v[16:31], a[40:43], v[100:103], v[104:119]
    v_exp_f32 v37, v37
    v_exp_f32 v38, v38
    v_exp_f32 v39, v39
    v_exp_f32 v40, v40
    v_exp_f32 v41, v41
    v_exp_f32 v42, v42
    v_smfmac_f32_32x32x32_bf16 v[80:95], a[136:139], v[32:39], v48
    v_exp_f32 v43, v43
    v_exp_f32 v44, v44
    v_exp_f32 v45, v45
    v_exp_f32 v46, v46
    v_exp_f32 v47, v47
    v_exp_f32 v16, v16
    v_exp_f32 v17, v17
    v_exp_f32 v18, v18
    v_smfmac_f32_32x32x32_bf16 v[80:95], a[140:143], v[40:47], v48
    v_exp_f32 v19, v19
    v_exp_f32 v20, v20
    v_mfma_f32_32x32x16_bf16 v[32:47], a[44:47], v[100:103], v[104:119]
    v_exp_f32 v21, v21
    v_exp_f32 v22, v22
    v_exp_f32 v23, v23
    v_exp_f32 v24, v24
    v_exp_f32 v25, v25
    v_exp_f32 v26, v26
    v_smfmac_f32_32x32x32_bf16 v[80:95], a[144:147], v[16:23], v48
    v_exp_f32 v27, v27
    v_exp_f32 v28, v28
    v_exp_f32 v29, v29
    v_exp_f32 v30, v30
    v_exp_f32 v31, v31
    v_exp_f32 v32, v32
    v_exp_f32 v33, v33
    v_exp_f32 v34, v34
    v_smfmac_f32_32x32x32_bf16 v[80:95], a[148:151], v[24:31], v48
    v_exp_f32 v35, v35
    v_exp_f32 v36, v36
    v_mfma_f32_32x32x16_bf16 v[16:31], a[48:51], v[100:103], v[104:119]
    v_exp_f32 v37, v37
    v_exp_f32 v38, v38
    v_exp_f32 v39, v39
    v_exp_f32 v40, v40
    v_exp_f32 v41, v41
    v_exp_f32 v42, v42
    v_smfmac_f32_32x32x32_bf16 v[80:95], a[152:155], v[32:39], v48
    v_exp_f32 v43, v43
    v_exp_f32 v44, v44
    v_exp_f32 v45, v45
    v_exp_f32 v46, v46
    v_exp_f32 v47, v47
    v_exp_f32 v16, v16
    v_exp_f32 v17, v17
    v_exp_f32 v18, v18
    v_smfmac_f32_32x32x32_bf16 v[80:95], a[156:159], v[40:47], v48
    v_exp_f32 v19, v19
    v_exp_f32 v20, v20
    v_mfma_f32_32x32x16_bf16 v[32:47], a[52:55], v[100:103], v[104:119]
    v_exp_f32 v21, v21
    v_exp_f32 v22, v22
    v_exp_f32 v23, v23
    v_exp_f32 v24, v24
    v_exp_f32 v25, v25
    v_exp_f32 v26, v26
    v_smfmac_f32_32x32x32_bf16 v[80:95], a[160:163], v[16:23], v48
    v_exp_f32 v27, v27
    v_exp_f32 v28, v28
    v_exp_f32 v29, v29
    v_exp_f32 v30, v30
    v_exp_f32 v31, v31
    v_exp_f32 v32, v32
    v_exp_f32 v33, v33
    v_exp_f32 v34, v34
    v_smfmac_f32_32x32x32_bf16 v[80:95], a[164:167], v[24:31], v48
    v_exp_f32 v35, v35
    v_exp_f32 v36, v36
    v_mfma_f32_32x32x16_bf16 v[16:31], a[56:59], v[100:103], v[104:119]
    v_exp_f32 v37, v37
    v_exp_f32 v38, v38
    v_exp_f32 v39, v39
    v_exp_f32 v40, v40
    v_exp_f32 v41, v41
    v_exp_f32 v42, v42
    v_smfmac_f32_32x32x32_bf16 v[80:95], a[168:171], v[32:39], v48
    v_exp_f32 v43, v43
    v_exp_f32 v44, v44
    v_exp_f32 v45, v45
    v_exp_f32 v46, v46
    v_exp_f32 v47, v47
    s_waitcnt lgkmcnt(0)
    v_exp_f32 v16, v16
    v_exp_f32 v17, v17
    v_exp_f32 v18, v18
    v_smfmac_f32_32x32x32_bf16 v[80:95], a[172:175], v[40:47], v48
    v_exp_f32 v19, v19
    v_exp_f32 v20, v20
    v_mfma_f32_32x32x16_bf16 v[32:47], a[60:63], v[100:103], v[104:119]
    v_exp_f32 v21, v21
    v_exp_f32 v22, v22
    v_exp_f32 v23, v23
    v_exp_f32 v24, v24
    v_exp_f32 v25, v25
    v_exp_f32 v26, v26
    v_smfmac_f32_32x32x32_bf16 v[80:95], a[176:179], v[16:23], v48
    v_exp_f32 v27, v27
    v_exp_f32 v28, v28
    v_exp_f32 v29, v29
    v_exp_f32 v30, v30
    v_exp_f32 v31, v31
    v_exp_f32 v32, v32
    v_mov_b32 v104, v121
    v_mov_b32 v105, v121
    v_mov_b32 v106, v121
    v_mov_b32 v107, v121
    v_mov_b32 v108, v121
    v_mov_b32 v109, v121
    v_mov_b32 v110, v121
    v_mov_b32 v111, v121
    v_mov_b32 v112, v121
    v_mov_b32 v113, v121
    v_mov_b32 v114, v121
    v_mov_b32 v115, v121
    v_mov_b32 v116, v121
    v_mov_b32 v117, v121
    v_mov_b32 v118, v121
    v_mov_b32 v119, v121
    v_exp_f32 v33, v33
    v_exp_f32 v34, v34
    v_smfmac_f32_32x32x32_bf16 v[80:95], a[180:183], v[24:31], v48
    v_exp_f32 v35, v35
    v_exp_f32 v36, v36
    v_mfma_f32_32x32x16_bf16 v[16:31], a[0:3], v[96:99], v[104:119]
    v_exp_f32 v37, v37
    v_exp_f32 v38, v38
    v_exp_f32 v39, v39
    v_exp_f32 v40, v40
    v_exp_f32 v41, v41
    v_exp_f32 v42, v42
    v_smfmac_f32_32x32x32_bf16 v[80:95], a[184:187], v[32:39], v48
    v_exp_f32 v43, v43
    v_exp_f32 v44, v44
    v_exp_f32 v45, v45
    v_exp_f32 v46, v46
    v_exp_f32 v47, v47
    s_sub_u32 s64, s64, 1
    s_cmp_lg_u32 s64, 0
    s_cbranch_scc1 L_sttX
    v_smfmac_f32_32x32x32_bf16 v[80:95], a[188:191], v[40:47], v48
    s_nop 11
    ds_write_b128 v56, v[80:83]
    ds_write_b128 v56, v[84:87] offset:1024
    ds_write_b32 v57, v88
    v_and_b32 v13, 15, v0
    v_lshlrev_b32 v13, 2, v13
    buffer_load_dword v12, v13, s[8:11], s86 offen sc1
    s_mul_i32 s3, s6, 18432
    s_add_u32 s3, s3, 73728
    v_add_u32 v118, s3, v9
    s_add_u32 s3, s3, 2048
    v_lshl_add_u32 v119, v0, 2, s3
    s_lshr_b32 s3, s6, 1
    s_lshl_b32 s7, s4, 1
    s_add_u32 s3, s3, s7
    s_lshl_b32 s3, s3, 5
    s_lshl_b32 s7, s5, 2
    s_add_u32 s3, s3, s7
    s_and_b32 s7, s6, 1
    s_lshl_b32 s7, s7, 1
    s_add_u32 s3, s3, s7
    s_lshl_b32 s3, s3, 10
    s_add_u32 s63, s3, 3145728
    s_waitcnt vmcnt(0)
    s_mov_b32 s29, 131072
XC_CHKS:
    v_cmp_eq_u32 vcc, 0, v12
    s_nop 0
    s_cmp_eq_u64 vcc, 0
    s_cbranch_scc1 XC_OKS
    s_sub_u32 s29, s29, 1
    s_cmp_eq_u32 s29, 0
    s_cbranch_scc1 XC_OKS
    buffer_load_dword v12, v13, s[8:11], s86 offen sc1
    s_waitcnt vmcnt(0)
    s_branch XC_CHKS
XC_OKS:
    v_cmp_ne_u32 vcc, s43, v12
    s_nop 0
    s_cmp_lg_u64 vcc, 0
    s_cselect_b32 s43, 1, 0
    s_branch L_att_done
HST_0:
    buffer_store_dwordx4 v[124:127], v9, s[8:11], s63 offen offset:0 sc1
    s_branch HSB_0
HST_1:
    buffer_store_dwordx4 v[124:127], v9, s[8:11], s63 offen offset:1024 sc1
    s_branch HSB_1
HST_2:
    buffer_store_dword v12, v13, s[8:11], s3 offen sc1
    s_branch HSB_2
HST_3:
    buffer_store_dwordx4 v[32:35], v9, s[8:11], s71 offen sc1
    buffer_store_dwordx4 v[36:39], v9, s[8:11], s71 offen offset:1024 sc1
    s_branch HSB_3
HST_4:
    buffer_store_dwordx2 v[40:41], v12, s[8:11], s3 offen sc1
    s_branch HSB_4
HST_5:
    buffer_store_dwordx4 v[24:27], v9, s[8:11], s30 offen offset:0 sc1
    s_branch HSB_5
HST_6:
    buffer_store_dwordx4 v[24:27], v9, s[8:11], s30 offen offset:1024 sc1
    s_branch HSB_6
HST_7:
    buffer_store_dwordx4 v[24:27], v9, s[8:11], s30 offen offset:2048 sc1
    s_branch HSB_7
HST_8:
    buffer_store_dwordx4 v[24:27], v9, s[8:11], s30 offen offset:3072 sc1
    s_branch HSB_8
HST_9:
    buffer_store_dwordx4 v[24:27], v9, s[8:11], s30 offen offset:0 sc1
    s_branch HSB_9
HST_10:
    buffer_store_dwordx4 v[24:27], v9, s[8:11], s30 offen offset:1024 sc1
    s_branch HSB_10
HST_11:
    buffer_store_dword v12, v13, s[8:11], s3 offen sc1
    s_branch HSB_11
.section .rodata,"a"
.p2align 6
.amdhsa_kernel sequential_preLN__grouped_kv_mqa__geglu_ffn__prompt_kernel
  .amdhsa_next_free_vgpr 512
  .amdhsa_next_free_sgpr 96
  .amdhsa_accum_offset 256
  .amdhsa_group_segment_fixed_size 0
  .amdhsa_kernarg_size 96
  .amdhsa_user_sgpr_count 2
  .amdhsa_user_sgpr_kernarg_segment_ptr 1
  .amdhsa_system_sgpr_workgroup_id_x 1
.end_amdhsa_kernel
```
